```python
import torch

def _softmax(x, axis=-1):
    return torch.softmax(x, dim=axis)
def _gelu(x):
    return torch.nn.functional.gelu(x, approximate="tanh")
def _silu(x):
    return torch.nn.functional.silu(x)
def _sigmoid(x):
    return torch.sigmoid(x)
def _layernorm(x, axis=-1, eps=1e-5):
    m = x.mean(dim=axis, keepdim=True)
    v = x.var(dim=axis, keepdim=True, unbiased=False)
    return (x - m) / torch.sqrt(v + eps)
def _scatter_add(tgt, idx, src, axis=0):
    return tgt.clone().index_add_(axis, idx, src)
def _segment_sum(src, seg, n):
    out = torch.zeros((n,) + src.shape[1:], dtype=src.dtype)
    return out.index_add_(0, seg, src)
def _pad(x, pw):
    flat = tuple(v for pair in reversed(pw) for v in pair)
    return torch.nn.functional.pad(x, flat)

kernel_name = 'gated_mix__ssm_conv_s4d__geglu_ffn__prompt'

def setup_inputs():

    _w = (lambda a: (lambda t: t.to(torch.bfloat16) if t.is_floating_point() else t)(torch.as_tensor(a)))
    def _A_setup():
        Bsz, L, D, N = 1, 2048, 576, 128
        return {
            "u": _w((lambda *s: torch.randn(*s, dtype=torch.bfloat16) * 0.05)(Bsz, L, D)),
            "log_A_real": _w((lambda *s: torch.randn(*s, dtype=torch.bfloat16) * 6.4)(D, N) * 0.5),
            "A_imag": _w((lambda *s: torch.randn(*s, dtype=torch.bfloat16) * 0.05)(D, N) * 3.14),
            "C_real": _w((lambda *s: torch.randn(*s, dtype=torch.bfloat16) * 0.05)(D, N) / N ** 0.5),
            "C_imag": _w((lambda *s: torch.randn(*s, dtype=torch.bfloat16) * 0.05)(D, N) / N ** 0.5),
            "log_dt": _w((lambda *s: torch.randn(*s, dtype=torch.bfloat16) * 0.05)(D) * 0.5 - 4.0),
            "D_skip": _w((lambda *s: torch.randn(*s, dtype=torch.bfloat16) * 0.05)(D)),
        }
    _A_in = _A_setup()

    def _B_setup():
        B, S, D, F = 1, 2048, 576, 4608
        return {
            "x": _w((lambda *s: torch.randn(*s, dtype=torch.bfloat16) * 0.05)(B, S, D)),
            "w_gate": _w((lambda *s: torch.randn(*s, dtype=torch.bfloat16) * 0.05)(D, F)),
            "w_up": _w((lambda *s: torch.randn(*s, dtype=torch.bfloat16) * 0.05)(D, F)),
            "w_down": _w((lambda *s: torch.randn(*s, dtype=torch.bfloat16) * 0.05)(F, D)),
        }
    _B_in = _B_setup()

    return {
        "A_u": _A_in["u"],
        "A_log_A_real": _A_in["log_A_real"],
        "A_A_imag": _A_in["A_imag"],
        "A_C_real": _A_in["C_real"],
        "A_C_imag": _A_in["C_imag"],
        "A_log_dt": _A_in["log_dt"],
        "A_D_skip": _A_in["D_skip"],
        "B_x": _B_in["x"],
        "B_w_gate": _B_in["w_gate"],
        "B_w_up": _B_in["w_up"],
        "B_w_down": _B_in["w_down"],
        "gate_w": _w((lambda *s: torch.randn(*s, dtype=torch.bfloat16) * 0.05)(576) * 16.0),
    }

def reference(A_u, A_log_A_real, A_A_imag, A_C_real, A_C_imag, A_log_dt, A_D_skip, B_x, B_w_gate, B_w_up, B_w_down, gate_w):
    def _A_ref(u, log_A_real, A_imag, C_real, C_imag, log_dt, D_skip):
        L = u.shape[1]
        dt = torch.exp(log_dt)
        A = -torch.exp(log_A_real) + 1j * A_imag
        C = (C_real + 1j * C_imag) * dt[:, None]
        pos = (lambda x, dt: x.to(dt))(torch.arange(L), log_dt.dtype)
        P = torch.exp((A * dt[:, None])[:, :, None] * pos[None, None, :])
        K = 2.0 * torch.einsum("dn,dnl->dl", C, P).real
        L2 = 2 * L
        u_t = (lambda x, *d: x.permute(*d))(u, 0, 2, 1)
        Kf = (lambda x, *a, **k: torch.fft.rfft(x.float(), *a, **k))(K, L2)
        Uf = (lambda x, *a, **k: torch.fft.rfft(x.float(), *a, **k))(u_t, L2)
        y = (lambda x, *a, **k: torch.fft.irfft(x, *a, **k).to(torch.bfloat16))(Uf * Kf[None, :, :], L2)[:, :, :L]
        y = (lambda x, *d: x.permute(*d))(y, 0, 2, 1)
        return y + u * D_skip[None, None, :]

    def _B_ref(x, w_gate, w_up, w_down):
        return (_gelu(x @ w_gate) * (x @ w_up)) @ w_down

    x = A_u
    g = _sigmoid((x * gate_w).sum(-1, keepdims=True))
    a = _A_ref(x, A_log_A_real, A_A_imag, A_C_real, A_C_imag, A_log_dt, A_D_skip)
    b = _B_ref(x, B_w_gate, B_w_up, B_w_down)
    return g * a + (1 - g) * b
```

```asm
; @launch grid=(256,1,1) block=(256,1,1) lds=163840
.amdgcn_target "amdgcn-amd-amdhsa--gfx950"
.text
    .globl gated_mix__ssm_conv_s4d__geglu_ffn__prompt_kernel
    .p2align 8
    .type gated_mix__ssm_conv_s4d__geglu_ffn__prompt_kernel,@function
gated_mix__ssm_conv_s4d__geglu_ffn__prompt_kernel:
    s_cmp_ge_u32 s2, 256
    s_cbranch_scc1 gated_mix__ssm_conv_s4d__geglu_ffn__prompt_kernel_end
    s_load_dwordx2 s[8:9], s[0:1], 0
    s_load_dwordx4 s[64:67], s[0:1], 64
    s_load_dwordx2 s[4:5], s[0:1], 112
    s_load_dwordx2 s[6:7], s[0:1], 104
    s_load_dwordx8 s[68:75], s[0:1], 8
    s_load_dwordx2 s[76:77], s[0:1], 40
    s_getpc_b64 s[78:79]
kg_pc_1:
    s_add_u32 s78, s78, kmap_table-kg_pc_1
    s_addc_u32 s79, s79, 0
    v_and_b32 v182, 63, v0
    v_lshrrev_b32 v186, 6, v0
    s_nop 0
    v_readfirstlane_b32 s20, v186
    s_and_b32 s3, s2, 7
    s_lshr_b32 s50, s2, 3
    s_and_b32 s51, s3, 1
    s_lshl_b32 s51, s51, 3
    s_and_b32 s52, s50, 7
    s_add_u32 s21, s51, s52
    s_lshr_b32 s53, s50, 3
    s_lshr_b32 s54, s3, 1
    s_mul_i32 s57, s54, 18
    s_mul_i32 s55, s53, 5
    s_add_u32 s57, s57, s55
    s_cmp_eq_u32 s53, 3
    s_cselect_b32 s31, 2, 4
    s_and_b32 s22, s20, 1
    s_lshr_b32 s23, s20, 1
    s_lshl_b32 s59, s21, 2
    s_lshl_b32 s60, s23, 1
    s_add_u32 s59, s59, s60
    s_mul_i32 s60, s59, 288
    s_lshl_b32 s61, s22, 1
    s_add_u32 s60, s60, s61
    s_lshl_b32 s60, s60, 10
    s_lshl_b32 s61, s57, 12
    s_add_u32 s27, s60, s61
    s_add_u32 s28, s27, 294912
    s_lshl_b32 s25, s20, 12
    s_lshl_b32 s58, s21, 7
    s_lshl_b32 s59, s20, 5
    s_add_u32 s58, s58, s59
    s_mul_i32 s26, s58, 1152
    s_lshl_b32 s58, s53, 1
    s_add_u32 s58, s58, s52
    s_cmp_eq_u32 s54, 2
    s_cselect_b32 s59, 2, 0
    s_add_u32 s58, s58, s59
    s_cmp_ge_u32 s58, 9
    s_cselect_b32 s59, 9, 0
    s_sub_u32 s58, s58, s59
    s_mov_b32 s61, s58
    s_mul_i32 s60, s22, 294912
    s_mul_i32 s59, s58, 589824
    s_add_u32 s32, s59, s60
    s_lshl_b32 s59, s58, 7
    s_add_u32 s41, s59, s26
    s_add_u32 s58, s58, 1
    s_cmp_eq_u32 s58, 9
    s_cselect_b32 s58, 0, s58
    s_mul_i32 s59, s58, 589824
    s_add_u32 s33, s59, s60
    s_lshl_b32 s59, s58, 7
    s_add_u32 s42, s59, s26
    s_add_u32 s58, s58, 1
    s_cmp_eq_u32 s58, 9
    s_cselect_b32 s58, 0, s58
    s_mul_i32 s59, s58, 589824
    s_add_u32 s34, s59, s60
    s_lshl_b32 s59, s58, 7
    s_add_u32 s43, s59, s26
    s_add_u32 s58, s58, 1
    s_cmp_eq_u32 s58, 9
    s_cselect_b32 s58, 0, s58
    s_mul_i32 s59, s58, 589824
    s_add_u32 s35, s59, s60
    s_lshl_b32 s59, s58, 7
    s_add_u32 s44, s59, s26
    s_add_u32 s58, s58, 1
    s_cmp_eq_u32 s58, 9
    s_cselect_b32 s58, 0, s58
    s_mul_i32 s59, s58, 589824
    s_add_u32 s36, s59, s60
    s_lshl_b32 s59, s58, 7
    s_add_u32 s45, s59, s26
    s_add_u32 s58, s58, 1
    s_cmp_eq_u32 s58, 9
    s_cselect_b32 s58, 0, s58
    s_mul_i32 s59, s58, 589824
    s_add_u32 s37, s59, s60
    s_lshl_b32 s59, s58, 7
    s_add_u32 s46, s59, s26
    s_add_u32 s58, s58, 1
    s_cmp_eq_u32 s58, 9
    s_cselect_b32 s58, 0, s58
    s_mul_i32 s59, s58, 589824
    s_add_u32 s38, s59, s60
    s_lshl_b32 s59, s58, 7
    s_add_u32 s47, s59, s26
    s_add_u32 s58, s58, 1
    s_cmp_eq_u32 s58, 9
    s_cselect_b32 s58, 0, s58
    s_mul_i32 s59, s58, 589824
    s_add_u32 s39, s59, s60
    s_lshl_b32 s59, s58, 7
    s_add_u32 s48, s59, s26
    s_add_u32 s58, s58, 1
    s_cmp_eq_u32 s58, 9
    s_cselect_b32 s58, 0, s58
    s_mul_i32 s59, s58, 589824
    s_add_u32 s40, s59, s60
    s_lshl_b32 s59, s58, 7
    s_add_u32 s49, s59, s26
    s_cmp_lt_u32 s53, 3
    s_cselect_b32 s26, 1, 0
    s_lshl_b32 s62, s2, 1
    s_add_u32 s62, s62, s23
    s_lshl_b32 s63, s20, 14
    s_cmp_ge_u32 s20, 2
    s_cselect_b32 s59, 98304, 0
    s_add_u32 s63, s63, s59
    s_xor_b32 s55, s63, 16384
    s_movk_i32 s60, 9216
    v_lshrrev_b32 v190, 3, v182
    v_mul_lo_u32 v171, v190, s60
    v_lshrrev_b32 v191, 4, v182
    v_and_b32 v192, 1, v191
    v_lshlrev_b32 v192, 2, v192
    v_and_b32 v193, 7, v182
    v_xor_b32 v192, v192, v193
    v_lshlrev_b32 v192, 4, v192
    v_add_u32 v171, v171, v192
    v_add_u32 v172, 72704, v171
    v_add_u32 v173, 145408, v171
    v_add_u32 v174, 218112, v171
    v_mul_u32_u24 v194, 1152, v190
    v_xor_b32 v192, v193, v191
    v_lshlrev_b32 v192, 4, v192
    v_add_u32 v175, v194, v192
    v_xor_b32 v192, 64, v192
    v_add_u32 v176, v194, v192
    v_add_u32 v176, 8192, v176
    v_add_u32 v177, 16384, v175
    v_add_u32 v178, 16384, v176
    s_waitcnt lgkmcnt(0)
    s_mov_b32 s10, 2359296
    s_mov_b32 s11, 0x20000
    s_cmp_lt_u32 s20, 2
    s_cselect_b32 s12, s64, s66
    s_cselect_b32 s13, s65, s67
    s_lshl_b32 s58, s57, 7
    s_add_u32 s12, s12, s58
    s_addc_u32 s13, s13, 0
    s_sub_u32 s14, 5308416, s58
    s_mov_b32 s15, 0x20000
    s_getpc_b64 s[58:59]
cpf_2:
    s_sub_u32 s58, s58, cpf_2-gated_mix__ssm_conv_s4d__geglu_ffn__prompt_kernel
    s_subb_u32 s59, s59, 0
    s_lshr_b32 s60, s2, 3
    s_lshl_b32 s60, s60, 2
    s_add_u32 s60, s60, s20
    s_mul_i32 s60, s60, 5
    v_add_u32 v196, s60, v182
    v_lshlrev_b32 v196, 7, v196
    s_mov_b32 s60, kmap_table-gated_mix__ssm_conv_s4d__geglu_ffn__prompt_kernel+4096
    v_min_u32 v196, s60, v196
    s_mov_b64 exec, 31
    global_load_dword v197, v196, s[58:59]
    s_mov_b64 exec, -1
    s_lshl_b32 s84, s62, 8
    s_lshl_b32 s85, s22, 7
    s_add_u32 s84, s84, s85
    v_lshlrev_b32 v5, 1, v182
    s_mov_b32 s82, 147456
    s_mov_b32 s83, 0x20000
    s_mov_b32 s80, s68
    s_mov_b32 s81, s69
    buffer_load_ushort v0, v5, s[80:83], s84 offen
    s_mov_b32 s80, s70
    s_mov_b32 s81, s71
    buffer_load_ushort v1, v5, s[80:83], s84 offen
    s_mov_b32 s80, s72
    s_mov_b32 s81, s73
    buffer_load_ushort v2, v5, s[80:83], s84 offen
    s_mov_b32 s80, s74
    s_mov_b32 s81, s75
    buffer_load_ushort v3, v5, s[80:83], s84 offen
    s_mov_b32 s80, s76
    s_mov_b32 s81, s77
    s_mov_b32 s82, 1152
    s_lshl_b32 s85, s62, 1
    v_mov_b32 v7, 0
    buffer_load_ushort v4, v7, s[80:83], s85 offen
    s_lshl_b32 s64, s21, 2
    s_add_u32 s64, s64, s54
    s_lshl_b32 s64, s64, 2
    s_add_u32 s64, s64, s53
    s_lshl_b32 s64, s64, 2
    s_or_b32 s58, s2, s20
    s_cmp_eq_u32 s58, 0
    s_cbranch_scc0 gated_mix__ssm_conv_s4d__geglu_ffn__prompt_kernel_nononce
    s_memrealtime s[58:59]
    s_waitcnt lgkmcnt(0)
    s_lshl_b32 s58, s58, 1
    s_or_b32 s58, s58, 1
    s_mov_b32 s56, s6
    s_mov_b32 s57, s7
    s_mov_b32 s59, 0x20000
    v_mov_b32 v190, s58
    s_mov_b32 s58, 256
    v_mov_b32 v191, 0
    s_mov_b64 exec, 1
    buffer_store_dword v190, v191, s[56:59], 0 offen sc0 sc1
    s_mov_b64 exec, -1
gated_mix__ssm_conv_s4d__geglu_ffn__prompt_kernel_nononce:
    s_add_u32 m0, s25, 32768
    s_nop 0
    buffer_load_dwordx4 v175, s[8:11], s41 offen offset:0 lds
    buffer_load_dwordx4 v176, s[8:11], s41 offen offset:1024 lds
    buffer_load_dwordx4 v177, s[8:11], s41 offen offset:2048 lds
    buffer_load_dwordx4 v178, s[8:11], s41 offen offset:3072 lds
    s_add_u32 m0, s25, 49152
    s_nop 0
    buffer_load_dwordx4 v171, s[12:15], s32 offen offset:0 lds
    buffer_load_dwordx4 v172, s[12:15], s32 offen offset:1024 lds
    buffer_load_dwordx4 v173, s[12:15], s32 offen offset:2048 lds
    buffer_load_dwordx4 v174, s[12:15], s32 offen offset:3072 lds
    v_lshlrev_b32 v11, 2, v182
    v_add_u32 v11, s63, v11
    v_and_b32 v13, 31, v182
    v_mul_u32_u24 v13, 272, v13
    v_lshrrev_b32 v14, 5, v182
    v_lshlrev_b32 v14, 4, v14
    v_add_u32 v13, v13, v14
    v_add_u32 v13, s63, v13
    s_waitcnt vmcnt(8)
    s_add_u32 m0, s25, 65536
    s_nop 0
    buffer_load_dwordx4 v175, s[8:11], s42 offen offset:0 lds
    buffer_load_dwordx4 v176, s[8:11], s42 offen offset:1024 lds
    buffer_load_dwordx4 v177, s[8:11], s42 offen offset:2048 lds
    buffer_load_dwordx4 v178, s[8:11], s42 offen offset:3072 lds
    s_add_u32 m0, s25, 81920
    s_nop 0
    buffer_load_dwordx4 v171, s[12:15], s33 offen offset:0 lds
    buffer_load_dwordx4 v172, s[12:15], s33 offen offset:1024 lds
    buffer_load_dwordx4 v173, s[12:15], s33 offen offset:2048 lds
    buffer_load_dwordx4 v174, s[12:15], s33 offen offset:3072 lds
    v_lshlrev_b32 v4, 16, v4
    v_lshlrev_b32 v15, 16, v0
    v_mul_f32 v10, 0x3fb8aa3b, v4
    v_mul_f32 v15, 0x3fb8aa3b, v15
    v_exp_f32 v10, v10
    v_exp_f32 v15, v15
    v_lshlrev_b32 v16, 16, v1
    v_cvt_pk_bf16_f32 v10, v10, v15
    v_and_b32 v15, 0xffff0000, v10
    v_lshlrev_b32 v10, 16, v10
    v_mul_f32 v16, v16, v10
    v_mul_f32 v15, v15, v10
    v_mul_f32 v16, 0x3e22f983, v16
    v_mul_f32 v15, 0xbfb8aa3b, v15
    v_lshlrev_b32 v30, 16, v2
    v_lshlrev_b32 v31, 16, v3
    v_add_f32 v58, v10, v10
    v_mul_f32 v30, v30, v58
    v_mul_f32 v31, v31, v58
    v_mul_f32 v32, 1.0, v15
    v_mul_f32 v38, 0x41000000, v15
    v_mul_f32 v44, 0x43800000, v15
    v_mul_f32 v33, 1.0, v16
    v_mul_f32 v39, 0x41000000, v16
    v_mul_f32 v45, 0x43800000, v16
    v_exp_f32 v32, v32
    v_exp_f32 v38, v38
    v_exp_f32 v44, v44
    v_fract_f32 v33, v33
    v_fract_f32 v39, v39
    v_fract_f32 v45, v45
    v_cos_f32 v18, v33
    v_cos_f32 v24, v39
    v_cos_f32 v26, v45
    v_sin_f32 v19, v33
    v_sin_f32 v25, v39
    v_sin_f32 v27, v45
    v_mul_f32 v18, v18, v32
    v_mul_f32 v24, v24, v38
    v_mul_f32 v26, v26, v44
    v_mul_f32 v19, v19, v32
    v_mul_f32 v25, v25, v38
    v_mul_f32 v27, v27, v44
    v_mul_f32 v40, v18, v18
    v_mul_f32 v46, v24, v24
    v_mul_f32 v41, v18, v19
    v_mul_f32 v47, v24, v25
    v_fma_f32 v20, -v19, v19, v40
    v_fma_f32 v28, -v25, v25, v46
    v_fma_f32 v21, v19, v18, v41
    v_fma_f32 v29, v25, v24, v47
    v_mul_f32 v40, v20, v20
    v_mul_f32 v41, v20, v21
    v_fma_f32 v22, -v21, v21, v40
    v_fma_f32 v23, v21, v20, v41
    v_cvt_pk_bf16_f32 v36, v30, -v31
    v_mul_f32 v40, v30, v26
    v_mov_b32 v44, 1.0
    v_cvt_pk_bf16_f32 v54, v24, v25
    ds_write_b32 v11, v36 offset:0
    v_mul_f32 v41, v30, v27
    v_mov_b32 v45, 0
    ds_write_b32 v11, v54 offset:6032
    v_mul_f32 v34, v30, v18
    v_fma_f32 v56, -v31, v27, v40
    v_cvt_pk_bf16_f32 v48, v44, v45
    v_mul_f32 v52, v24, v28
    v_mul_f32 v35, v30, v19
    v_fma_f32 v57, v31, v26, v41
    ds_write_b32 v11, v48 offset:5760
    v_mul_f32 v53, v24, v29
    v_fma_f32 v32, -v31, v19, v34
    v_cvt_pk_bf16_f32 v42, v56, -v57
    v_cvt_pk_bf16_f32 v48, v28, v29
    v_fma_f32 v50, -v25, v29, v52
    v_fma_f32 v33, v31, v18, v35
    ds_write_b32 v11, v42 offset:2176
    ds_write_b32 v11, v48 offset:6304
    v_fma_f32 v51, v25, v28, v53
    v_cvt_pk_bf16_f32 v36, v32, -v33
    v_mul_f32 v40, v56, v20
    v_mul_f32 v46, v28, v28
    v_cvt_pk_bf16_f32 v54, v50, v51
    ds_write_b32 v11, v36 offset:272
    v_mul_f32 v41, v56, v21
    v_mul_f32 v47, v28, v29
    ds_write_b32 v11, v54 offset:6576
    v_mul_f32 v34, v32, v18
    v_fma_f32 v38, -v57, v21, v40
    v_fma_f32 v44, -v29, v29, v46
    v_mul_f32 v52, v50, v28
    v_mul_f32 v35, v32, v19
    v_fma_f32 v39, v57, v20, v41
    v_fma_f32 v45, v29, v28, v47
    v_mul_f32 v53, v50, v29
    v_fma_f32 v32, -v33, v19, v34
    v_cvt_pk_bf16_f32 v42, v38, -v39
    v_cvt_pk_bf16_f32 v48, v44, v45
    v_fma_f32 v50, -v51, v29, v52
    v_fma_f32 v33, v33, v18, v35
    ds_write_b32 v11, v42 offset:2448
    ds_write_b32 v11, v48 offset:6848
    v_fma_f32 v51, v51, v28, v53
    v_cvt_pk_bf16_f32 v36, v32, -v33
    v_mul_f32 v40, v38, v20
    v_mul_f32 v46, v44, v28
    v_cvt_pk_bf16_f32 v54, v50, v51
    ds_write_b32 v11, v36 offset:544
    v_mul_f32 v41, v38, v21
    v_mul_f32 v47, v44, v29
    ds_write_b32 v11, v54 offset:7120
    v_mul_f32 v34, v32, v18
    v_fma_f32 v38, -v39, v21, v40
    v_fma_f32 v44, -v45, v29, v46
    v_mul_f32 v52, v50, v28
    v_mul_f32 v35, v32, v19
    v_fma_f32 v39, v39, v20, v41
    v_fma_f32 v45, v45, v28, v47
    v_mul_f32 v53, v50, v29
    v_fma_f32 v32, -v33, v19, v34
    v_cvt_pk_bf16_f32 v42, v38, -v39
    v_cvt_pk_bf16_f32 v48, v44, v45
    v_fma_f32 v50, -v51, v29, v52
    v_fma_f32 v33, v33, v18, v35
    ds_write_b32 v11, v42 offset:2720
    ds_write_b32 v11, v48 offset:7392
    v_fma_f32 v51, v51, v28, v53
    v_cvt_pk_bf16_f32 v36, v32, -v33
    v_mul_f32 v40, v38, v20
    v_mul_f32 v46, v44, v28
    v_cvt_pk_bf16_f32 v54, v50, v51
    s_lshl_b32 s85, s22, 11
    v_lshlrev_b32 v6, 4, v182
    v_add_u32 v6, s85, v6
    global_load_dwordx4 v[72:75], v6, s[78:79]
    ds_write_b32 v11, v36 offset:816
    v_mul_f32 v41, v38, v21
    v_mul_f32 v47, v44, v29
    ds_write_b32 v11, v54 offset:7664
    v_mul_f32 v34, v32, v18
    v_fma_f32 v38, -v39, v21, v40
    v_fma_f32 v44, -v45, v29, v46
    v_mul_f32 v52, v50, v28
    v_mul_f32 v35, v32, v19
    v_fma_f32 v39, v39, v20, v41
    v_fma_f32 v45, v45, v28, v47
    v_mul_f32 v53, v50, v29
    v_fma_f32 v32, -v33, v19, v34
    v_cvt_pk_bf16_f32 v42, v38, -v39
    v_cvt_pk_bf16_f32 v48, v44, v45
    v_fma_f32 v50, -v51, v29, v52
    v_fma_f32 v33, v33, v18, v35
    ds_write_b32 v11, v42 offset:2992
    ds_write_b32 v11, v48 offset:7936
    v_fma_f32 v51, v51, v28, v53
    v_cvt_pk_bf16_f32 v36, v32, -v33
    v_mul_f32 v40, v56, v26
    v_mul_f32 v46, v44, v28
    v_cvt_pk_bf16_f32 v54, v50, v51
    ds_write_b32 v11, v36 offset:1088
    v_mul_f32 v41, v56, v27
    v_mul_f32 v47, v44, v29
    ds_write_b32 v11, v54 offset:8208
    v_mul_f32 v34, v32, v18
    v_fma_f32 v56, -v57, v27, v40
    v_fma_f32 v44, -v45, v29, v46
    v_mul_f32 v52, v50, v28
    v_mul_f32 v35, v32, v19
    v_fma_f32 v57, v57, v26, v41
    v_fma_f32 v45, v45, v28, v47
    v_mul_f32 v53, v50, v29
    v_fma_f32 v32, -v33, v19, v34
    v_cvt_pk_bf16_f32 v42, v56, -v57
    v_cvt_pk_bf16_f32 v48, v44, v45
    v_fma_f32 v50, -v51, v29, v52
    v_fma_f32 v33, v33, v18, v35
    ds_write_b32 v11, v42 offset:3264
    ds_write_b32 v11, v48 offset:8480
    v_fma_f32 v51, v51, v28, v53
    v_cvt_pk_bf16_f32 v36, v32, -v33
    v_mul_f32 v40, v56, v22
    v_mul_f32 v46, v44, v28
    v_cvt_pk_bf16_f32 v54, v50, v51
    ds_write_b32 v11, v36 offset:1360
    v_mul_f32 v41, v56, v23
    v_mul_f32 v47, v44, v29
    ds_write_b32 v11, v54 offset:8752
    v_mul_f32 v34, v32, v18
    v_fma_f32 v38, -v57, v23, v40
    v_fma_f32 v44, -v45, v29, v46
    v_mul_f32 v52, v50, v28
    v_mul_f32 v35, v32, v19
    v_fma_f32 v39, v57, v22, v41
    v_fma_f32 v45, v45, v28, v47
    v_mul_f32 v53, v50, v29
    v_fma_f32 v32, -v33, v19, v34
    v_cvt_pk_bf16_f32 v42, v38, -v39
    v_cvt_pk_bf16_f32 v48, v44, v45
    v_fma_f32 v50, -v51, v29, v52
    v_fma_f32 v33, v33, v18, v35
    ds_write_b32 v11, v42 offset:3536
    ds_write_b32 v11, v48 offset:9024
    v_fma_f32 v51, v51, v28, v53
    v_cvt_pk_bf16_f32 v36, v32, -v33
    v_mul_f32 v40, v56, v26
    v_mul_f32 v46, v44, v28
    v_cvt_pk_bf16_f32 v54, v50, v51
    ds_write_b32 v11, v36 offset:1632
    v_mul_f32 v41, v56, v27
    v_mul_f32 v47, v44, v29
    ds_write_b32 v11, v54 offset:9296
    global_load_dwordx4 v[76:79], v6, s[78:79] offset:1024
    v_mul_f32 v34, v32, v18
    v_fma_f32 v56, -v57, v27, v40
    v_fma_f32 v44, -v45, v29, v46
    v_mul_f32 v52, v50, v28
    v_mul_f32 v35, v32, v19
    v_fma_f32 v57, v57, v26, v41
    v_fma_f32 v45, v45, v28, v47
    v_mul_f32 v53, v50, v29
    v_fma_f32 v32, -v33, v19, v34
    v_cvt_pk_bf16_f32 v42, v56, -v57
    v_cvt_pk_bf16_f32 v48, v44, v45
    v_fma_f32 v50, -v51, v29, v52
    v_fma_f32 v33, v33, v18, v35
    ds_write_b32 v11, v42 offset:3808
    ds_write_b32 v11, v48 offset:9568
    v_fma_f32 v51, v51, v28, v53
    v_cvt_pk_bf16_f32 v36, v32, -v33
    v_mul_f32 v40, v56, v22
    v_mul_f32 v46, v44, v28
    v_cvt_pk_bf16_f32 v54, v50, v51
    ds_write_b32 v11, v36 offset:1904
    v_mul_f32 v41, v56, v23
    v_mul_f32 v47, v44, v29
    ds_write_b32 v11, v54 offset:9840
    v_fma_f32 v38, -v57, v23, v40
    v_fma_f32 v44, -v45, v29, v46
    v_mul_f32 v52, v50, v28
    v_fma_f32 v39, v57, v22, v41
    v_fma_f32 v45, v45, v28, v47
    v_mul_f32 v53, v50, v29
    v_cvt_pk_bf16_f32 v42, v38, -v39
    v_cvt_pk_bf16_f32 v48, v44, v45
    v_fma_f32 v50, -v51, v29, v52
    ds_write_b32 v11, v42 offset:4080
    ds_write_b32 v11, v48 offset:10112
    v_fma_f32 v51, v51, v28, v53
    v_mul_f32 v40, v56, v26
    v_mul_f32 v46, v44, v28
    v_cvt_pk_bf16_f32 v54, v50, v51
    v_mul_f32 v41, v56, v27
    v_mul_f32 v47, v44, v29
    ds_write_b32 v11, v54 offset:10384
    v_fma_f32 v56, -v57, v27, v40
    v_fma_f32 v44, -v45, v29, v46
    v_mul_f32 v52, v50, v28
    v_fma_f32 v57, v57, v26, v41
    v_fma_f32 v45, v45, v28, v47
    v_mul_f32 v53, v50, v29
    v_cvt_pk_bf16_f32 v42, v56, -v57
    v_cvt_pk_bf16_f32 v48, v44, v45
    v_fma_f32 v50, -v51, v29, v52
    ds_write_b32 v11, v42 offset:4352
    ds_write_b32 v11, v48 offset:10656
    v_fma_f32 v51, v51, v28, v53
    v_mul_f32 v40, v56, v26
    v_mul_f32 v46, v44, v28
    v_cvt_pk_bf16_f32 v54, v50, v51
    v_mul_f32 v41, v56, v27
    v_mul_f32 v47, v44, v29
    ds_write_b32 v11, v54 offset:10928
    v_fma_f32 v56, -v57, v27, v40
    v_fma_f32 v44, -v45, v29, v46
    v_mul_f32 v52, v50, v28
    v_fma_f32 v57, v57, v26, v41
    v_fma_f32 v45, v45, v28, v47
    v_mul_f32 v53, v50, v29
    v_cvt_pk_bf16_f32 v42, v56, -v57
    v_cvt_pk_bf16_f32 v48, v44, v45
    v_fma_f32 v50, -v51, v29, v52
    ds_write_b32 v11, v42 offset:4624
    ds_write_b32 v11, v48 offset:11200
    v_fma_f32 v51, v51, v28, v53
    v_mul_f32 v40, v56, v26
    v_mul_f32 v46, v44, v28
    v_cvt_pk_bf16_f32 v54, v50, v51
    v_mul_f32 v41, v56, v27
    v_and_b32 v8, 3, v182
    v_lshlrev_b32 v8, 4, v8
    v_add_u32 v8, 4096, v8
    global_load_dwordx4 v[80:83], v8, s[78:79]
    v_mul_f32 v47, v44, v29
    ds_write_b32 v11, v54 offset:11472
    v_fma_f32 v56, -v57, v27, v40
    v_fma_f32 v44, -v45, v29, v46
    v_mul_f32 v52, v50, v28
    v_fma_f32 v57, v57, v26, v41
    v_fma_f32 v45, v45, v28, v47
    v_mul_f32 v53, v50, v29
    v_cvt_pk_bf16_f32 v42, v56, -v57
    v_cvt_pk_bf16_f32 v48, v44, v45
    v_fma_f32 v50, -v51, v29, v52
    ds_write_b32 v11, v42 offset:4896
    ds_write_b32 v11, v48 offset:11744
    v_fma_f32 v51, v51, v28, v53
    v_mul_f32 v40, v56, v26
    v_mul_f32 v46, v44, v28
    v_cvt_pk_bf16_f32 v54, v50, v51
    v_mul_f32 v41, v56, v27
    v_mul_f32 v47, v44, v29
    ds_write_b32 v11, v54 offset:12016
    v_fma_f32 v56, -v57, v27, v40
    v_fma_f32 v44, -v45, v29, v46
    v_mul_f32 v52, v50, v28
    v_fma_f32 v57, v57, v26, v41
    v_fma_f32 v45, v45, v28, v47
    v_mul_f32 v53, v50, v29
    v_cvt_pk_bf16_f32 v42, v56, -v57
    v_cvt_pk_bf16_f32 v48, v44, v45
    v_fma_f32 v50, -v51, v29, v52
    ds_write_b32 v11, v42 offset:5168
    ds_write_b32 v11, v48 offset:12288
    v_fma_f32 v51, v51, v28, v53
    v_mul_f32 v40, v56, v26
    v_mul_f32 v46, v44, v28
    v_cvt_pk_bf16_f32 v54, v50, v51
    v_mul_f32 v41, v56, v27
    v_mul_f32 v47, v44, v29
    ds_write_b32 v11, v54 offset:12560
    v_fma_f32 v56, -v57, v27, v40
    v_fma_f32 v44, -v45, v29, v46
    v_mul_f32 v52, v50, v28
    v_fma_f32 v57, v57, v26, v41
    v_fma_f32 v45, v45, v28, v47
    v_mul_f32 v53, v50, v29
    v_cvt_pk_bf16_f32 v42, v56, -v57
    v_cvt_pk_bf16_f32 v48, v44, v45
    v_fma_f32 v50, -v51, v29, v52
    ds_write_b32 v11, v42 offset:5440
    ds_write_b32 v11, v48 offset:12832
    v_fma_f32 v51, v51, v28, v53
    v_mul_f32 v46, v44, v28
    v_cvt_pk_bf16_f32 v54, v50, v51
    v_mul_f32 v47, v44, v29
    ds_write_b32 v11, v54 offset:13104
    v_fma_f32 v44, -v45, v29, v46
    v_mul_f32 v52, v50, v28
    v_fma_f32 v45, v45, v28, v47
    v_mul_f32 v53, v50, v29
    v_cvt_pk_bf16_f32 v48, v44, v45
    v_fma_f32 v50, -v51, v29, v52
    ds_write_b32 v11, v48 offset:13376
    v_fma_f32 v51, v51, v28, v53
    v_mul_f32 v46, v44, v28
    v_cvt_pk_bf16_f32 v54, v50, v51
    v_mul_f32 v47, v44, v29
    ds_write_b32 v11, v54 offset:13648
    v_fma_f32 v44, -v45, v29, v46
    v_mul_f32 v52, v50, v28
    v_fma_f32 v45, v45, v28, v47
    v_mul_f32 v53, v50, v29
    v_cvt_pk_bf16_f32 v48, v44, v45
    v_fma_f32 v50, -v51, v29, v52
    ds_write_b32 v11, v48 offset:13920
    v_fma_f32 v51, v51, v28, v53
    v_cvt_pk_bf16_f32 v54, v50, v51
    ds_write_b32 v11, v54 offset:14192
    s_add_u32 m0, s25, 98304
    s_nop 0
    buffer_load_dwordx4 v175, s[8:11], s43 offen offset:0 lds
    buffer_load_dwordx4 v176, s[8:11], s43 offen offset:1024 lds
    buffer_load_dwordx4 v177, s[8:11], s43 offen offset:2048 lds
    buffer_load_dwordx4 v178, s[8:11], s43 offen offset:3072 lds
    s_add_u32 m0, s25, 114688
    s_nop 0
    buffer_load_dwordx4 v171, s[12:15], s34 offen offset:0 lds
    buffer_load_dwordx4 v172, s[12:15], s34 offen offset:1024 lds
    buffer_load_dwordx4 v173, s[12:15], s34 offen offset:2048 lds
    buffer_load_dwordx4 v174, s[12:15], s34 offen offset:3072 lds
    s_waitcnt lgkmcnt(0)
    ds_read_b128 v[112:115], v13 offset:0
    ds_read_b128 v[116:119], v13 offset:5760
    ds_read_b128 v[120:123], v13 offset:32
    ds_read_b128 v[124:127], v13 offset:5792
    ds_read_b128 v[128:131], v13 offset:64
    ds_read_b128 v[132:135], v13 offset:5824
    ds_read_b128 v[136:139], v13 offset:96
    ds_read_b128 v[140:143], v13 offset:5856
    s_waitcnt lgkmcnt(6)
    v_mfma_f32_32x32x16_bf16 v[96:111], v[112:115], v[116:119], 0
    s_nop 3
    ds_read_b128 v[112:115], v13 offset:128
    ds_read_b128 v[116:119], v13 offset:5888
    s_waitcnt lgkmcnt(6)
    v_mfma_f32_32x32x16_bf16 v[96:111], v[120:123], v[124:127], v[96:111]
    s_nop 3
    ds_read_b128 v[120:123], v13 offset:160
    ds_read_b128 v[124:127], v13 offset:5920
    s_waitcnt lgkmcnt(6)
    v_mfma_f32_32x32x16_bf16 v[96:111], v[128:131], v[132:135], v[96:111]
    s_nop 3
    ds_read_b128 v[128:131], v13 offset:192
    ds_read_b128 v[132:135], v13 offset:5952
    s_waitcnt lgkmcnt(6)
    v_mfma_f32_32x32x16_bf16 v[96:111], v[136:139], v[140:143], v[96:111]
    s_nop 3
    ds_read_b128 v[136:139], v13 offset:224
    ds_read_b128 v[140:143], v13 offset:5984
    s_waitcnt lgkmcnt(6)
    v_mfma_f32_32x32x16_bf16 v[96:111], v[112:115], v[116:119], v[96:111]
    s_waitcnt lgkmcnt(4)
    v_mfma_f32_32x32x16_bf16 v[96:111], v[120:123], v[124:127], v[96:111]
    s_waitcnt lgkmcnt(2)
    v_mfma_f32_32x32x16_bf16 v[96:111], v[128:131], v[132:135], v[96:111]
    s_waitcnt lgkmcnt(0)
    v_mfma_f32_32x32x16_bf16 v[96:111], v[136:139], v[140:143], v[96:111]
    v_lshlrev_b32 v60, 4, v182
    v_add_u32 v61, s55, v60
    v_add_u32 v60, s63, v60
    s_nop 7
    s_nop 3
    ds_write_b128 v60, v[96:99] offset:0
    ds_write_b128 v60, v[100:103] offset:1024
    ds_write_b128 v60, v[104:107] offset:2048
    s_waitcnt lgkmcnt(0)
    s_barrier
    ds_read_b128 v[112:115], v61 offset:0
    ds_read_b128 v[116:119], v61 offset:1024
    ds_read_b128 v[120:123], v61 offset:2048
    v_and_b32 v60, 31, v182
    v_lshlrev_b32 v60, 1, v60
    v_lshrrev_b32 v61, 5, v182
    v_lshlrev_b32 v61, 8, v61
    v_add_u32 v60, v60, v61
    v_add_u32 v60, s63, v60
    v_mov_b32 v58, s63
    s_add_u32 s80, s4, 37748736
    s_addc_u32 s81, s5, 0
    s_mov_b32 s82, 2396160
    s_mov_b32 s83, 0x20000
    s_mul_i32 s84, s62, 4160
    s_waitcnt lgkmcnt(0)
    v_add_f32 v96, v96, v112
    v_add_f32 v97, v97, v113
    v_add_f32 v98, v98, v114
    v_add_f32 v99, v99, v115
    v_add_f32 v100, v100, v116
    v_add_f32 v101, v101, v117
    v_add_f32 v102, v102, v118
    v_add_f32 v103, v103, v119
    v_add_f32 v104, v104, v120
    v_add_f32 v105, v105, v121
    v_add_f32 v106, v106, v122
    v_add_f32 v107, v107, v123
    v_cvt_pk_bf16_f32 v32, v96, v97
    ds_write_b16 v60, v32 offset:14464
    ds_write_b16_d16_hi v60, v32 offset:14528
    v_cvt_pk_bf16_f32 v38, v98, v99
    ds_write_b16 v60, v38 offset:14592
    ds_write_b16_d16_hi v60, v38 offset:14656
    v_cvt_pk_bf16_f32 v44, v100, v101
    ds_write_b16 v60, v44 offset:14976
    ds_write_b16_d16_hi v60, v44 offset:15040
    v_cvt_pk_bf16_f32 v50, v102, v103
    ds_write_b16 v60, v50 offset:15104
    ds_write_b16_d16_hi v60, v50 offset:15168
    v_cvt_pk_bf16_f32 v32, v104, v105
    ds_write_b16 v60, v32 offset:15488
    ds_write_b16_d16_hi v60, v32 offset:15552
    v_cvt_pk_bf16_f32 v38, v106, v107
    ds_write_b16 v60, v38 offset:15616
    ds_write_b16_d16_hi v60, v38 offset:15680
    v_mov_b32 v59, 0
    ds_write_b16 v58, v59 offset:15808
    s_waitcnt vmcnt(8) lgkmcnt(0)
    v_add_u32_sdwa v32, v58, v72 dst_sel:DWORD dst_unused:UNUSED_PAD src0_sel:DWORD src1_sel:WORD_0
    v_add_u32_sdwa v33, v58, v72 dst_sel:DWORD dst_unused:UNUSED_PAD src0_sel:DWORD src1_sel:WORD_1
    v_add_u32_sdwa v34, v58, v73 dst_sel:DWORD dst_unused:UNUSED_PAD src0_sel:DWORD src1_sel:WORD_0
    v_add_u32_sdwa v35, v58, v73 dst_sel:DWORD dst_unused:UNUSED_PAD src0_sel:DWORD src1_sel:WORD_1
    v_add_u32_sdwa v36, v58, v74 dst_sel:DWORD dst_unused:UNUSED_PAD src0_sel:DWORD src1_sel:WORD_0
    v_add_u32_sdwa v37, v58, v74 dst_sel:DWORD dst_unused:UNUSED_PAD src0_sel:DWORD src1_sel:WORD_1
    v_add_u32_sdwa v38, v58, v75 dst_sel:DWORD dst_unused:UNUSED_PAD src0_sel:DWORD src1_sel:WORD_0
    v_add_u32_sdwa v39, v58, v75 dst_sel:DWORD dst_unused:UNUSED_PAD src0_sel:DWORD src1_sel:WORD_1
    v_add_u32_sdwa v40, v58, v76 dst_sel:DWORD dst_unused:UNUSED_PAD src0_sel:DWORD src1_sel:WORD_0
    v_add_u32_sdwa v41, v58, v76 dst_sel:DWORD dst_unused:UNUSED_PAD src0_sel:DWORD src1_sel:WORD_1
    v_add_u32_sdwa v42, v58, v77 dst_sel:DWORD dst_unused:UNUSED_PAD src0_sel:DWORD src1_sel:WORD_0
    v_add_u32_sdwa v43, v58, v77 dst_sel:DWORD dst_unused:UNUSED_PAD src0_sel:DWORD src1_sel:WORD_1
    v_add_u32_sdwa v44, v58, v78 dst_sel:DWORD dst_unused:UNUSED_PAD src0_sel:DWORD src1_sel:WORD_0
    v_add_u32_sdwa v45, v58, v78 dst_sel:DWORD dst_unused:UNUSED_PAD src0_sel:DWORD src1_sel:WORD_1
    v_add_u32_sdwa v46, v58, v79 dst_sel:DWORD dst_unused:UNUSED_PAD src0_sel:DWORD src1_sel:WORD_0
    v_add_u32_sdwa v47, v58, v79 dst_sel:DWORD dst_unused:UNUSED_PAD src0_sel:DWORD src1_sel:WORD_1
    v_add_u32_sdwa v48, v58, v80 dst_sel:DWORD dst_unused:UNUSED_PAD src0_sel:DWORD src1_sel:WORD_0
    v_add_u32_sdwa v49, v58, v80 dst_sel:DWORD dst_unused:UNUSED_PAD src0_sel:DWORD src1_sel:WORD_1
    v_add_u32_sdwa v50, v58, v81 dst_sel:DWORD dst_unused:UNUSED_PAD src0_sel:DWORD src1_sel:WORD_0
    v_add_u32_sdwa v51, v58, v81 dst_sel:DWORD dst_unused:UNUSED_PAD src0_sel:DWORD src1_sel:WORD_1
    v_add_u32_sdwa v52, v58, v82 dst_sel:DWORD dst_unused:UNUSED_PAD src0_sel:DWORD src1_sel:WORD_0
    v_add_u32_sdwa v53, v58, v82 dst_sel:DWORD dst_unused:UNUSED_PAD src0_sel:DWORD src1_sel:WORD_1
    v_add_u32_sdwa v54, v58, v83 dst_sel:DWORD dst_unused:UNUSED_PAD src0_sel:DWORD src1_sel:WORD_0
    v_add_u32_sdwa v55, v58, v83 dst_sel:DWORD dst_unused:UNUSED_PAD src0_sel:DWORD src1_sel:WORD_1
    ds_read_u16 v32, v32 offset:14464
    ds_read_u16_d16_hi v33, v33 offset:14464
    ds_read_u16 v34, v34 offset:14464
    ds_read_u16_d16_hi v35, v35 offset:14464
    ds_read_u16 v36, v36 offset:14464
    ds_read_u16_d16_hi v37, v37 offset:14464
    ds_read_u16 v38, v38 offset:14464
    ds_read_u16_d16_hi v39, v39 offset:14464
    ds_read_u16 v40, v40 offset:14464
    ds_read_u16_d16_hi v41, v41 offset:14464
    ds_read_u16 v42, v42 offset:14464
    ds_read_u16_d16_hi v43, v43 offset:14464
    ds_read_u16 v44, v44 offset:14464
    ds_read_u16_d16_hi v45, v45 offset:14464
    s_waitcnt lgkmcnt(8)
    ds_read_u16 v46, v46 offset:14464
    ds_read_u16_d16_hi v47, v47 offset:14464
    s_waitcnt lgkmcnt(7)
    ds_read_u16 v48, v48 offset:14464
    ds_read_u16_d16_hi v49, v49 offset:14464
    ds_read_u16 v50, v50 offset:14464
    ds_read_u16_d16_hi v51, v51 offset:14464
    ds_read_u16 v52, v52 offset:14464
    ds_read_u16_d16_hi v53, v53 offset:14464
    ds_read_u16 v54, v54 offset:14464
    ds_read_u16_d16_hi v55, v55 offset:14464
    s_waitcnt lgkmcnt(0)
    v_and_b32 v33, 0xffff0000, v33
    v_or_b32 v84, v32, v33
    v_and_b32 v35, 0xffff0000, v35
    v_or_b32 v85, v34, v35
    v_and_b32 v37, 0xffff0000, v37
    v_or_b32 v86, v36, v37
    v_and_b32 v39, 0xffff0000, v39
    v_or_b32 v87, v38, v39
    v_and_b32 v41, 0xffff0000, v41
    v_or_b32 v88, v40, v41
    v_and_b32 v43, 0xffff0000, v43
    v_or_b32 v89, v42, v43
    v_and_b32 v45, 0xffff0000, v45
    v_or_b32 v90, v44, v45
    v_and_b32 v47, 0xffff0000, v47
    v_or_b32 v91, v46, v47
    v_and_b32 v49, 0xffff0000, v49
    v_or_b32 v92, v48, v49
    v_and_b32 v51, 0xffff0000, v51
    v_or_b32 v93, v50, v51
    v_and_b32 v53, 0xffff0000, v53
    v_or_b32 v94, v52, v53
    v_and_b32 v55, 0xffff0000, v55
    v_or_b32 v95, v54, v55
    buffer_store_dwordx4 v[84:87], v6, s[80:83], s84 offen offset:0 sc1
    buffer_store_dwordx4 v[88:91], v6, s[80:83], s84 offen offset:1024 sc1
    v_lshlrev_b32 v60, 4, v182
    v_cmp_gt_u32 vcc, 4, v182
    s_and_saveexec_b64 s[86:87], vcc
    s_add_u32 s84, s84, 4096
    buffer_store_dwordx4 v[92:95], v60, s[80:83], s84 offen sc1
    s_mov_b64 exec, s[86:87]
    s_mov_b32 s56, s6
    s_mov_b32 s57, s7
    s_mov_b32 s58, 256
    s_mov_b32 s59, 0x20000
    v_mov_b32 v185, 0
    buffer_load_dword v184, v185, s[56:59], 0 offen sc0 sc1
    s_mov_b32 s16, s4
    s_mov_b32 s17, s5
    s_mov_b32 s18, 18874368
    s_mov_b32 s19, 0x20000
    v_lshlrev_b32 v179, 4, v182
    v_mov_b32 v180, 0xbdd2d3e8
    v_mov_b32 v181, 0xc0135761
    v_lshrrev_b32 v186, 5, v182
    v_lshlrev_b32 v186, 3, v186
    v_bfe_u32 v188, v182, 2, 2
    v_add_u32 v186, v186, v188
    v_lshlrev_b32 v186, 7, v186
    v_bfe_u32 v189, v182, 4, 1
    v_lshlrev_b32 v189, 1, v189
    v_bfe_u32 v190, v182, 1, 1
    v_add_u32 v189, v189, v190
    s_lshl_b32 s58, s22, 2
    v_add_u32 v189, s58, v189
    v_lshrrev_b32 v188, 1, v188
    v_lshlrev_b32 v188, 2, v188
    v_xor_b32 v189, v189, v188
    v_lshlrev_b32 v189, 4, v189
    v_add_u32 v186, v186, v189
    v_and_b32 v190, 1, v182
    v_lshlrev_b32 v190, 3, v190
    v_add_u32 v168, v186, v190
    v_add_u32 v169, 0x10000, v168
    v_add_u32 v170, 0x20000, v168
    v_mov_b32 v183, v168
    v_and_b32 v186, 31, v182
    v_bfe_u32 v187, v182, 1, 3
    v_lshrrev_b32 v188, 5, v182
    v_xor_b32 v187, v187, v188
    v_lshlrev_b32 v187, 4, v187
    s_lshl_b32 s58, s23, 6
    v_add_u32 v186, s58, v186
    v_lshlrev_b32 v186, 7, v186
    v_add_u32 v186, v186, v187
    v_xor_b32 v64, 0, v186
    v_add_u32 v68, 0x10000, v64
    v_add_u32 v72, 0x20000, v64
    v_xor_b32 v65, 32, v186
    v_add_u32 v69, 0x10000, v65
    v_add_u32 v73, 0x20000, v65
    v_xor_b32 v66, 64, v186
    v_add_u32 v70, 0x10000, v66
    v_add_u32 v74, 0x20000, v66
    v_xor_b32 v67, 96, v186
    v_add_u32 v71, 0x10000, v67
    v_add_u32 v75, 0x20000, v67
    s_waitcnt vmcnt(8) lgkmcnt(0)
    s_barrier
    s_cmp_eq_u32 s54, 3
    s_cbranch_scc1 gated_mix__ssm_conv_s4d__geglu_ffn__prompt_kernel_nout
    s_cmp_eq_u32 s54, 2
    s_cselect_b32 s50, 1, 0
    s_cmp_eq_u32 s53, 3
    s_cselect_b32 s51, 0, s50
    s_cmp_eq_u32 s51, 1
    s_cbranch_scc1 gated_mix__ssm_conv_s4d__geglu_ffn__prompt_kernel_nout
    s_cmp_eq_u32 s54, 1
    s_cselect_b32 s50, 1, 0
    s_lshl_b32 s51, s50, 15
    s_add_u32 s51, s51, 32768
    s_add_u32 s52, s61, s50
    s_cmp_eq_u32 s52, 9
    s_cselect_b32 s52, 0, s52
    v_lshrrev_b32 v186, 4, v182
    v_bfe_u32 v187, v182, 2, 2
    v_lshlrev_b32 v188, 3, v186
    v_add_u32 v188, v188, v187
    v_lshlrev_b32 v188, 7, v188
    s_lshl_b32 s53, s20, 12
    s_add_u32 s53, s53, s51
    v_add_u32 v188, s53, v188
    v_and_b32 v189, 1, v182
    v_lshlrev_b32 v189, 3, v189
    v_add_u32 v188, v188, v189
    v_lshlrev_b32 v189, 2, v186
    v_lshrrev_b32 v187, 1, v187
    v_add_u32 v189, v189, v187
    v_bfe_u32 v190, v182, 1, 1
    v_and_b32 v191, 7, v189
    v_xor_b32 v191, v191, v190
    v_lshlrev_b32 v191, 4, v191
    v_add_u32 v189, 2, v189
    v_and_b32 v189, 7, v189
    v_xor_b32 v189, v189, v190
    v_lshlrev_b32 v189, 4, v189
    v_xor_b32 v192, 0, v191
    v_add_u32 v192, v192, v188
    v_xor_b32 v193, 0, v189
    v_add_u32 v193, v193, v188
    ds_read_b64_tr_b16 v[0:1], v192
    ds_read_b64_tr_b16 v[2:3], v193 offset:512
    v_xor_b32 v192, 32, v191
    v_add_u32 v192, v192, v188
    v_xor_b32 v193, 32, v189
    v_add_u32 v193, v193, v188
    ds_read_b64_tr_b16 v[4:5], v192
    ds_read_b64_tr_b16 v[6:7], v193 offset:512
    v_xor_b32 v192, 64, v191
    v_add_u32 v192, v192, v188
    v_xor_b32 v193, 64, v189
    v_add_u32 v193, v193, v188
    ds_read_b64_tr_b16 v[8:9], v192
    ds_read_b64_tr_b16 v[10:11], v193 offset:512
    v_xor_b32 v192, 96, v191
    v_add_u32 v192, v192, v188
    v_xor_b32 v193, 96, v189
    v_add_u32 v193, v193, v188
    ds_read_b64_tr_b16 v[12:13], v192
    ds_read_b64_tr_b16 v[14:15], v193 offset:512
    v_and_b32 v192, 15, v182
    v_lshlrev_b32 v192, 12, v192
    v_lshlrev_b32 v193, 4, v186
    v_add_u32 v192, v192, v193
    s_add_u32 s56, s4, 40894464
    s_addc_u32 s57, s5, 0
    s_mov_b32 s58, 2359296
    s_mov_b32 s59, 0x20000
    s_lshl_b32 s52, s52, 18
    s_lshl_b32 s53, s21, 8
    s_add_u32 s52, s52, s53
    s_lshl_b32 s53, s20, 6
    s_add_u32 s52, s52, s53
    s_waitcnt lgkmcnt(0)
    s_add_u32 s53, s52, 0
    buffer_store_dwordx4 v[0:3], v192, s[56:59], s53 offen sc1
    s_add_u32 s53, s52, 65536
    buffer_store_dwordx4 v[4:7], v192, s[56:59], s53 offen sc1
    s_add_u32 s53, s52, 131072
    buffer_store_dwordx4 v[8:11], v192, s[56:59], s53 offen sc1
    s_add_u32 s53, s52, 196608
    buffer_store_dwordx4 v[12:15], v192, s[56:59], s53 offen sc1
gated_mix__ssm_conv_s4d__geglu_ffn__prompt_kernel_nout:
    ds_read_b64_tr_b16 v[128:129], v168 offset:49152
    ds_read_b64_tr_b16 v[130:131], v168 offset:49664
    ds_read_b64_tr_b16 v[132:133], v168 offset:57344
    ds_read_b64_tr_b16 v[134:135], v168 offset:57856
    ds_read_b128 a[0:3], v64 offset:32768
    ds_read_b128 a[4:7], v64 offset:36864
    ds_read_b64_tr_b16 v[136:137], v168 offset:51200
    ds_read_b64_tr_b16 v[138:139], v168 offset:51712
    ds_read_b64_tr_b16 v[140:141], v168 offset:59392
    ds_read_b64_tr_b16 v[142:143], v168 offset:59904
    ds_read_b128 a[8:11], v65 offset:32768
    ds_read_b128 a[12:15], v65 offset:36864
    s_waitcnt lgkmcnt(6)
    v_mfma_f32_32x32x16_bf16 v[0:15], v[128:131], a[0:3], 0
    ds_read_b64_tr_b16 v[144:145], v168 offset:53248
    ds_read_b128 a[16:19], v66 offset:32768
    s_add_u32 m0, s25, 131072
    s_nop 0
    buffer_load_dwordx4 v178, s[8:11], s44 offen offset:3072 lds
    v_mfma_f32_32x32x16_bf16 v[32:47], v[132:135], a[0:3], 0
    ds_read_b64_tr_b16 v[146:147], v168 offset:53760
    ds_read_b128 a[20:23], v66 offset:36864
    buffer_load_dwordx4 v177, s[8:11], s44 offen offset:2048 lds
    v_mfma_f32_32x32x16_bf16 v[48:63], v[132:135], a[4:7], 0
    ds_read_b64_tr_b16 v[148:149], v168 offset:61440
    buffer_load_dwordx4 v176, s[8:11], s44 offen offset:1024 lds
    v_mfma_f32_32x32x16_bf16 v[16:31], v[128:131], a[4:7], 0
    ds_read_b64_tr_b16 v[150:151], v168 offset:61952
    buffer_load_dwordx4 v175, s[8:11], s44 offen offset:0 lds
    s_waitcnt lgkmcnt(6)
    v_mfma_f32_32x32x16_bf16 v[0:15], v[136:139], a[8:11], v[0:15]
    ds_read_b64_tr_b16 v[128:129], v168 offset:55296
    ds_read_b128 a[24:27], v67 offset:32768
    s_add_u32 m0, s25, 147456
    s_nop 0
    buffer_load_dwordx4 v174, s[12:15], s35 offen offset:3072 lds
    v_mfma_f32_32x32x16_bf16 v[32:47], v[140:143], a[8:11], v[32:47]
    ds_read_b64_tr_b16 v[130:131], v168 offset:55808
    ds_read_b128 a[28:31], v67 offset:36864
    buffer_load_dwordx4 v173, s[12:15], s35 offen offset:2048 lds
    v_mfma_f32_32x32x16_bf16 v[48:63], v[140:143], a[12:15], v[48:63]
    ds_read_b64_tr_b16 v[132:133], v168 offset:63488
    buffer_load_dwordx4 v172, s[12:15], s35 offen offset:1024 lds
    v_mfma_f32_32x32x16_bf16 v[16:31], v[136:139], a[12:15], v[16:31]
    ds_read_b64_tr_b16 v[134:135], v168 offset:64000
    buffer_load_dwordx4 v171, s[12:15], s35 offen offset:0 lds
    s_waitcnt lgkmcnt(6)
    v_mfma_f32_32x32x16_bf16 v[0:15], v[144:147], a[16:19], v[0:15]
    ds_read_b64_tr_b16 v[136:137], v169 offset:16384
    ds_read_b128 a[32:35], v68 offset:0
    s_add_u32 m0, s25, 0
    s_nop 0
    buffer_load_dwordx4 v178, s[8:11], s45 offen offset:3072 lds
    v_mfma_f32_32x32x16_bf16 v[32:47], v[148:151], a[16:19], v[32:47]
    ds_read_b64_tr_b16 v[138:139], v169 offset:16896
    ds_read_b128 a[36:39], v68 offset:4096
    buffer_load_dwordx4 v177, s[8:11], s45 offen offset:2048 lds
    v_mfma_f32_32x32x16_bf16 v[48:63], v[148:151], a[20:23], v[48:63]
    ds_read_b64_tr_b16 v[140:141], v169 offset:24576
    buffer_load_dwordx4 v176, s[8:11], s45 offen offset:1024 lds
    v_mfma_f32_32x32x16_bf16 v[16:31], v[144:147], a[20:23], v[16:31]
    ds_read_b64_tr_b16 v[142:143], v169 offset:25088
    buffer_load_dwordx4 v175, s[8:11], s45 offen offset:0 lds
    s_waitcnt vmcnt(12) lgkmcnt(6)
    s_barrier
    v_mfma_f32_32x32x16_bf16 v[0:15], v[128:131], a[24:27], v[0:15]
    ds_read_b64_tr_b16 v[144:145], v169 offset:18432
    ds_read_b128 a[40:43], v69 offset:0
    s_add_u32 m0, s25, 16384
    s_nop 0
    buffer_load_dwordx4 v174, s[12:15], s36 offen offset:3072 lds
    v_mfma_f32_32x32x16_bf16 v[32:47], v[132:135], a[24:27], v[32:47]
    ds_read_b64_tr_b16 v[146:147], v169 offset:18944
    ds_read_b128 a[44:47], v69 offset:4096
    buffer_load_dwordx4 v173, s[12:15], s36 offen offset:2048 lds
    s_add_u32 m0, s25, 32768
    s_nop 0
    buffer_load_dwordx4 v176, s[8:11], s46 offen offset:1024 lds
    v_mfma_f32_32x32x16_bf16 v[48:63], v[132:135], a[28:31], v[48:63]
    ds_read_b64_tr_b16 v[148:149], v169 offset:26624
    s_add_u32 m0, s25, 16384
    s_nop 0
    buffer_load_dwordx4 v172, s[12:15], s36 offen offset:1024 lds
    s_add_u32 m0, s25, 32768
    s_nop 0
    buffer_load_dwordx4 v175, s[8:11], s46 offen offset:0 lds
    v_mfma_f32_32x32x16_bf16 v[16:31], v[128:131], a[28:31], v[16:31]
    ds_read_b64_tr_b16 v[150:151], v169 offset:27136
    s_add_u32 m0, s25, 16384
    s_nop 0
    buffer_load_dwordx4 v171, s[12:15], s36 offen offset:0 lds
    s_waitcnt lgkmcnt(6)
    v_mfma_f32_32x32x16_bf16 v[0:15], v[136:139], a[32:35], v[0:15]
    ds_read_b64_tr_b16 v[128:129], v169 offset:20480
    ds_read_b128 a[48:51], v70 offset:0
    v_mfma_f32_32x32x16_bf16 v[32:47], v[140:143], a[32:35], v[32:47]
    ds_read_b64_tr_b16 v[130:131], v169 offset:20992
    ds_read_b128 a[52:55], v70 offset:4096
    v_mfma_f32_32x32x16_bf16 v[48:63], v[140:143], a[36:39], v[48:63]
    ds_read_b64_tr_b16 v[132:133], v169 offset:28672
    s_add_u32 m0, s25, 32768
    s_nop 0
    buffer_load_dwordx4 v178, s[8:11], s46 offen offset:3072 lds
    v_mfma_f32_32x32x16_bf16 v[16:31], v[136:139], a[36:39], v[16:31]
    ds_read_b64_tr_b16 v[134:135], v169 offset:29184
    buffer_load_dwordx4 v177, s[8:11], s46 offen offset:2048 lds
    s_waitcnt lgkmcnt(6)
    v_mfma_f32_32x32x16_bf16 v[0:15], v[144:147], a[40:43], v[0:15]
    ds_read_b64_tr_b16 v[136:137], v169 offset:22528
    ds_read_b128 a[56:59], v71 offset:0
    v_mfma_f32_32x32x16_bf16 v[32:47], v[148:151], a[40:43], v[32:47]
    ds_read_b64_tr_b16 v[138:139], v169 offset:23040
    ds_read_b128 a[60:63], v71 offset:4096
    v_mfma_f32_32x32x16_bf16 v[48:63], v[148:151], a[44:47], v[48:63]
    ds_read_b64_tr_b16 v[140:141], v169 offset:30720
    s_add_u32 m0, s25, 49152
    s_nop 0
    buffer_load_dwordx4 v172, s[12:15], s37 offen offset:1024 lds
    v_mfma_f32_32x32x16_bf16 v[16:31], v[144:147], a[44:47], v[16:31]
    ds_read_b64_tr_b16 v[142:143], v169 offset:31232
    buffer_load_dwordx4 v171, s[12:15], s37 offen offset:0 lds
    s_waitcnt lgkmcnt(6)
    v_mfma_f32_32x32x16_bf16 v[0:15], v[128:131], a[48:51], v[0:15]
    ds_read_b64_tr_b16 v[144:145], v169 offset:49152
    ds_read_b128 a[64:67], v68 offset:32768
    v_mfma_f32_32x32x16_bf16 v[32:47], v[132:135], a[48:51], v[32:47]
    ds_read_b64_tr_b16 v[146:147], v169 offset:49664
    ds_read_b128 a[68:71], v68 offset:36864
    v_mfma_f32_32x32x16_bf16 v[48:63], v[132:135], a[52:55], v[48:63]
    ds_read_b64_tr_b16 v[148:149], v169 offset:57344
    buffer_load_dwordx4 v174, s[12:15], s37 offen offset:3072 lds
    v_mfma_f32_32x32x16_bf16 v[16:31], v[128:131], a[52:55], v[16:31]
    ds_read_b64_tr_b16 v[150:151], v169 offset:57856
    buffer_load_dwordx4 v173, s[12:15], s37 offen offset:2048 lds
    s_waitcnt vmcnt(16) lgkmcnt(6)
    s_barrier
    v_mfma_f32_32x32x16_bf16 v[0:15], v[136:139], a[56:59], v[0:15]
    ds_read_b64_tr_b16 v[128:129], v169 offset:51200
    ds_read_b128 a[72:75], v69 offset:32768
    v_mfma_f32_32x32x16_bf16 v[32:47], v[140:143], a[56:59], v[32:47]
    ds_read_b64_tr_b16 v[130:131], v169 offset:51712
    ds_read_b128 a[76:79], v69 offset:36864
    v_mfma_f32_32x32x16_bf16 v[48:63], v[140:143], a[60:63], v[48:63]
    ds_read_b64_tr_b16 v[132:133], v169 offset:59392
    s_add_u32 m0, s25, 65536
    s_nop 0
    buffer_load_dwordx4 v176, s[8:11], s47 offen offset:1024 lds
    v_mfma_f32_32x32x16_bf16 v[16:31], v[136:139], a[60:63], v[16:31]
    ds_read_b64_tr_b16 v[134:135], v169 offset:59904
    buffer_load_dwordx4 v175, s[8:11], s47 offen offset:0 lds
    s_waitcnt lgkmcnt(6)
    v_mfma_f32_32x32x16_bf16 v[0:15], v[144:147], a[64:67], v[0:15]
    ds_read_b64_tr_b16 v[136:137], v169 offset:53248
    ds_read_b128 a[80:83], v70 offset:32768
    v_mfma_f32_32x32x16_bf16 v[32:47], v[148:151], a[64:67], v[32:47]
    ds_read_b64_tr_b16 v[138:139], v169 offset:53760
    ds_read_b128 a[84:87], v70 offset:36864
    v_mfma_f32_32x32x16_bf16 v[48:63], v[148:151], a[68:71], v[48:63]
    ds_read_b64_tr_b16 v[140:141], v169 offset:61440
    buffer_load_dwordx4 v178, s[8:11], s47 offen offset:3072 lds
    v_mfma_f32_32x32x16_bf16 v[16:31], v[144:147], a[68:71], v[16:31]
    ds_read_b64_tr_b16 v[142:143], v169 offset:61952
    buffer_load_dwordx4 v177, s[8:11], s47 offen offset:2048 lds
    s_waitcnt lgkmcnt(6)
    v_mfma_f32_32x32x16_bf16 v[0:15], v[128:131], a[72:75], v[0:15]
    ds_read_b64_tr_b16 v[144:145], v169 offset:55296
    ds_read_b128 a[88:91], v71 offset:32768
    v_mfma_f32_32x32x16_bf16 v[32:47], v[132:135], a[72:75], v[32:47]
    ds_read_b64_tr_b16 v[146:147], v169 offset:55808
    ds_read_b128 a[92:95], v71 offset:36864
    v_mfma_f32_32x32x16_bf16 v[48:63], v[132:135], a[76:79], v[48:63]
    ds_read_b64_tr_b16 v[148:149], v169 offset:63488
    s_add_u32 m0, s25, 81920
    s_nop 0
    buffer_load_dwordx4 v172, s[12:15], s38 offen offset:1024 lds
    v_mfma_f32_32x32x16_bf16 v[16:31], v[128:131], a[76:79], v[16:31]
    ds_read_b64_tr_b16 v[150:151], v169 offset:64000
    buffer_load_dwordx4 v171, s[12:15], s38 offen offset:0 lds
    s_waitcnt lgkmcnt(6)
    v_mfma_f32_32x32x16_bf16 v[0:15], v[136:139], a[80:83], v[0:15]
    ds_read_b64_tr_b16 v[128:129], v170 offset:16384
    ds_read_b128 a[96:99], v72 offset:0
    v_mfma_f32_32x32x16_bf16 v[32:47], v[140:143], a[80:83], v[32:47]
    ds_read_b64_tr_b16 v[130:131], v170 offset:16896
    ds_read_b128 a[100:103], v72 offset:4096
    v_mfma_f32_32x32x16_bf16 v[48:63], v[140:143], a[84:87], v[48:63]
    ds_read_b64_tr_b16 v[132:133], v170 offset:24576
    buffer_load_dwordx4 v174, s[12:15], s38 offen offset:3072 lds
    v_mfma_f32_32x32x16_bf16 v[16:31], v[136:139], a[84:87], v[16:31]
    ds_read_b64_tr_b16 v[134:135], v170 offset:25088
    buffer_load_dwordx4 v173, s[12:15], s38 offen offset:2048 lds
    s_waitcnt vmcnt(14) lgkmcnt(6)
    s_barrier
    v_mfma_f32_32x32x16_bf16 v[0:15], v[144:147], a[88:91], v[0:15]
    ds_read_b64_tr_b16 v[136:137], v170 offset:18432
    ds_read_b128 a[104:107], v73 offset:0
    v_mfma_f32_32x32x16_bf16 v[32:47], v[148:151], a[88:91], v[32:47]
    ds_read_b64_tr_b16 v[138:139], v170 offset:18944
    ds_read_b128 a[108:111], v73 offset:4096
    v_mfma_f32_32x32x16_bf16 v[48:63], v[148:151], a[92:95], v[48:63]
    ds_read_b64_tr_b16 v[140:141], v170 offset:26624
    s_add_u32 m0, s25, 98304
    s_nop 0
    buffer_load_dwordx4 v176, s[8:11], s48 offen offset:1024 lds
    v_mfma_f32_32x32x16_bf16 v[16:31], v[144:147], a[92:95], v[16:31]
    ds_read_b64_tr_b16 v[142:143], v170 offset:27136
    buffer_load_dwordx4 v175, s[8:11], s48 offen offset:0 lds
    s_waitcnt lgkmcnt(6)
    v_mfma_f32_32x32x16_bf16 v[0:15], v[128:131], a[96:99], v[0:15]
    ds_read_b64_tr_b16 v[144:145], v170 offset:20480
    ds_read_b128 a[112:115], v74 offset:0
    v_mfma_f32_32x32x16_bf16 v[32:47], v[132:135], a[96:99], v[32:47]
    ds_read_b64_tr_b16 v[146:147], v170 offset:20992
    ds_read_b128 a[116:119], v74 offset:4096
    v_mfma_f32_32x32x16_bf16 v[48:63], v[132:135], a[100:103], v[48:63]
    ds_read_b64_tr_b16 v[148:149], v170 offset:28672
    buffer_load_dwordx4 v178, s[8:11], s48 offen offset:3072 lds
    v_mfma_f32_32x32x16_bf16 v[16:31], v[128:131], a[100:103], v[16:31]
    ds_read_b64_tr_b16 v[150:151], v170 offset:29184
    buffer_load_dwordx4 v177, s[8:11], s48 offen offset:2048 lds
    s_waitcnt lgkmcnt(6)
    v_mfma_f32_32x32x16_bf16 v[0:15], v[136:139], a[104:107], v[0:15]
    ds_read_b64_tr_b16 v[128:129], v170 offset:22528
    ds_read_b128 a[120:123], v75 offset:0
    v_mfma_f32_32x32x16_bf16 v[32:47], v[140:143], a[104:107], v[32:47]
    ds_read_b64_tr_b16 v[130:131], v170 offset:23040
    ds_read_b128 a[124:127], v75 offset:4096
    v_mfma_f32_32x32x16_bf16 v[48:63], v[140:143], a[108:111], v[48:63]
    ds_read_b64_tr_b16 v[132:133], v170 offset:30720
    s_add_u32 m0, s25, 114688
    s_nop 0
    buffer_load_dwordx4 v172, s[12:15], s39 offen offset:1024 lds
    v_mfma_f32_32x32x16_bf16 v[16:31], v[136:139], a[108:111], v[16:31]
    ds_read_b64_tr_b16 v[134:135], v170 offset:31232
    buffer_load_dwordx4 v171, s[12:15], s39 offen offset:0 lds
    s_waitcnt lgkmcnt(6)
    v_mfma_f32_32x32x16_bf16 v[0:15], v[144:147], a[112:115], v[0:15]
    ds_read_b64_tr_b16 v[136:137], v168 offset:16384
    ds_read_b128 a[128:131], v64 offset:0
    v_mfma_f32_32x32x16_bf16 v[32:47], v[148:151], a[112:115], v[32:47]
    ds_read_b64_tr_b16 v[138:139], v168 offset:16896
    ds_read_b128 a[132:135], v64 offset:4096
    v_mfma_f32_32x32x16_bf16 v[48:63], v[148:151], a[116:119], v[48:63]
    ds_read_b64_tr_b16 v[140:141], v168 offset:24576
    buffer_load_dwordx4 v174, s[12:15], s39 offen offset:3072 lds
    v_mfma_f32_32x32x16_bf16 v[16:31], v[144:147], a[116:119], v[16:31]
    ds_read_b64_tr_b16 v[142:143], v168 offset:25088
    buffer_load_dwordx4 v173, s[12:15], s39 offen offset:2048 lds
    s_waitcnt vmcnt(16) lgkmcnt(6)
    s_barrier
    v_mfma_f32_32x32x16_bf16 v[0:15], v[128:131], a[120:123], v[0:15]
    ds_read_b64_tr_b16 v[144:145], v168 offset:18432
    ds_read_b128 a[136:139], v65 offset:0
    v_mfma_f32_32x32x16_bf16 v[32:47], v[132:135], a[120:123], v[32:47]
    ds_read_b64_tr_b16 v[146:147], v168 offset:18944
    ds_read_b128 a[140:143], v65 offset:4096
    v_mfma_f32_32x32x16_bf16 v[48:63], v[132:135], a[124:127], v[48:63]
    ds_read_b64_tr_b16 v[148:149], v168 offset:26624
    s_add_u32 m0, s25, 131072
    s_nop 0
    buffer_load_dwordx4 v176, s[8:11], s49 offen offset:1024 lds
    v_mfma_f32_32x32x16_bf16 v[16:31], v[128:131], a[124:127], v[16:31]
    ds_read_b64_tr_b16 v[150:151], v168 offset:27136
    buffer_load_dwordx4 v175, s[8:11], s49 offen offset:0 lds
    s_waitcnt lgkmcnt(6)
    v_mfma_f32_32x32x16_bf16 v[0:15], v[136:139], a[128:131], v[0:15]
    ds_read_b64_tr_b16 v[128:129], v168 offset:20480
    ds_read_b128 a[144:147], v66 offset:0
    v_mfma_f32_32x32x16_bf16 v[32:47], v[140:143], a[128:131], v[32:47]
    ds_read_b64_tr_b16 v[130:131], v168 offset:20992
    ds_read_b128 a[148:151], v66 offset:4096
    v_mfma_f32_32x32x16_bf16 v[48:63], v[140:143], a[132:135], v[48:63]
    ds_read_b64_tr_b16 v[132:133], v168 offset:28672
    buffer_load_dwordx4 v178, s[8:11], s49 offen offset:3072 lds
    v_mfma_f32_32x32x16_bf16 v[16:31], v[136:139], a[132:135], v[16:31]
    ds_read_b64_tr_b16 v[134:135], v168 offset:29184
    buffer_load_dwordx4 v177, s[8:11], s49 offen offset:2048 lds
    s_waitcnt lgkmcnt(6)
    v_mfma_f32_32x32x16_bf16 v[0:15], v[144:147], a[136:139], v[0:15]
    ds_read_b64_tr_b16 v[136:137], v168 offset:22528
    ds_read_b128 a[152:155], v67 offset:0
    v_mfma_f32_32x32x16_bf16 v[32:47], v[148:151], a[136:139], v[32:47]
    ds_read_b64_tr_b16 v[138:139], v168 offset:23040
    ds_read_b128 a[156:159], v67 offset:4096
    v_mfma_f32_32x32x16_bf16 v[48:63], v[148:151], a[140:143], v[48:63]
    ds_read_b64_tr_b16 v[140:141], v168 offset:30720
    s_add_u32 m0, s25, 147456
    s_nop 0
    buffer_load_dwordx4 v172, s[12:15], s40 offen offset:1024 lds
    v_mfma_f32_32x32x16_bf16 v[16:31], v[144:147], a[140:143], v[16:31]
    ds_read_b64_tr_b16 v[142:143], v168 offset:31232
    buffer_load_dwordx4 v171, s[12:15], s40 offen offset:0 lds
    s_waitcnt lgkmcnt(6)
    v_mfma_f32_32x32x16_bf16 v[0:15], v[128:131], a[144:147], v[0:15]
    ds_read_b64_tr_b16 v[144:145], v168 offset:49152
    ds_read_b128 a[160:163], v64 offset:32768
    v_mfma_f32_32x32x16_bf16 v[32:47], v[132:135], a[144:147], v[32:47]
    ds_read_b64_tr_b16 v[146:147], v168 offset:49664
    ds_read_b128 a[164:167], v64 offset:36864
    v_mfma_f32_32x32x16_bf16 v[48:63], v[132:135], a[148:151], v[48:63]
    ds_read_b64_tr_b16 v[148:149], v168 offset:57344
    buffer_load_dwordx4 v174, s[12:15], s40 offen offset:3072 lds
    v_mfma_f32_32x32x16_bf16 v[16:31], v[128:131], a[148:151], v[16:31]
    ds_read_b64_tr_b16 v[150:151], v168 offset:57856
    buffer_load_dwordx4 v173, s[12:15], s40 offen offset:2048 lds
    s_waitcnt vmcnt(16) lgkmcnt(6)
    s_barrier
    v_mfma_f32_32x32x16_bf16 v[0:15], v[136:139], a[152:155], v[0:15]
    ds_read_b64_tr_b16 v[128:129], v168 offset:51200
    ds_read_b128 a[168:171], v65 offset:32768
    s_add_u32 s12, s12, 128
    s_addc_u32 s13, s13, 0
    s_sub_u32 s14, s14, 128
    v_mfma_f32_32x32x16_bf16 v[32:47], v[140:143], a[152:155], v[32:47]
    ds_read_b64_tr_b16 v[130:131], v168 offset:51712
    ds_read_b128 a[172:175], v65 offset:36864
    v_mfma_f32_32x32x16_bf16 v[48:63], v[140:143], a[156:159], v[48:63]
    ds_read_b64_tr_b16 v[132:133], v168 offset:59392
    s_add_u32 m0, s25, 0
    s_nop 0
    buffer_load_dwordx4 v172, s[12:15], s32 offen offset:1024 lds
    v_mfma_f32_32x32x16_bf16 v[16:31], v[136:139], a[156:159], v[16:31]
    ds_read_b64_tr_b16 v[134:135], v168 offset:59904
    buffer_load_dwordx4 v171, s[12:15], s32 offen offset:0 lds
    s_waitcnt lgkmcnt(6)
    v_mfma_f32_32x32x16_bf16 v[0:15], v[144:147], a[160:163], v[0:15]
    ds_read_b64_tr_b16 v[136:137], v168 offset:53248
    ds_read_b128 a[176:179], v66 offset:32768
    v_mfma_f32_32x32x16_bf16 v[32:47], v[148:151], a[160:163], v[32:47]
    ds_read_b64_tr_b16 v[138:139], v168 offset:53760
    ds_read_b128 a[180:183], v66 offset:36864
    v_mfma_f32_32x32x16_bf16 v[48:63], v[148:151], a[164:167], v[48:63]
    ds_read_b64_tr_b16 v[140:141], v168 offset:61440
    buffer_load_dwordx4 v174, s[12:15], s32 offen offset:3072 lds
    v_mfma_f32_32x32x16_bf16 v[16:31], v[144:147], a[164:167], v[16:31]
    ds_read_b64_tr_b16 v[142:143], v168 offset:61952
    buffer_load_dwordx4 v173, s[12:15], s32 offen offset:2048 lds
    s_waitcnt lgkmcnt(6)
    v_mfma_f32_32x32x16_bf16 v[0:15], v[128:131], a[168:171], v[0:15]
    ds_read_b64_tr_b16 v[144:145], v168 offset:55296
    ds_read_b128 a[184:187], v67 offset:32768
    v_mfma_f32_32x32x16_bf16 v[32:47], v[132:135], a[168:171], v[32:47]
    ds_read_b64_tr_b16 v[146:147], v168 offset:55808
    ds_read_b128 a[188:191], v67 offset:36864
    v_mfma_f32_32x32x16_bf16 v[48:63], v[132:135], a[172:175], v[48:63]
    ds_read_b64_tr_b16 v[148:149], v168 offset:63488
    s_add_u32 m0, s25, 16384
    s_nop 0
    buffer_load_dwordx4 v172, s[12:15], s33 offen offset:1024 lds
    v_mfma_f32_32x32x16_bf16 v[16:31], v[128:131], a[172:175], v[16:31]
    ds_read_b64_tr_b16 v[150:151], v168 offset:64000
    buffer_load_dwordx4 v171, s[12:15], s33 offen offset:0 lds
    s_waitcnt lgkmcnt(6)
    v_mfma_f32_32x32x16_bf16 v[0:15], v[136:139], a[176:179], v[0:15]
    ds_read_b64_tr_b16 v[128:129], v169 offset:16384
    ds_read_b128 a[192:195], v68 offset:0
    v_mfma_f32_32x32x16_bf16 v[32:47], v[140:143], a[176:179], v[32:47]
    ds_read_b64_tr_b16 v[130:131], v169 offset:16896
    ds_read_b128 a[196:199], v68 offset:4096
    v_mfma_f32_32x32x16_bf16 v[48:63], v[140:143], a[180:183], v[48:63]
    ds_read_b64_tr_b16 v[132:133], v169 offset:24576
    buffer_load_dwordx4 v174, s[12:15], s33 offen offset:3072 lds
    v_mfma_f32_32x32x16_bf16 v[16:31], v[136:139], a[180:183], v[16:31]
    ds_read_b64_tr_b16 v[134:135], v169 offset:25088
    buffer_load_dwordx4 v173, s[12:15], s33 offen offset:2048 lds
    s_waitcnt vmcnt(16) lgkmcnt(6)
    s_barrier
    v_mfma_f32_32x32x16_bf16 v[0:15], v[144:147], a[184:187], v[0:15]
    ds_read_b64_tr_b16 v[136:137], v169 offset:18432
    ds_read_b128 a[200:203], v69 offset:0
    v_mfma_f32_32x32x16_bf16 v[32:47], v[148:151], a[184:187], v[32:47]
    ds_read_b64_tr_b16 v[138:139], v169 offset:18944
    ds_read_b128 a[204:207], v69 offset:4096
    v_mfma_f32_32x32x16_bf16 v[48:63], v[148:151], a[188:191], v[48:63]
    ds_read_b64_tr_b16 v[140:141], v169 offset:26624
    s_add_u32 m0, s25, 32768
    s_nop 0
    buffer_load_dwordx4 v172, s[12:15], s34 offen offset:1024 lds
    v_mfma_f32_32x32x16_bf16 v[16:31], v[144:147], a[188:191], v[16:31]
    ds_read_b64_tr_b16 v[142:143], v169 offset:27136
    buffer_load_dwordx4 v171, s[12:15], s34 offen offset:0 lds
    s_waitcnt lgkmcnt(6)
    v_mfma_f32_32x32x16_bf16 v[0:15], v[128:131], a[192:195], v[0:15]
    ds_read_b64_tr_b16 v[144:145], v169 offset:20480
    ds_read_b128 a[208:211], v70 offset:0
    v_mfma_f32_32x32x16_bf16 v[32:47], v[132:135], a[192:195], v[32:47]
    ds_read_b64_tr_b16 v[146:147], v169 offset:20992
    ds_read_b128 a[212:215], v70 offset:4096
    v_mfma_f32_32x32x16_bf16 v[48:63], v[132:135], a[196:199], v[48:63]
    ds_read_b64_tr_b16 v[148:149], v169 offset:28672
    buffer_load_dwordx4 v174, s[12:15], s34 offen offset:3072 lds
    v_mfma_f32_32x32x16_bf16 v[16:31], v[128:131], a[196:199], v[16:31]
    ds_read_b64_tr_b16 v[150:151], v169 offset:29184
    buffer_load_dwordx4 v173, s[12:15], s34 offen offset:2048 lds
    s_waitcnt lgkmcnt(6)
    v_mfma_f32_32x32x16_bf16 v[0:15], v[136:139], a[200:203], v[0:15]
    ds_read_b64_tr_b16 v[128:129], v169 offset:22528
    ds_read_b128 a[216:219], v71 offset:0
    v_mfma_f32_32x32x16_bf16 v[32:47], v[140:143], a[200:203], v[32:47]
    ds_read_b64_tr_b16 v[130:131], v169 offset:23040
    ds_read_b128 a[220:223], v71 offset:4096
    v_mfma_f32_32x32x16_bf16 v[48:63], v[140:143], a[204:207], v[48:63]
    ds_read_b64_tr_b16 v[132:133], v169 offset:30720
    s_add_u32 m0, s25, 49152
    s_nop 0
    buffer_load_dwordx4 v172, s[12:15], s35 offen offset:1024 lds
    v_mfma_f32_32x32x16_bf16 v[16:31], v[136:139], a[204:207], v[16:31]
    ds_read_b64_tr_b16 v[134:135], v169 offset:31232
    buffer_load_dwordx4 v171, s[12:15], s35 offen offset:0 lds
    s_waitcnt lgkmcnt(6)
    v_mfma_f32_32x32x16_bf16 v[0:15], v[144:147], a[208:211], v[0:15]
    ds_read_b64_tr_b16 v[136:137], v169 offset:49152
    ds_read_b128 a[224:227], v68 offset:32768
    v_mfma_f32_32x32x16_bf16 v[32:47], v[148:151], a[208:211], v[32:47]
    ds_read_b64_tr_b16 v[138:139], v169 offset:49664
    ds_read_b128 a[228:231], v68 offset:36864
    v_mfma_f32_32x32x16_bf16 v[48:63], v[148:151], a[212:215], v[48:63]
    ds_read_b64_tr_b16 v[140:141], v169 offset:57344
    buffer_load_dwordx4 v174, s[12:15], s35 offen offset:3072 lds
    v_mfma_f32_32x32x16_bf16 v[16:31], v[144:147], a[212:215], v[16:31]
    ds_read_b64_tr_b16 v[142:143], v169 offset:57856
    buffer_load_dwordx4 v173, s[12:15], s35 offen offset:2048 lds
    s_waitcnt vmcnt(16) lgkmcnt(6)
    s_barrier
    v_mfma_f32_32x32x16_bf16 v[0:15], v[128:131], a[216:219], v[0:15]
    ds_read_b64_tr_b16 v[144:145], v169 offset:51200
    ds_read_b128 a[232:235], v69 offset:32768
    v_mfma_f32_32x32x16_bf16 v[32:47], v[132:135], a[216:219], v[32:47]
    ds_read_b64_tr_b16 v[146:147], v169 offset:51712
    ds_read_b128 a[236:239], v69 offset:36864
    v_mfma_f32_32x32x16_bf16 v[48:63], v[132:135], a[220:223], v[48:63]
    ds_read_b64_tr_b16 v[148:149], v169 offset:59392
    s_add_u32 m0, s25, 65536
    s_nop 0
    buffer_load_dwordx4 v172, s[12:15], s36 offen offset:1024 lds
    v_mfma_f32_32x32x16_bf16 v[16:31], v[128:131], a[220:223], v[16:31]
    ds_read_b64_tr_b16 v[150:151], v169 offset:59904
    buffer_load_dwordx4 v171, s[12:15], s36 offen offset:0 lds
    s_waitcnt lgkmcnt(6)
    v_mfma_f32_32x32x16_bf16 v[0:15], v[136:139], a[224:227], v[0:15]
    ds_read_b64_tr_b16 v[128:129], v169 offset:53248
    ds_read_b128 a[240:243], v70 offset:32768
    v_mfma_f32_32x32x16_bf16 v[32:47], v[140:143], a[224:227], v[32:47]
    ds_read_b64_tr_b16 v[130:131], v169 offset:53760
    ds_read_b128 a[244:247], v70 offset:36864
    v_mfma_f32_32x32x16_bf16 v[48:63], v[140:143], a[228:231], v[48:63]
    ds_read_b64_tr_b16 v[132:133], v169 offset:61440
    buffer_load_dwordx4 v174, s[12:15], s36 offen offset:3072 lds
    v_mfma_f32_32x32x16_bf16 v[16:31], v[136:139], a[228:231], v[16:31]
    ds_read_b64_tr_b16 v[134:135], v169 offset:61952
    buffer_load_dwordx4 v173, s[12:15], s36 offen offset:2048 lds
    s_waitcnt lgkmcnt(6)
    v_mfma_f32_32x32x16_bf16 v[0:15], v[144:147], a[232:235], v[0:15]
    ds_read_b64_tr_b16 v[136:137], v169 offset:55296
    ds_read_b128 a[248:251], v71 offset:32768
    v_mfma_f32_32x32x16_bf16 v[32:47], v[148:151], a[232:235], v[32:47]
    ds_read_b64_tr_b16 v[138:139], v169 offset:55808
    ds_read_b128 a[252:255], v71 offset:36864
    v_mfma_f32_32x32x16_bf16 v[48:63], v[148:151], a[236:239], v[48:63]
    ds_read_b64_tr_b16 v[140:141], v169 offset:63488
    s_add_u32 m0, s25, 81920
    s_nop 0
    buffer_load_dwordx4 v172, s[12:15], s37 offen offset:1024 lds
    v_mfma_f32_32x32x16_bf16 v[16:31], v[144:147], a[236:239], v[16:31]
    ds_read_b64_tr_b16 v[142:143], v169 offset:64000
    buffer_load_dwordx4 v171, s[12:15], s37 offen offset:0 lds
    s_waitcnt lgkmcnt(6)
    v_mfma_f32_32x32x16_bf16 v[0:15], v[128:131], a[240:243], v[0:15]
    ds_read_b64_tr_b16 v[144:145], v170 offset:16384
    ds_read_b128 v[224:227], v72 offset:0
    v_mfma_f32_32x32x16_bf16 v[32:47], v[132:135], a[240:243], v[32:47]
    ds_read_b64_tr_b16 v[146:147], v170 offset:16896
    ds_read_b128 v[228:231], v72 offset:4096
    v_mfma_f32_32x32x16_bf16 v[48:63], v[132:135], a[244:247], v[48:63]
    ds_read_b64_tr_b16 v[148:149], v170 offset:24576
    buffer_load_dwordx4 v174, s[12:15], s37 offen offset:3072 lds
    v_mfma_f32_32x32x16_bf16 v[16:31], v[128:131], a[244:247], v[16:31]
    ds_read_b64_tr_b16 v[150:151], v170 offset:25088
    buffer_load_dwordx4 v173, s[12:15], s37 offen offset:2048 lds
    s_waitcnt vmcnt(20) lgkmcnt(6)
    s_barrier
    v_mfma_f32_32x32x16_bf16 v[0:15], v[136:139], a[248:251], v[0:15]
    ds_read_b64_tr_b16 v[128:129], v170 offset:18432
    ds_read_b128 v[232:235], v73 offset:0
    v_mfma_f32_32x32x16_bf16 v[32:47], v[140:143], a[248:251], v[32:47]
    ds_read_b64_tr_b16 v[130:131], v170 offset:18944
    ds_read_b128 v[236:239], v73 offset:4096
    v_mfma_f32_32x32x16_bf16 v[48:63], v[140:143], a[252:255], v[48:63]
    ds_read_b64_tr_b16 v[132:133], v170 offset:26624
    v_mfma_f32_32x32x16_bf16 v[16:31], v[136:139], a[252:255], v[16:31]
    ds_read_b64_tr_b16 v[134:135], v170 offset:27136
    s_waitcnt lgkmcnt(6)
    v_mfma_f32_32x32x16_bf16 v[0:15], v[144:147], v[224:227], v[0:15]
    ds_read_b64_tr_b16 v[136:137], v170 offset:20480
    ds_read_b128 v[240:243], v74 offset:0
    v_mfma_f32_32x32x16_bf16 v[32:47], v[148:151], v[224:227], v[32:47]
    ds_read_b64_tr_b16 v[138:139], v170 offset:20992
    ds_read_b128 v[244:247], v74 offset:4096
    v_mfma_f32_32x32x16_bf16 v[48:63], v[148:151], v[228:231], v[48:63]
    ds_read_b64_tr_b16 v[140:141], v170 offset:28672
    v_mfma_f32_32x32x16_bf16 v[16:31], v[144:147], v[228:231], v[16:31]
    ds_read_b64_tr_b16 v[142:143], v170 offset:29184
    s_waitcnt lgkmcnt(6)
    v_mfma_f32_32x32x16_bf16 v[0:15], v[128:131], v[232:235], v[0:15]
    ds_read_b64_tr_b16 v[144:145], v170 offset:22528
    ds_read_b128 v[248:251], v75 offset:0
    v_mfma_f32_32x32x16_bf16 v[32:47], v[132:135], v[232:235], v[32:47]
    ds_read_b64_tr_b16 v[146:147], v170 offset:23040
    ds_read_b128 v[252:255], v75 offset:4096
    v_mfma_f32_32x32x16_bf16 v[48:63], v[132:135], v[236:239], v[48:63]
    ds_read_b64_tr_b16 v[148:149], v170 offset:30720
    v_mfma_f32_32x32x16_bf16 v[16:31], v[128:131], v[236:239], v[16:31]
    ds_read_b64_tr_b16 v[150:151], v170 offset:31232
    s_waitcnt lgkmcnt(6)
    v_mfma_f32_32x32x16_bf16 v[0:15], v[136:139], v[240:243], v[0:15]
    ds_read_b64_tr_b16 v[128:129], v168 offset:0
    v_mfma_f32_32x32x16_bf16 v[32:47], v[140:143], v[240:243], v[32:47]
    ds_read_b64_tr_b16 v[130:131], v168 offset:512
    v_mfma_f32_32x32x16_bf16 v[48:63], v[140:143], v[244:247], v[48:63]
    ds_read_b64_tr_b16 v[132:133], v168 offset:8192
    v_mfma_f32_32x32x16_bf16 v[16:31], v[136:139], v[244:247], v[16:31]
    ds_read_b64_tr_b16 v[134:135], v168 offset:8704
    s_waitcnt vmcnt(8) lgkmcnt(4)
    s_barrier
    v_mfma_f32_32x32x16_bf16 v[64:79], v[144:147], v[248:251], v[0:15]
    ds_read_b64_tr_b16 v[136:137], v168 offset:2048
    v_mfma_f32_32x32x16_bf16 v[96:111], v[148:151], v[248:251], v[32:47]
    ds_read_b64_tr_b16 v[138:139], v168 offset:2560
    v_mfma_f32_32x32x16_bf16 v[112:127], v[148:151], v[252:255], v[48:63]
    ds_read_b64_tr_b16 v[140:141], v168 offset:10240
    v_mfma_f32_32x32x16_bf16 v[80:95], v[144:147], v[252:255], v[16:31]
    ds_read_b64_tr_b16 v[142:143], v168 offset:10752
    s_mov_b32 s60, 0x40000
gated_mix__ssm_conv_s4d__geglu_ffn__prompt_kernel_np_3:
    v_readfirstlane_b32 s65, v184
    s_nop 3
    s_cmp_lg_u32 s65, 0
    s_cbranch_scc1 gated_mix__ssm_conv_s4d__geglu_ffn__prompt_kernel_nok_4
    s_sleep 2
    s_mov_b32 s56, s6
    s_mov_b32 s57, s7
    s_mov_b32 s58, 256
    s_mov_b32 s59, 0x20000
    buffer_load_dword v184, v185, s[56:59], 0 offen sc0 sc1
    s_waitcnt vmcnt(0)
    s_sub_u32 s60, s60, 1
    s_cmp_lg_u32 s60, 0
    s_cbranch_scc1 gated_mix__ssm_conv_s4d__geglu_ffn__prompt_kernel_np_3
gated_mix__ssm_conv_s4d__geglu_ffn__prompt_kernel_nok_4:
    s_mov_b32 s24, s31
    s_add_u32 s56, s4, 48234496
    s_addc_u32 s57, s5, 0
    s_mov_b32 s58, 16384
    s_mov_b32 s59, 0x20000
    s_movk_i32 s60, 5120
    s_lshr_b32 s62, s2, 3
    s_and_b32 s62, s62, 7
    s_and_b32 s61, s3, 1
    s_lshl_b32 s61, s61, 3
    s_add_u32 s61, s61, s62
    s_lshl_b32 s61, s61, 2
    s_lshr_b32 s62, s3, 1
    s_add_u32 s61, s61, s62
    s_lshl_b32 s61, s61, 4
    s_mov_b32 s52, s4
    s_mov_b32 s53, s5
    s_mov_b32 s54, 0
    s_mov_b32 s55, 0x20000
    v_mov_b32 v208, 0
    v_mov_b32 v209, 0
    v_mov_b32 v210, 0
    v_mov_b32 v211, 0
    v_mov_b32 v220, 0
    v_mov_b32 v221, 0
    s_cmp_eq_u32 s26, 1
    s_cbranch_scc0 nosetup_5
    s_load_dwordx2 s[52:53], s[0:1], 80
    s_lshr_b32 s63, s2, 3
    s_lshr_b32 s46, s3, 1
    s_and_b32 s62, s3, 1
    s_lshl_b32 s62, s62, 3
    s_and_b32 s50, s63, 7
    s_add_u32 s47, s62, s50
    s_lshr_b32 s48, s63, 3
    s_lshr_b32 s66, s20, 1
    s_and_b32 s49, s20, 1
    s_lshl_b32 s62, s47, 2
    s_add_u32 s62, s62, s20
    s_mul_i32 s62, s62, 288
    s_mul_i32 s63, s46, 72
    s_add_u32 s62, s62, s63
    s_lshl_b32 s51, s62, 10
    s_mul_i32 s62, s46, 1152
    s_lshl_b32 s63, s20, 3
    s_add_u32 s62, s62, s63
    s_mul_i32 s62, s62, 1152
    s_mul_i32 s63, s48, 384
    s_add_u32 s44, s62, s63
    s_lshl_b32 s62, s48, 2
    s_mul_i32 s63, s50, 3
    s_lshr_b32 s63, s63, 1
    s_add_u32 s62, s62, s63
    s_cmp_ge_u32 s62, 12
    s_cselect_b32 s63, 12, 0
    s_sub_u32 s62, s62, s63
    v_mul_u32_u24 v216, 43, v182
    v_lshrrev_b32 v216, 9, v216
    v_mul_u32_u24 v212, 12, v216
    v_sub_u32 v212, v182, v212
    v_add_u32 v212, s62, v212
    v_subrev_u32 v213, 12, v212
    v_cmp_le_u32 vcc, 12, v212
    s_nop 1
    v_cndmask_b32 v212, v212, v213, vcc
    v_lshrrev_b32 v213, 2, v212
    v_mul_u32_u24 v213, 10, v213
    v_and_b32 v214, 3, v212
    v_add_u32 v213, v213, v214
    v_add_u32 v214, 6, v213
    v_lshrrev_b32 v215, 1, v212
    v_mul_u32_u24 v215, 10, v215
    v_and_b32 v222, 1, v212
    v_add_u32 v215, v215, v222
    v_add_u32 v215, 4, v215
    v_add_u32 v222, 24, v212
    v_cmp_le_u32 vcc, 6, v212
    s_nop 1
    v_cndmask_b32 v215, v215, v222, vcc
    v_cmp_eq_u32 vcc, 1, v216
    s_nop 1
    v_cndmask_b32 v213, v213, v215, vcc
    v_cmp_le_u32 vcc, 2, v216
    s_nop 1
    v_cndmask_b32 v213, v213, v214, vcc
    v_min_u32 v213, 35, v213
    v_lshlrev_b32 v222, 11, v213
    v_add_u32 v222, s51, v222
    s_mov_b32 s62, 36864
    v_mul_lo_u32 v223, v213, s62
    v_add_u32 v223, s44, v223
    s_mov_b32 s45, 0
    s_lshl_b32 s41, s20, 11
    s_mul_i32 s42, s20, 3072
    s_add_u32 s42, s42, 8192
    v_lshlrev_b32 v208, 4, v182
    v_lshrrev_b32 v212, 3, v182
    v_mul_u32_u24 v209, 1152, v212
    v_bfe_u32 v213, v182, 4, 1
    v_lshlrev_b32 v213, 2, v213
    v_and_b32 v214, 7, v182
    v_xor_b32 v213, v213, v214
    v_lshlrev_b32 v213, 4, v213
    v_add_u32 v209, v209, v213
    v_add_u32 v211, 0, v209
    v_add_u32 v210, 896, v209
    v_add_u32 v209, 1792, v209
    v_lshrrev_b32 v212, 5, v182
    v_lshlrev_b32 v212, 2, v212
    v_bfe_u32 v213, v182, 2, 2
    v_add_u32 v212, v212, v213
    v_lshlrev_b32 v212, 7, v212
    v_and_b32 v214, 1, v182
    v_lshlrev_b32 v214, 1, v214
    v_bfe_u32 v215, v182, 4, 1
    v_add_u32 v214, v214, v215
    v_lshlrev_b32 v214, 4, v214
    v_add_u32 v212, v212, v214
    v_bfe_u32 v214, v182, 1, 1
    v_lshlrev_b32 v214, 3, v214
    v_add_u32 v212, v212, v214
    v_lshrrev_b32 v213, 1, v213
    v_lshlrev_b32 v213, 6, v213
    s_mul_i32 s62, s49, 3
    s_add_u32 s62, s62, 0
    s_and_b32 s63, s62, 1
    s_lshl_b32 s63, s63, 6
    s_lshr_b32 s62, s62, 1
    s_lshl_b32 s62, s62, 10
    v_xor_b32 v214, s63, v213
    v_add_u32 v214, v214, v212
    v_add_u32 v200, s62, v214
    v_add_u32 v203, 0x10000, v200
    s_mul_i32 s62, s49, 3
    s_add_u32 s62, s62, 1
    s_and_b32 s63, s62, 1
    s_lshl_b32 s63, s63, 6
    s_lshr_b32 s62, s62, 1
    s_lshl_b32 s62, s62, 10
    v_xor_b32 v214, s63, v213
    v_add_u32 v214, v214, v212
    v_add_u32 v201, s62, v214
    v_add_u32 v204, 0x10000, v201
    s_mul_i32 s62, s49, 3
    s_add_u32 s62, s62, 2
    s_and_b32 s63, s62, 1
    s_lshl_b32 s63, s63, 6
    s_lshr_b32 s62, s62, 1
    s_lshl_b32 s62, s62, 10
    v_xor_b32 v214, s63, v213
    v_add_u32 v214, v214, v212
    v_add_u32 v202, s62, v214
    v_add_u32 v205, 0x10000, v202
    s_lshl_b32 s62, s66, 12
    v_add_u32 v206, s62, v208
    v_add_u32 v207, 0x10000, v206
    v_and_b32 v220, 3, v182
    v_lshlrev_b32 v220, 4, v220
    v_mov_b32 v221, 0
    s_add_u32 s8, s4, 0
    s_addc_u32 s9, s5, 0
    s_mov_b32 s10, 18874368
    s_mov_b32 s11, 0x20000
    s_waitcnt lgkmcnt(0)
    s_sub_u32 s52, s52, 1792
    s_subb_u32 s53, s53, 0
    s_mov_b32 s54, 5310208
    s_mov_b32 s55, 0x20000
    v_readlane_b32 s43, v222, s45
    v_readlane_b32 s44, v223, s45
    s_add_u32 s45, s45, 1
nosetup_5:
    s_mov_b32 s50, 0
    s_movk_i32 s60, 5120
    .p2align 6
gated_mix__ssm_conv_s4d__geglu_ffn__prompt_kernel_loop:
    s_waitcnt lgkmcnt(4)
    v_mfma_f32_32x32x16_bf16 v[0:15], v[128:131], a[0:3], 0
    ds_read_b64_tr_b16 v[144:145], v168 offset:4096
    v_mfma_f32_32x32x16_bf16 v[32:47], v[132:135], a[0:3], 0
    ds_read_b64_tr_b16 v[146:147], v168 offset:4608
    s_add_u32 m0, s25, 98304
    s_nop 0
    buffer_load_dwordx4 v171, s[12:15], s38 offen offset:0 lds
    v_mfma_f32_32x32x16_bf16 v[48:63], v[132:135], a[4:7], 0
    ds_read_b64_tr_b16 v[148:149], v168 offset:12288
    v_mfma_f32_32x32x16_bf16 v[16:31], v[128:131], a[4:7], 0
    ds_read_b64_tr_b16 v[150:151], v168 offset:12800
    buffer_load_dwordx4 v172, s[12:15], s38 offen offset:1024 lds
    s_waitcnt lgkmcnt(4)
    v_mfma_f32_32x32x16_bf16 v[0:15], v[136:139], a[8:11], v[0:15]
    ds_read_b64_tr_b16 v[128:129], v168 offset:6144
    v_mfma_f32_32x32x16_bf16 v[32:47], v[140:143], a[8:11], v[32:47]
    ds_read_b64_tr_b16 v[130:131], v168 offset:6656
    buffer_load_dwordx4 v173, s[12:15], s38 offen offset:2048 lds
    v_mfma_f32_32x32x16_bf16 v[48:63], v[140:143], a[12:15], v[48:63]
    ds_read_b64_tr_b16 v[132:133], v168 offset:14336
    v_mfma_f32_32x32x16_bf16 v[16:31], v[136:139], a[12:15], v[16:31]
    ds_read_b64_tr_b16 v[134:135], v168 offset:14848
    buffer_load_dwordx4 v174, s[12:15], s38 offen offset:3072 lds
    s_waitcnt lgkmcnt(4)
    v_mfma_f32_32x32x16_bf16 v[0:15], v[144:147], a[16:19], v[0:15]
    ds_read_b64_tr_b16 v[136:137], v168 offset:16384
    v_mfma_f32_32x32x16_bf16 v[32:47], v[148:151], a[16:19], v[32:47]
    ds_read_b64_tr_b16 v[138:139], v168 offset:16896
    s_add_u32 m0, s25, 114688
    s_nop 0
    buffer_load_dwordx4 v171, s[12:15], s39 offen offset:0 lds
    v_mfma_f32_32x32x16_bf16 v[48:63], v[148:151], a[20:23], v[48:63]
    ds_read_b64_tr_b16 v[140:141], v168 offset:24576
    v_mfma_f32_32x32x16_bf16 v[16:31], v[144:147], a[20:23], v[16:31]
    ds_read_b64_tr_b16 v[142:143], v168 offset:25088
    buffer_load_dwordx4 v172, s[12:15], s39 offen offset:1024 lds
    s_waitcnt lgkmcnt(4)
    v_mfma_f32_32x32x16_bf16 v[0:15], v[128:131], a[24:27], v[0:15]
    ds_read_b64_tr_b16 v[144:145], v168 offset:18432
    v_mfma_f32_32x32x16_bf16 v[32:47], v[132:135], a[24:27], v[32:47]
    ds_read_b64_tr_b16 v[146:147], v168 offset:18944
    buffer_load_dwordx4 v173, s[12:15], s39 offen offset:2048 lds
    v_mfma_f32_32x32x16_bf16 v[48:63], v[132:135], a[28:31], v[48:63]
    ds_read_b64_tr_b16 v[148:149], v168 offset:26624
    v_mfma_f32_32x32x16_bf16 v[16:31], v[128:131], a[28:31], v[16:31]
    ds_read_b64_tr_b16 v[150:151], v168 offset:27136
    buffer_load_dwordx4 v174, s[12:15], s39 offen offset:3072 lds
    s_waitcnt lgkmcnt(4)
    v_mfma_f32_32x32x16_bf16 v[0:15], v[136:139], a[32:35], v[0:15]
    ds_read_b64_tr_b16 v[128:129], v168 offset:20480
    v_mfma_f32_32x32x16_bf16 v[32:47], v[140:143], a[32:35], v[32:47]
    ds_read_b64_tr_b16 v[130:131], v168 offset:20992
    s_add_u32 m0, s25, 131072
    s_nop 0
    buffer_load_dwordx4 v171, s[12:15], s40 offen offset:0 lds
    v_mfma_f32_32x32x16_bf16 v[48:63], v[140:143], a[36:39], v[48:63]
    ds_read_b64_tr_b16 v[132:133], v168 offset:28672
    v_mfma_f32_32x32x16_bf16 v[16:31], v[136:139], a[36:39], v[16:31]
    ds_read_b64_tr_b16 v[134:135], v168 offset:29184
    buffer_load_dwordx4 v172, s[12:15], s40 offen offset:1024 lds
    s_waitcnt lgkmcnt(4)
    v_mfma_f32_32x32x16_bf16 v[0:15], v[144:147], a[40:43], v[0:15]
    ds_read_b64_tr_b16 v[136:137], v168 offset:22528
    v_mul_f32 v152, v64, v64
    v_mul_f32 v153, v65, v65
    v_mul_f32 v154, v66, v66
    v_mfma_f32_32x32x16_bf16 v[32:47], v[148:151], a[40:43], v[32:47]
    ds_read_b64_tr_b16 v[138:139], v168 offset:23040
    buffer_load_dwordx4 v173, s[12:15], s40 offen offset:2048 lds
    v_mul_f32 v155, v67, v67
    v_fma_f32 v152, v152, v180, v181
    v_mfma_f32_32x32x16_bf16 v[48:63], v[148:151], a[44:47], v[48:63]
    ds_read_b64_tr_b16 v[140:141], v168 offset:30720
    v_fma_f32 v153, v153, v180, v181
    v_fma_f32 v154, v154, v180, v181
    v_fma_f32 v155, v155, v180, v181
    v_mfma_f32_32x32x16_bf16 v[16:31], v[144:147], a[44:47], v[16:31]
    ds_read_b64_tr_b16 v[142:143], v168 offset:31232
    buffer_load_dwordx4 v174, s[12:15], s40 offen offset:3072 lds
    v_mul_f32 v152, v152, v64
    v_mul_f32 v153, v153, v65
    s_waitcnt lgkmcnt(4)
    s_cmp_eq_u32 s24, 1
    s_cbranch_scc0 nofl_6
    s_add_u32 s62, s61, 6144
    buffer_load_dwordx4 v[192:195], v185, s[56:59], s62 offen sc0 sc1
nofl_6:
    v_mfma_f32_32x32x16_bf16 v[0:15], v[128:131], a[48:51], v[0:15]
    ds_read_b64_tr_b16 v[144:145], v168 offset:32768
    v_mul_f32 v154, v154, v66
    v_mul_f32 v155, v155, v67
    v_exp_f32 v152, v152
    v_mfma_f32_32x32x16_bf16 v[32:47], v[132:135], a[48:51], v[32:47]
    ds_read_b64_tr_b16 v[146:147], v168 offset:33280
    v_exp_f32 v153, v153
    v_mfma_f32_32x32x16_bf16 v[48:63], v[132:135], a[52:55], v[48:63]
    ds_read_b64_tr_b16 v[148:149], v168 offset:40960
    v_exp_f32 v154, v154
    v_exp_f32 v155, v155
    v_mfma_f32_32x32x16_bf16 v[16:31], v[128:131], a[52:55], v[16:31]
    ds_read_b64_tr_b16 v[150:151], v168 offset:41472
    v_mul_f32 v156, v64, v96
    v_mul_f32 v157, v65, v97
    v_mul_f32 v158, v66, v98
    v_mul_f32 v159, v67, v99
    s_waitcnt lgkmcnt(4)
    v_mfma_f32_32x32x16_bf16 v[0:15], v[136:139], a[56:59], v[0:15]
    ds_read_b64_tr_b16 v[128:129], v168 offset:34816
    v_add_f32 v152, 1.0, v152
    v_add_f32 v153, 1.0, v153
    v_add_f32 v154, 1.0, v154
    v_mfma_f32_32x32x16_bf16 v[32:47], v[140:143], a[56:59], v[32:47]
    ds_read_b64_tr_b16 v[130:131], v168 offset:35328
    v_add_f32 v155, 1.0, v155
    v_rcp_f32 v152, v152
    v_mfma_f32_32x32x16_bf16 v[48:63], v[140:143], a[60:63], v[48:63]
    ds_read_b64_tr_b16 v[132:133], v168 offset:43008
    v_rcp_f32 v153, v153
    v_rcp_f32 v154, v154
    v_mfma_f32_32x32x16_bf16 v[16:31], v[136:139], a[60:63], v[16:31]
    ds_read_b64_tr_b16 v[134:135], v168 offset:43520
    v_rcp_f32 v155, v155
    v_mul_f32 v156, v156, v152
    s_waitcnt lgkmcnt(4)
    v_mfma_f32_32x32x16_bf16 v[0:15], v[144:147], a[64:67], v[0:15]
    ds_read_b64_tr_b16 v[136:137], v168 offset:36864
    v_mul_f32 v157, v157, v153
    v_mul_f32 v158, v158, v154
    v_mul_f32 v159, v159, v155
    v_cvt_pk_bf16_f32 v160, v156, v157
    v_mfma_f32_32x32x16_bf16 v[32:47], v[148:151], a[64:67], v[32:47]
    ds_read_b64_tr_b16 v[138:139], v168 offset:37376
    v_cvt_pk_bf16_f32 v161, v158, v159
    v_mul_f32 v152, v68, v68
    v_mul_f32 v153, v69, v69
    v_mfma_f32_32x32x16_bf16 v[48:63], v[148:151], a[68:71], v[48:63]
    ds_read_b64_tr_b16 v[140:141], v168 offset:45056
    v_mul_f32 v154, v70, v70
    v_mul_f32 v155, v71, v71
    v_fma_f32 v152, v152, v180, v181
    v_mfma_f32_32x32x16_bf16 v[16:31], v[144:147], a[68:71], v[16:31]
    ds_read_b64_tr_b16 v[142:143], v168 offset:45568
    v_fma_f32 v153, v153, v180, v181
    v_fma_f32 v154, v154, v180, v181
    v_fma_f32 v155, v155, v180, v181
    s_waitcnt lgkmcnt(4)
    v_mfma_f32_32x32x16_bf16 v[0:15], v[128:131], a[72:75], v[0:15]
    ds_read_b64_tr_b16 v[144:145], v168 offset:38912
    v_mul_f32 v152, v152, v68
    v_mul_f32 v153, v153, v69
    v_mul_f32 v154, v154, v70
    v_mfma_f32_32x32x16_bf16 v[32:47], v[132:135], a[72:75], v[32:47]
    ds_read_b64_tr_b16 v[146:147], v168 offset:39424
    v_mul_f32 v155, v155, v71
    v_exp_f32 v152, v152
    v_mfma_f32_32x32x16_bf16 v[48:63], v[132:135], a[76:79], v[48:63]
    ds_read_b64_tr_b16 v[148:149], v168 offset:47104
    v_exp_f32 v153, v153
    v_exp_f32 v154, v154
    v_mfma_f32_32x32x16_bf16 v[16:31], v[128:131], a[76:79], v[16:31]
    ds_read_b64_tr_b16 v[150:151], v168 offset:47616
    v_exp_f32 v155, v155
    v_mul_f32 v156, v68, v100
    s_waitcnt lgkmcnt(4)
    v_mfma_f32_32x32x16_bf16 v[0:15], v[136:139], a[80:83], v[0:15]
    ds_read_b64_tr_b16 v[128:129], v168 offset:49152
    v_mul_f32 v157, v69, v101
    v_mul_f32 v158, v70, v102
    v_mul_f32 v159, v71, v103
    v_add_f32 v152, 1.0, v152
    v_mfma_f32_32x32x16_bf16 v[32:47], v[140:143], a[80:83], v[32:47]
    ds_read_b64_tr_b16 v[130:131], v168 offset:49664
    v_add_f32 v153, 1.0, v153
    v_add_f32 v154, 1.0, v154
    v_add_f32 v155, 1.0, v155
    v_mfma_f32_32x32x16_bf16 v[48:63], v[140:143], a[84:87], v[48:63]
    ds_read_b64_tr_b16 v[132:133], v168 offset:57344
    v_rcp_f32 v152, v152
    v_rcp_f32 v153, v153
    v_mfma_f32_32x32x16_bf16 v[16:31], v[136:139], a[84:87], v[16:31]
    ds_read_b64_tr_b16 v[134:135], v168 offset:57856
    v_rcp_f32 v154, v154
    v_rcp_f32 v155, v155
    s_waitcnt vmcnt(8) lgkmcnt(4)
    s_waitcnt vmcnt(0)
    s_barrier
    s_add_u32 s12, s12, 128
    s_addc_u32 s13, s13, 0
    s_sub_u32 s14, s14, 128
    s_cmp_eq_u32 s24, 1
    s_cselect_b32 s14, 0, s14
    s_cselect_b32 s50, 1, 0
    s_cmp_eq_u32 s31, 4
    s_cselect_b32 s50, s50, 0
    s_cmp_eq_u32 s24, s31
    s_cbranch_scc0 nsf_7
    s_cmp_eq_u32 s20, 0
    s_cbranch_scc0 nsf_7
    s_lshl_b32 s62, s2, 2
    s_add_u32 s62, s62, 5120
    v_mov_b32 v186, s65
    s_mov_b64 exec, 1
    buffer_store_dword v186, v185, s[56:59], s62 offen sc0 sc1
    s_mov_b64 exec, -1
nsf_7:
    s_cmp_eq_u32 s31, 4
    s_cbranch_scc0 hf01_8
    s_cmp_le_u32 s24, 2
    s_cbranch_scc0 hf01_8
    s_cmp_eq_u32 s20, 0
    s_cbranch_scc0 hf01_8
    s_cmp_eq_u32 s24, 2
    s_cselect_b32 s62, 6144, 0
    s_add_u32 s62, s62, s64
    v_mov_b32 v186, s65
    s_mov_b64 exec, 1
    buffer_store_dword v186, v185, s[56:59], s62 offen sc0 sc1
    s_mov_b64 exec, -1
hf01_8:
    s_cmp_eq_u32 s50, 1
    s_cbranch_scc0 noearly_9
    s_lshl_b32 s25, s20, 12
    s_add_u32 s25, s25, 0x28000
    v_xor_b32 v214, s65, v192
    v_xor_b32 v215, s65, v193
    v_or_b32 v214, v214, v215
    v_xor_b32 v215, s65, v194
    v_or_b32 v214, v214, v215
    v_cmp_ne_u32 vcc, 0, v214
    s_cbranch_vccz gated_mix__ssm_conv_s4d__geglu_ffn__prompt_kernel_ok_10
    s_add_u32 s62, s61, 6144
    s_mov_b32 s63, 0x40000
gated_mix__ssm_conv_s4d__geglu_ffn__prompt_kernel_poll3_11:
    buffer_load_dwordx4 v[196:199], v221, s[56:59], s62 offen sc0 sc1
    s_waitcnt vmcnt(0)
    v_xor_b32 v196, s65, v196
    v_xor_b32 v197, s65, v197
    v_xor_b32 v198, s65, v198
    v_or3_b32 v196, v196, v197, v198
    v_cmp_ne_u32 vcc, 0, v196
    s_cbranch_vccz gated_mix__ssm_conv_s4d__geglu_ffn__prompt_kernel_pd3_12
    s_sleep 4
    s_sub_u32 s63, s63, 1
    s_cmp_lg_u32 s63, 0
    s_cbranch_scc1 gated_mix__ssm_conv_s4d__geglu_ffn__prompt_kernel_poll3_11
gated_mix__ssm_conv_s4d__geglu_ffn__prompt_kernel_pd3_12:
gated_mix__ssm_conv_s4d__geglu_ffn__prompt_kernel_ok_10:
    s_add_u32 m0, s41, 0
    s_nop 0
    buffer_load_dwordx4 v208, s[8:11], s43 offen sc1 lds
    buffer_load_dwordx4 v208, s[8:11], s43 offen offset:1024 sc1 lds
    s_add_u32 m0, s42, 0
    s_nop 0
    buffer_load_dwordx4 v209, s[52:55], s44 offen offset:0 lds
    buffer_load_dwordx4 v210, s[52:55], s44 offen offset:1024 lds
    buffer_load_dwordx4 v211, s[52:55], s44 offen offset:2048 lds
    v_readlane_b32 s43, v222, s45
    v_readlane_b32 s44, v223, s45
    s_add_u32 s45, s45, 1
    s_nop 2
    s_add_u32 m0, s41, 20480
    s_nop 0
    buffer_load_dwordx4 v208, s[8:11], s43 offen sc1 lds
    buffer_load_dwordx4 v208, s[8:11], s43 offen offset:1024 sc1 lds
    s_add_u32 m0, s42, 20480
    s_nop 0
    buffer_load_dwordx4 v209, s[52:55], s44 offen offset:0 lds
    buffer_load_dwordx4 v210, s[52:55], s44 offen offset:1024 lds
    buffer_load_dwordx4 v211, s[52:55], s44 offen offset:2048 lds
    v_readlane_b32 s43, v222, s45
    v_readlane_b32 s44, v223, s45
    s_add_u32 s45, s45, 1
    s_nop 2
noearly_9:
    v_mfma_f32_32x32x16_bf16 v[0:15], v[144:147], a[88:91], v[0:15]
    ds_read_b64_tr_b16 v[136:137], v168 offset:51200
    v_mul_f32 v156, v156, v152
    v_mul_f32 v157, v157, v153
    v_mul_f32 v158, v158, v154
    v_mfma_f32_32x32x16_bf16 v[32:47], v[148:151], a[88:91], v[32:47]
    ds_read_b64_tr_b16 v[138:139], v168 offset:51712
    s_add_u32 m0, s25, 0
    s_nop 0
    buffer_load_dwordx4 v171, s[12:15], s32 offen offset:0 lds
    v_mfma_f32_32x32x16_bf16 v[48:63], v[148:151], a[92:95], v[48:63]
    ds_read_b64_tr_b16 v[140:141], v168 offset:59392
    v_mul_f32 v159, v159, v155
    v_cvt_pk_bf16_f32 v162, v156, v157
    v_cvt_pk_bf16_f32 v163, v158, v159
    v_mfma_f32_32x32x16_bf16 v[16:31], v[144:147], a[92:95], v[16:31]
    ds_read_b64_tr_b16 v[142:143], v168 offset:59904
    buffer_load_dwordx4 v172, s[12:15], s32 offen offset:1024 lds
    s_waitcnt lgkmcnt(4)
    v_mfma_f32_32x32x16_bf16 v[0:15], v[128:131], a[96:99], v[0:15]
    ds_read_b64_tr_b16 v[144:145], v168 offset:53248
    buffer_store_dwordx4 v[160:163], v179, s[16:19], s27 offen offset:0 sc1
    v_mul_f32 v152, v72, v72
    v_mfma_f32_32x32x16_bf16 v[32:47], v[132:135], a[96:99], v[32:47]
    ds_read_b64_tr_b16 v[146:147], v168 offset:53760
    buffer_load_dwordx4 v173, s[12:15], s32 offen offset:2048 lds
    v_mul_f32 v153, v73, v73
    v_mul_f32 v154, v74, v74
    v_mfma_f32_32x32x16_bf16 v[48:63], v[132:135], a[100:103], v[48:63]
    ds_read_b64_tr_b16 v[148:149], v168 offset:61440
    v_mul_f32 v155, v75, v75
    v_fma_f32 v152, v152, v180, v181
    v_fma_f32 v153, v153, v180, v181
    v_mfma_f32_32x32x16_bf16 v[16:31], v[128:131], a[100:103], v[16:31]
    ds_read_b64_tr_b16 v[150:151], v168 offset:61952
    buffer_load_dwordx4 v174, s[12:15], s32 offen offset:3072 lds
    v_fma_f32 v154, v154, v180, v181
    s_waitcnt lgkmcnt(4)
    v_mfma_f32_32x32x16_bf16 v[0:15], v[136:139], a[104:107], v[0:15]
    ds_read_b64_tr_b16 v[128:129], v168 offset:55296
    v_fma_f32 v155, v155, v180, v181
    v_mul_f32 v152, v152, v72
    v_mul_f32 v153, v153, v73
    v_mul_f32 v154, v154, v74
    v_mfma_f32_32x32x16_bf16 v[32:47], v[140:143], a[104:107], v[32:47]
    ds_read_b64_tr_b16 v[130:131], v168 offset:55808
    s_add_u32 m0, s25, 16384
    s_nop 0
    buffer_load_dwordx4 v171, s[12:15], s33 offen offset:0 lds
    v_mfma_f32_32x32x16_bf16 v[48:63], v[140:143], a[108:111], v[48:63]
    ds_read_b64_tr_b16 v[132:133], v168 offset:63488
    v_mul_f32 v155, v155, v75
    v_exp_f32 v152, v152
    v_mfma_f32_32x32x16_bf16 v[16:31], v[136:139], a[108:111], v[16:31]
    ds_read_b64_tr_b16 v[134:135], v168 offset:64000
    v_exp_f32 v153, v153
    v_exp_f32 v154, v154
    s_waitcnt lgkmcnt(4)
    v_mfma_f32_32x32x16_bf16 v[0:15], v[144:147], a[112:115], v[0:15]
    ds_read_b64_tr_b16 v[136:137], v169 offset:0
    v_exp_f32 v155, v155
    v_mul_f32 v156, v72, v104
    v_mul_f32 v157, v73, v105
    v_mfma_f32_32x32x16_bf16 v[32:47], v[148:151], a[112:115], v[32:47]
    ds_read_b64_tr_b16 v[138:139], v169 offset:512
    buffer_load_dwordx4 v172, s[12:15], s33 offen offset:1024 lds
    v_mul_f32 v158, v74, v106
    v_mul_f32 v159, v75, v107
    v_mfma_f32_32x32x16_bf16 v[48:63], v[148:151], a[116:119], v[48:63]
    ds_read_b64_tr_b16 v[140:141], v169 offset:8192
    v_add_f32 v152, 1.0, v152
    v_add_f32 v153, 1.0, v153
    v_add_f32 v154, 1.0, v154
    v_mfma_f32_32x32x16_bf16 v[16:31], v[144:147], a[116:119], v[16:31]
    ds_read_b64_tr_b16 v[142:143], v169 offset:8704
    v_add_f32 v155, 1.0, v155
    v_rcp_f32 v152, v152
    s_waitcnt lgkmcnt(4)
    v_mfma_f32_32x32x16_bf16 v[0:15], v[128:131], a[120:123], v[0:15]
    ds_read_b64_tr_b16 v[144:145], v169 offset:2048
    v_rcp_f32 v153, v153
    v_rcp_f32 v154, v154
    v_mfma_f32_32x32x16_bf16 v[32:47], v[132:135], a[120:123], v[32:47]
    ds_read_b64_tr_b16 v[146:147], v169 offset:2560
    buffer_load_dwordx4 v173, s[12:15], s33 offen offset:2048 lds
    v_rcp_f32 v155, v155
    v_mfma_f32_32x32x16_bf16 v[48:63], v[132:135], a[124:127], v[48:63]
    ds_read_b64_tr_b16 v[148:149], v169 offset:10240
    v_mul_f32 v156, v156, v152
    v_mul_f32 v157, v157, v153
    v_mul_f32 v158, v158, v154
    v_mul_f32 v159, v159, v155
    v_mfma_f32_32x32x16_bf16 v[16:31], v[128:131], a[124:127], v[16:31]
    ds_read_b64_tr_b16 v[150:151], v169 offset:10752
    v_cvt_pk_bf16_f32 v164, v156, v157
    v_cvt_pk_bf16_f32 v165, v158, v159
    s_waitcnt lgkmcnt(4)
    v_mfma_f32_32x32x16_bf16 v[0:15], v[136:139], a[128:131], v[0:15]
    ds_read_b64_tr_b16 v[128:129], v169 offset:4096
    v_mul_f32 v152, v76, v76
    v_mul_f32 v153, v77, v77
    v_mul_f32 v154, v78, v78
    v_mul_f32 v155, v79, v79
    v_mfma_f32_32x32x16_bf16 v[32:47], v[140:143], a[128:131], v[32:47]
    ds_read_b64_tr_b16 v[130:131], v169 offset:4608
    buffer_load_dwordx4 v174, s[12:15], s33 offen offset:3072 lds
    v_fma_f32 v152, v152, v180, v181
    v_fma_f32 v153, v153, v180, v181
    v_mfma_f32_32x32x16_bf16 v[48:63], v[140:143], a[132:135], v[48:63]
    ds_read_b64_tr_b16 v[132:133], v169 offset:12288
    v_fma_f32 v154, v154, v180, v181
    v_fma_f32 v155, v155, v180, v181
    v_mfma_f32_32x32x16_bf16 v[16:31], v[136:139], a[132:135], v[16:31]
    ds_read_b64_tr_b16 v[134:135], v169 offset:12800
    v_mul_f32 v152, v152, v76
    v_mul_f32 v153, v153, v77
    v_mul_f32 v154, v154, v78
    v_mul_f32 v155, v155, v79
    s_waitcnt lgkmcnt(4)
    s_cmp_eq_u32 s24, 1
    s_cbranch_scc0 nofl_13
    buffer_load_dwordx4 v[196:199], v179, s[56:59], s60 offen sc0 sc1
nofl_13:
    v_mfma_f32_32x32x16_bf16 v[0:15], v[144:147], a[136:139], v[0:15]
    ds_read_b64_tr_b16 v[136:137], v169 offset:6144
    v_exp_f32 v152, v152
    v_exp_f32 v153, v153
    v_mfma_f32_32x32x16_bf16 v[32:47], v[148:151], a[136:139], v[32:47]
    ds_read_b64_tr_b16 v[138:139], v169 offset:6656
    s_add_u32 m0, s25, 32768
    s_nop 0
    buffer_load_dwordx4 v171, s[12:15], s34 offen offset:0 lds
    v_mfma_f32_32x32x16_bf16 v[48:63], v[148:151], a[140:143], v[48:63]
    ds_read_b64_tr_b16 v[140:141], v169 offset:14336
    v_exp_f32 v154, v154
    v_exp_f32 v155, v155
    v_mfma_f32_32x32x16_bf16 v[16:31], v[144:147], a[140:143], v[16:31]
    ds_read_b64_tr_b16 v[142:143], v169 offset:14848
    v_mul_f32 v156, v76, v108
    v_mul_f32 v157, v77, v109
    v_mul_f32 v158, v78, v110
    s_waitcnt lgkmcnt(4)
    v_mfma_f32_32x32x16_bf16 v[0:15], v[128:131], a[144:147], v[0:15]
    ds_read_b64_tr_b16 v[144:145], v169 offset:16384
    v_mul_f32 v159, v79, v111
    v_add_f32 v152, 1.0, v152
    v_add_f32 v153, 1.0, v153
    v_mfma_f32_32x32x16_bf16 v[32:47], v[132:135], a[144:147], v[32:47]
    ds_read_b64_tr_b16 v[146:147], v169 offset:16896
    buffer_load_dwordx4 v172, s[12:15], s34 offen offset:1024 lds
    v_add_f32 v154, 1.0, v154
    v_add_f32 v155, 1.0, v155
    v_mfma_f32_32x32x16_bf16 v[48:63], v[132:135], a[148:151], v[48:63]
    ds_read_b64_tr_b16 v[148:149], v169 offset:24576
    v_rcp_f32 v152, v152
    v_rcp_f32 v153, v153
    v_mfma_f32_32x32x16_bf16 v[16:31], v[128:131], a[148:151], v[16:31]
    ds_read_b64_tr_b16 v[150:151], v169 offset:25088
    v_rcp_f32 v154, v154
    v_rcp_f32 v155, v155
    s_waitcnt lgkmcnt(4)
    v_mfma_f32_32x32x16_bf16 v[0:15], v[136:139], a[152:155], v[0:15]
    ds_read_b64_tr_b16 v[128:129], v169 offset:18432
    v_mul_f32 v156, v156, v152
    v_mul_f32 v157, v157, v153
    v_mul_f32 v158, v158, v154
    v_mfma_f32_32x32x16_bf16 v[32:47], v[140:143], a[152:155], v[32:47]
    ds_read_b64_tr_b16 v[130:131], v169 offset:18944
    buffer_load_dwordx4 v173, s[12:15], s34 offen offset:2048 lds
    v_mul_f32 v159, v159, v155
    v_cvt_pk_bf16_f32 v166, v156, v157
    v_mfma_f32_32x32x16_bf16 v[48:63], v[140:143], a[156:159], v[48:63]
    ds_read_b64_tr_b16 v[132:133], v169 offset:26624
    v_cvt_pk_bf16_f32 v167, v158, v159
    v_mfma_f32_32x32x16_bf16 v[16:31], v[136:139], a[156:159], v[16:31]
    ds_read_b64_tr_b16 v[134:135], v169 offset:27136
    buffer_store_dwordx4 v[164:167], v179, s[16:19], s27 offen offset:1024 sc1
    s_waitcnt lgkmcnt(4)
    v_mfma_f32_32x32x16_bf16 v[0:15], v[144:147], a[160:163], v[0:15]
    ds_read_b64_tr_b16 v[136:137], v169 offset:20480
    v_mul_f32 v152, v80, v80
    v_mul_f32 v153, v81, v81
    v_mul_f32 v154, v82, v82
    v_mfma_f32_32x32x16_bf16 v[32:47], v[148:151], a[160:163], v[32:47]
    ds_read_b64_tr_b16 v[138:139], v169 offset:20992
    buffer_load_dwordx4 v174, s[12:15], s34 offen offset:3072 lds
    v_mul_f32 v155, v83, v83
    v_fma_f32 v152, v152, v180, v181
    v_mfma_f32_32x32x16_bf16 v[48:63], v[148:151], a[164:167], v[48:63]
    ds_read_b64_tr_b16 v[140:141], v169 offset:28672
    v_fma_f32 v153, v153, v180, v181
    v_fma_f32 v154, v154, v180, v181
    v_fma_f32 v155, v155, v180, v181
    v_mfma_f32_32x32x16_bf16 v[16:31], v[144:147], a[164:167], v[16:31]
    ds_read_b64_tr_b16 v[142:143], v169 offset:29184
    v_mul_f32 v152, v152, v80
    v_mul_f32 v153, v153, v81
    v_mul_f32 v154, v154, v82
    s_waitcnt lgkmcnt(4)
    v_mfma_f32_32x32x16_bf16 v[0:15], v[128:131], a[168:171], v[0:15]
    ds_read_b64_tr_b16 v[144:145], v169 offset:22528
    v_mul_f32 v155, v155, v83
    v_exp_f32 v152, v152
    v_mfma_f32_32x32x16_bf16 v[32:47], v[132:135], a[168:171], v[32:47]
    ds_read_b64_tr_b16 v[146:147], v169 offset:23040
    v_exp_f32 v153, v153
    v_exp_f32 v154, v154
    v_mfma_f32_32x32x16_bf16 v[48:63], v[132:135], a[172:175], v[48:63]
    ds_read_b64_tr_b16 v[148:149], v169 offset:30720
    v_exp_f32 v155, v155
    v_mul_f32 v156, v80, v112
    v_mul_f32 v157, v81, v113
    v_mfma_f32_32x32x16_bf16 v[16:31], v[128:131], a[172:175], v[16:31]
    ds_read_b64_tr_b16 v[150:151], v169 offset:31232
    v_mul_f32 v158, v82, v114
    v_mul_f32 v159, v83, v115
    v_add_f32 v152, 1.0, v152
    s_waitcnt lgkmcnt(4)
    v_mfma_f32_32x32x16_bf16 v[0:15], v[136:139], a[176:179], v[0:15]
    ds_read_b64_tr_b16 v[128:129], v169 offset:32768
    v_add_f32 v153, 1.0, v153
    v_add_f32 v154, 1.0, v154
    v_add_f32 v155, 1.0, v155
    v_mfma_f32_32x32x16_bf16 v[32:47], v[140:143], a[176:179], v[32:47]
    ds_read_b64_tr_b16 v[130:131], v169 offset:33280
    v_rcp_f32 v152, v152
    v_rcp_f32 v153, v153
    v_mfma_f32_32x32x16_bf16 v[48:63], v[140:143], a[180:183], v[48:63]
    ds_read_b64_tr_b16 v[132:133], v169 offset:40960
    v_rcp_f32 v154, v154
    v_rcp_f32 v155, v155
    v_mfma_f32_32x32x16_bf16 v[16:31], v[136:139], a[180:183], v[16:31]
    ds_read_b64_tr_b16 v[134:135], v169 offset:41472
    v_mul_f32 v156, v156, v152
    v_mul_f32 v157, v157, v153
    v_mul_f32 v158, v158, v154
    s_cmp_eq_u32 s50, 1
    s_cbranch_scc1 altw_14
    s_waitcnt vmcnt(9) lgkmcnt(4)
    s_branch altj_15
altw_14:
    s_waitcnt lgkmcnt(4)
altj_15:
    s_barrier
    s_cmp_eq_u32 s50, 1
    s_cbranch_scc0 noearly2_16
    s_add_u32 m0, s41, 40960
    s_nop 0
    buffer_load_dwordx4 v208, s[8:11], s43 offen sc1 lds
    buffer_load_dwordx4 v208, s[8:11], s43 offen offset:1024 sc1 lds
    s_add_u32 m0, s42, 40960
    s_nop 0
    buffer_load_dwordx4 v209, s[52:55], s44 offen offset:0 lds
    buffer_load_dwordx4 v210, s[52:55], s44 offen offset:1024 lds
    buffer_load_dwordx4 v211, s[52:55], s44 offen offset:2048 lds
    v_readlane_b32 s43, v222, s45
    v_readlane_b32 s44, v223, s45
    s_add_u32 s45, s45, 1
    s_nop 2
    s_add_u32 m0, s41, 61440
    s_nop 0
    buffer_load_dwordx4 v208, s[8:11], s43 offen sc1 lds
    buffer_load_dwordx4 v208, s[8:11], s43 offen offset:1024 sc1 lds
    s_add_u32 m0, s42, 61440
    s_nop 0
    buffer_load_dwordx4 v209, s[52:55], s44 offen offset:0 lds
    buffer_load_dwordx4 v210, s[52:55], s44 offen offset:1024 lds
    buffer_load_dwordx4 v211, s[52:55], s44 offen offset:2048 lds
    v_readlane_b32 s43, v222, s45
    v_readlane_b32 s44, v223, s45
    s_add_u32 s45, s45, 1
    s_nop 2
noearly2_16:
    v_mfma_f32_32x32x16_bf16 v[0:15], v[144:147], a[184:187], v[0:15]
    ds_read_b64_tr_b16 v[136:137], v169 offset:34816
    v_mul_f32 v159, v159, v155
    v_cvt_pk_bf16_f32 v160, v156, v157
    v_cvt_pk_bf16_f32 v161, v158, v159
    v_mfma_f32_32x32x16_bf16 v[32:47], v[148:151], a[184:187], v[32:47]
    ds_read_b64_tr_b16 v[138:139], v169 offset:35328
    s_add_u32 m0, s25, 49152
    s_nop 0
    buffer_load_dwordx4 v171, s[12:15], s35 offen offset:0 lds
    v_mfma_f32_32x32x16_bf16 v[48:63], v[148:151], a[188:191], v[48:63]
    ds_read_b64_tr_b16 v[140:141], v169 offset:43008
    v_mul_f32 v152, v84, v84
    v_mul_f32 v153, v85, v85
    v_mul_f32 v154, v86, v86
    v_mul_f32 v155, v87, v87
    v_mfma_f32_32x32x16_bf16 v[16:31], v[144:147], a[188:191], v[16:31]
    ds_read_b64_tr_b16 v[142:143], v169 offset:43520
    buffer_load_dwordx4 v172, s[12:15], s35 offen offset:1024 lds
    v_fma_f32 v152, v152, v180, v181
    v_fma_f32 v153, v153, v180, v181
    s_waitcnt lgkmcnt(4)
    v_mfma_f32_32x32x16_bf16 v[0:15], v[128:131], a[192:195], v[0:15]
    ds_read_b64_tr_b16 v[144:145], v169 offset:36864
    v_fma_f32 v154, v154, v180, v181
    v_fma_f32 v155, v155, v180, v181
    v_mfma_f32_32x32x16_bf16 v[32:47], v[132:135], a[192:195], v[32:47]
    ds_read_b64_tr_b16 v[146:147], v169 offset:37376
    buffer_load_dwordx4 v173, s[12:15], s35 offen offset:2048 lds
    v_mul_f32 v152, v152, v84
    v_mul_f32 v153, v153, v85
    v_mfma_f32_32x32x16_bf16 v[48:63], v[132:135], a[196:199], v[48:63]
    ds_read_b64_tr_b16 v[148:149], v169 offset:45056
    v_mul_f32 v154, v154, v86
    v_mul_f32 v155, v155, v87
    v_exp_f32 v152, v152
    v_mfma_f32_32x32x16_bf16 v[16:31], v[128:131], a[196:199], v[16:31]
    ds_read_b64_tr_b16 v[150:151], v169 offset:45568
    buffer_load_dwordx4 v174, s[12:15], s35 offen offset:3072 lds
    v_exp_f32 v153, v153
    s_waitcnt lgkmcnt(4)
    v_mfma_f32_32x32x16_bf16 v[0:15], v[136:139], a[200:203], v[0:15]
    ds_read_b64_tr_b16 v[128:129], v169 offset:38912
    v_exp_f32 v154, v154
    v_exp_f32 v155, v155
    v_mfma_f32_32x32x16_bf16 v[32:47], v[140:143], a[200:203], v[32:47]
    ds_read_b64_tr_b16 v[130:131], v169 offset:39424
    s_add_u32 m0, s25, 65536
    s_nop 0
    buffer_load_dwordx4 v171, s[12:15], s36 offen offset:0 lds
    v_mfma_f32_32x32x16_bf16 v[48:63], v[140:143], a[204:207], v[48:63]
    ds_read_b64_tr_b16 v[132:133], v169 offset:47104
    v_mul_f32 v156, v84, v116
    v_mul_f32 v157, v85, v117
    v_mul_f32 v158, v86, v118
    v_mfma_f32_32x32x16_bf16 v[16:31], v[136:139], a[204:207], v[16:31]
    ds_read_b64_tr_b16 v[134:135], v169 offset:47616
    v_mul_f32 v159, v87, v119
    v_add_f32 v152, 1.0, v152
    v_add_f32 v153, 1.0, v153
    v_add_f32 v154, 1.0, v154
    s_waitcnt lgkmcnt(4)
    v_mfma_f32_32x32x16_bf16 v[0:15], v[144:147], a[208:211], v[0:15]
    ds_read_b64_tr_b16 v[136:137], v169 offset:49152
    v_add_f32 v155, 1.0, v155
    v_rcp_f32 v152, v152
    v_mfma_f32_32x32x16_bf16 v[32:47], v[148:151], a[208:211], v[32:47]
    ds_read_b64_tr_b16 v[138:139], v169 offset:49664
    buffer_load_dwordx4 v172, s[12:15], s36 offen offset:1024 lds
    v_rcp_f32 v153, v153
    v_mfma_f32_32x32x16_bf16 v[48:63], v[148:151], a[212:215], v[48:63]
    ds_read_b64_tr_b16 v[140:141], v169 offset:57344
    v_rcp_f32 v154, v154
    v_rcp_f32 v155, v155
    v_mfma_f32_32x32x16_bf16 v[16:31], v[144:147], a[212:215], v[16:31]
    ds_read_b64_tr_b16 v[142:143], v169 offset:57856
    v_mul_f32 v156, v156, v152
    v_mul_f32 v157, v157, v153
    v_mul_f32 v158, v158, v154
    s_waitcnt lgkmcnt(4)
    v_mfma_f32_32x32x16_bf16 v[0:15], v[128:131], a[216:219], v[0:15]
    ds_read_b64_tr_b16 v[144:145], v169 offset:51200
    v_mul_f32 v159, v159, v155
    v_cvt_pk_bf16_f32 v162, v156, v157
    v_cvt_pk_bf16_f32 v163, v158, v159
    v_mfma_f32_32x32x16_bf16 v[32:47], v[132:135], a[216:219], v[32:47]
    ds_read_b64_tr_b16 v[146:147], v169 offset:51712
    buffer_load_dwordx4 v173, s[12:15], s36 offen offset:2048 lds
    v_mfma_f32_32x32x16_bf16 v[48:63], v[132:135], a[220:223], v[48:63]
    ds_read_b64_tr_b16 v[148:149], v169 offset:59392
    buffer_store_dwordx4 v[160:163], v179, s[16:19], s28 offen offset:0 sc1
    v_mul_f32 v152, v88, v88
    v_mfma_f32_32x32x16_bf16 v[16:31], v[128:131], a[220:223], v[16:31]
    ds_read_b64_tr_b16 v[150:151], v169 offset:59904
    v_mul_f32 v153, v89, v89
    v_mul_f32 v154, v90, v90
    v_mul_f32 v155, v91, v91
    s_waitcnt lgkmcnt(4)
    v_mfma_f32_32x32x16_bf16 v[0:15], v[136:139], a[224:227], v[0:15]
    ds_read_b64_tr_b16 v[128:129], v169 offset:53248
    v_fma_f32 v152, v152, v180, v181
    v_fma_f32 v153, v153, v180, v181
    v_fma_f32 v154, v154, v180, v181
    v_mfma_f32_32x32x16_bf16 v[32:47], v[140:143], a[224:227], v[32:47]
    ds_read_b64_tr_b16 v[130:131], v169 offset:53760
    buffer_load_dwordx4 v174, s[12:15], s36 offen offset:3072 lds
    v_fma_f32 v155, v155, v180, v181
    v_mul_f32 v152, v152, v88
    v_mfma_f32_32x32x16_bf16 v[48:63], v[140:143], a[228:231], v[48:63]
    ds_read_b64_tr_b16 v[132:133], v169 offset:61440
    v_mul_f32 v153, v153, v89
    v_mul_f32 v154, v154, v90
    v_mul_f32 v155, v155, v91
    v_mfma_f32_32x32x16_bf16 v[16:31], v[136:139], a[228:231], v[16:31]
    ds_read_b64_tr_b16 v[134:135], v169 offset:61952
    v_exp_f32 v152, v152
    v_exp_f32 v153, v153
    s_waitcnt lgkmcnt(4)
    v_mfma_f32_32x32x16_bf16 v[0:15], v[144:147], a[232:235], v[0:15]
    ds_read_b64_tr_b16 v[136:137], v169 offset:55296
    v_exp_f32 v154, v154
    v_mfma_f32_32x32x16_bf16 v[32:47], v[148:151], a[232:235], v[32:47]
    ds_read_b64_tr_b16 v[138:139], v169 offset:55808
    s_add_u32 m0, s25, 81920
    s_nop 0
    buffer_load_dwordx4 v171, s[12:15], s37 offen offset:0 lds
    v_exp_f32 v155, v155
    v_mfma_f32_32x32x16_bf16 v[48:63], v[148:151], a[236:239], v[48:63]
    ds_read_b64_tr_b16 v[140:141], v169 offset:63488
    v_mul_f32 v156, v88, v120
    v_mul_f32 v157, v89, v121
    v_mul_f32 v158, v90, v122
    v_mfma_f32_32x32x16_bf16 v[16:31], v[144:147], a[236:239], v[16:31]
    ds_read_b64_tr_b16 v[142:143], v169 offset:64000
    v_mul_f32 v159, v91, v123
    v_add_f32 v152, 1.0, v152
    v_add_f32 v153, 1.0, v153
    s_waitcnt lgkmcnt(4)
    v_mfma_f32_32x32x16_bf16 v[0:15], v[128:131], a[240:243], v[0:15]
    ds_read_b64_tr_b16 v[144:145], v170 offset:0
    v_add_f32 v154, 1.0, v154
    v_add_f32 v155, 1.0, v155
    v_rcp_f32 v152, v152
    v_mfma_f32_32x32x16_bf16 v[32:47], v[132:135], a[240:243], v[32:47]
    ds_read_b64_tr_b16 v[146:147], v170 offset:512
    buffer_load_dwordx4 v172, s[12:15], s37 offen offset:1024 lds
    v_rcp_f32 v153, v153
    v_mfma_f32_32x32x16_bf16 v[48:63], v[132:135], a[244:247], v[48:63]
    ds_read_b64_tr_b16 v[148:149], v170 offset:8192
    v_rcp_f32 v154, v154
    v_rcp_f32 v155, v155
    v_mfma_f32_32x32x16_bf16 v[16:31], v[128:131], a[244:247], v[16:31]
    ds_read_b64_tr_b16 v[150:151], v170 offset:8704
    v_mul_f32 v156, v156, v152
    v_mul_f32 v157, v157, v153
    v_mul_f32 v158, v158, v154
    s_waitcnt lgkmcnt(4)
    v_mfma_f32_32x32x16_bf16 v[0:15], v[136:139], a[248:251], v[0:15]
    ds_read_b64_tr_b16 v[128:129], v170 offset:2048
    v_mul_f32 v159, v159, v155
    v_cvt_pk_bf16_f32 v164, v156, v157
    v_cvt_pk_bf16_f32 v165, v158, v159
    v_mfma_f32_32x32x16_bf16 v[32:47], v[140:143], a[248:251], v[32:47]
    ds_read_b64_tr_b16 v[130:131], v170 offset:2560
    buffer_load_dwordx4 v173, s[12:15], s37 offen offset:2048 lds
    v_mul_f32 v152, v92, v92
    v_mul_f32 v153, v93, v93
    v_mfma_f32_32x32x16_bf16 v[48:63], v[140:143], a[252:255], v[48:63]
    ds_read_b64_tr_b16 v[132:133], v170 offset:10240
    v_mul_f32 v154, v94, v94
    v_mul_f32 v155, v95, v95
    v_fma_f32 v152, v152, v180, v181
    v_mfma_f32_32x32x16_bf16 v[16:31], v[136:139], a[252:255], v[16:31]
    ds_read_b64_tr_b16 v[134:135], v170 offset:10752
    v_fma_f32 v153, v153, v180, v181
    v_fma_f32 v154, v154, v180, v181
    v_fma_f32 v155, v155, v180, v181
    s_waitcnt lgkmcnt(4)
    v_mfma_f32_32x32x16_bf16 v[0:15], v[144:147], v[224:227], v[0:15]
    ds_read_b64_tr_b16 v[136:137], v170 offset:4096
    v_mul_f32 v152, v152, v92
    v_mul_f32 v153, v153, v93
    v_mul_f32 v154, v154, v94
    v_mfma_f32_32x32x16_bf16 v[32:47], v[148:151], v[224:227], v[32:47]
    ds_read_b64_tr_b16 v[138:139], v170 offset:4608
    buffer_load_dwordx4 v174, s[12:15], s37 offen offset:3072 lds
    v_mul_f32 v155, v155, v95
    v_exp_f32 v152, v152
    v_mfma_f32_32x32x16_bf16 v[48:63], v[148:151], v[228:231], v[48:63]
    ds_read_b64_tr_b16 v[140:141], v170 offset:12288
    v_exp_f32 v153, v153
    v_mfma_f32_32x32x16_bf16 v[16:31], v[144:147], v[228:231], v[16:31]
    ds_read_b64_tr_b16 v[142:143], v170 offset:12800
    v_exp_f32 v154, v154
    v_exp_f32 v155, v155
    s_waitcnt lgkmcnt(4)
    v_mfma_f32_32x32x16_bf16 v[0:15], v[128:131], v[232:235], v[0:15]
    ds_read_b64_tr_b16 v[144:145], v170 offset:6144
    v_mul_f32 v156, v92, v124
    v_mul_f32 v157, v93, v125
    v_mul_f32 v158, v94, v126
    v_mfma_f32_32x32x16_bf16 v[32:47], v[132:135], v[232:235], v[32:47]
    ds_read_b64_tr_b16 v[146:147], v170 offset:6656
    v_mul_f32 v159, v95, v127
    v_add_f32 v152, 1.0, v152
    v_add_f32 v153, 1.0, v153
    v_add_f32 v154, 1.0, v154
    v_mfma_f32_32x32x16_bf16 v[48:63], v[132:135], v[236:239], v[48:63]
    ds_read_b64_tr_b16 v[148:149], v170 offset:14336
    v_add_f32 v155, 1.0, v155
    v_rcp_f32 v152, v152
    v_mfma_f32_32x32x16_bf16 v[16:31], v[128:131], v[236:239], v[16:31]
    ds_read_b64_tr_b16 v[150:151], v170 offset:14848
    v_rcp_f32 v153, v153
    v_rcp_f32 v154, v154
    s_waitcnt lgkmcnt(4)
    v_mfma_f32_32x32x16_bf16 v[0:15], v[136:139], v[240:243], v[0:15]
    ds_read_b64_tr_b16 v[128:129], v168 offset:0
    v_rcp_f32 v155, v155
    v_mul_f32 v156, v156, v152
    v_mfma_f32_32x32x16_bf16 v[32:47], v[140:143], v[240:243], v[32:47]
    ds_read_b64_tr_b16 v[130:131], v168 offset:512
    v_mul_f32 v157, v157, v153
    v_mul_f32 v158, v158, v154
    v_mul_f32 v159, v159, v155
    v_cvt_pk_bf16_f32 v166, v156, v157
    v_mfma_f32_32x32x16_bf16 v[48:63], v[140:143], v[244:247], v[48:63]
    ds_read_b64_tr_b16 v[132:133], v168 offset:8192
    v_cvt_pk_bf16_f32 v167, v158, v159
    v_mfma_f32_32x32x16_bf16 v[16:31], v[136:139], v[244:247], v[16:31]
    ds_read_b64_tr_b16 v[134:135], v168 offset:8704
    buffer_store_dwordx4 v[164:167], v179, s[16:19], s28 offen offset:1024 sc1
    s_cmp_eq_u32 s50, 1
    s_cbranch_scc1 altw_17
    s_waitcnt vmcnt(10) lgkmcnt(4)
    s_branch altj_18
altw_17:
    s_waitcnt lgkmcnt(4)
altj_18:
    s_barrier
    v_mfma_f32_32x32x16_bf16 v[64:79], v[144:147], v[248:251], v[0:15]
    ds_read_b64_tr_b16 v[136:137], v168 offset:2048
    v_mfma_f32_32x32x16_bf16 v[96:111], v[148:151], v[248:251], v[32:47]
    ds_read_b64_tr_b16 v[138:139], v168 offset:2560
    v_mfma_f32_32x32x16_bf16 v[112:127], v[148:151], v[252:255], v[48:63]
    ds_read_b64_tr_b16 v[140:141], v168 offset:10240
    v_mfma_f32_32x32x16_bf16 v[80:95], v[144:147], v[252:255], v[16:31]
    ds_read_b64_tr_b16 v[142:143], v168 offset:10752
    s_add_u32 s27, s27, 4096
    s_add_u32 s28, s28, 4096
    s_sub_u32 s24, s24, 1
    s_cmp_lg_u32 s24, 0
    s_cbranch_scc1 gated_mix__ssm_conv_s4d__geglu_ffn__prompt_kernel_loop
    s_waitcnt lgkmcnt(0)
    s_barrier
    s_lshr_b32 s62, s2, 3
    v_mov_b32 v168, 0
    s_cmp_ge_u32 s62, 24
    s_cbranch_scc1 gated_mix__ssm_conv_s4d__geglu_ffn__prompt_kernel_notg2
    s_add_u32 m0, s41, 81920
    s_nop 0
    buffer_load_dwordx4 v208, s[8:11], s43 offen sc1 lds
    buffer_load_dwordx4 v208, s[8:11], s43 offen offset:1024 sc1 lds
    s_add_u32 m0, s42, 81920
    s_nop 0
    buffer_load_dwordx4 v209, s[52:55], s44 offen offset:0 lds
    buffer_load_dwordx4 v210, s[52:55], s44 offen offset:1024 lds
    buffer_load_dwordx4 v211, s[52:55], s44 offen offset:2048 lds
    v_readlane_b32 s43, v222, s45
    v_readlane_b32 s44, v223, s45
    s_add_u32 s45, s45, 1
    s_waitcnt vmcnt(20)
    s_barrier
    ds_read_b128 v[12:15], v206 offset:0
    ds_read_b64_tr_b16 v[0:1], v200 offset:8192
    ds_read_b64_tr_b16 v[2:3], v200 offset:11264
    ds_read_b128 v[16:19], v206 offset:2048
    ds_read_b64_tr_b16 v[4:5], v201 offset:8192
    ds_read_b64_tr_b16 v[6:7], v201 offset:11264
    ds_read_b64_tr_b16 v[8:9], v202 offset:8192
    ds_read_b64_tr_b16 v[10:11], v202 offset:11264
    ds_read_b128 v[32:35], v206 offset:1024
    ds_read_b64_tr_b16 v[20:21], v200 offset:14336
    ds_read_b64_tr_b16 v[22:23], v200 offset:17408
    ds_read_b128 v[36:39], v206 offset:3072
    ds_read_b64_tr_b16 v[24:25], v201 offset:14336
    ds_read_b64_tr_b16 v[26:27], v201 offset:17408
    s_waitcnt vmcnt(15)
    s_barrier
    s_waitcnt lgkmcnt(11)
    v_mfma_f32_32x32x16_bf16 a[0:15], v[0:3], v[12:15], 0
    ds_read_b64_tr_b16 v[28:29], v202 offset:14336
    ds_read_b64_tr_b16 v[30:31], v202 offset:17408
    s_add_u32 m0, s41, 102400
    v_mul_f32 v152, v64, v64
    v_mul_f32 v153, v65, v65
    v_mul_f32 v154, v66, v66
    v_mul_f32 v155, v67, v67
    s_waitcnt lgkmcnt(12)
    v_mfma_f32_32x32x16_bf16 a[16:31], v[0:3], v[16:19], 0
    ds_read_b128 v[52:55], v206 offset:20480
    s_nop 0
    v_fma_f32 v152, v152, v180, v181
    v_fma_f32 v153, v153, v180, v181
    v_fma_f32 v154, v154, v180, v181
    v_fma_f32 v155, v155, v180, v181
    s_waitcnt lgkmcnt(11)
    v_mfma_f32_32x32x16_bf16 a[32:47], v[4:7], v[12:15], 0
    ds_read_b64_tr_b16 v[40:41], v200 offset:28672
    ds_read_b64_tr_b16 v[42:43], v200 offset:31744
    buffer_load_dwordx4 v208, s[8:11], s43 offen sc1 lds
    v_mul_f32 v152, v152, v64
    v_mul_f32 v153, v153, v65
    v_mul_f32 v154, v154, v66
    v_mul_f32 v155, v155, v67
    v_mfma_f32_32x32x16_bf16 a[48:63], v[4:7], v[16:19], 0
    ds_read_b128 v[56:59], v206 offset:22528
    buffer_load_dwordx4 v208, s[8:11], s43 offen offset:1024 sc1 lds
    v_exp_f32 v152, v152
    v_exp_f32 v153, v153
    v_exp_f32 v154, v154
    v_exp_f32 v155, v155
    s_waitcnt lgkmcnt(12)
    v_mfma_f32_32x32x16_bf16 a[64:79], v[8:11], v[12:15], 0
    ds_read_b64_tr_b16 v[44:45], v201 offset:28672
    s_add_u32 m0, s42, 102400
    v_mul_f32 v156, v64, v96
    v_mul_f32 v157, v65, v97
    v_mul_f32 v158, v66, v98
    v_mul_f32 v159, v67, v99
    v_mfma_f32_32x32x16_bf16 a[80:95], v[8:11], v[16:19], 0
    ds_read_b64_tr_b16 v[46:47], v201 offset:31744
    s_nop 0
    v_add_f32 v152, 1.0, v152
    v_add_f32 v153, 1.0, v153
    v_add_f32 v154, 1.0, v154
    v_add_f32 v155, 1.0, v155
    v_rcp_f32 v152, v152
    s_waitcnt lgkmcnt(11)
    v_mfma_f32_32x32x16_bf16 a[0:15], v[20:23], v[32:35], a[0:15]
    ds_read_b64_tr_b16 v[48:49], v202 offset:28672
    ds_read_b64_tr_b16 v[50:51], v202 offset:31744
    buffer_load_dwordx4 v209, s[52:55], s44 offen offset:0 lds
    v_rcp_f32 v153, v153
    v_rcp_f32 v154, v154
    v_rcp_f32 v155, v155
    v_mul_f32 v156, v156, v152
    s_waitcnt lgkmcnt(12)
    v_mfma_f32_32x32x16_bf16 a[16:31], v[20:23], v[36:39], a[16:31]
    ds_read_b128 v[12:15], v206 offset:21504
    buffer_load_dwordx4 v210, s[52:55], s44 offen offset:1024 lds
    v_mul_f32 v157, v157, v153
    v_mul_f32 v158, v158, v154
    v_mul_f32 v159, v159, v155
    v_cvt_pk_bf16_f32 v160, v156, v157
    s_waitcnt lgkmcnt(11)
    v_mfma_f32_32x32x16_bf16 a[32:47], v[24:27], v[32:35], a[32:47]
    ds_read_b64_tr_b16 v[0:1], v200 offset:34816
    ds_read_b64_tr_b16 v[2:3], v200 offset:37888
    buffer_load_dwordx4 v211, s[52:55], s44 offen offset:2048 lds
    v_cvt_pk_bf16_f32 v161, v158, v159
    v_mul_f32 v152, v68, v68
    v_mul_f32 v153, v69, v69
    v_mul_f32 v154, v70, v70
    v_mfma_f32_32x32x16_bf16 a[48:63], v[24:27], v[36:39], a[48:63]
    ds_read_b128 v[16:19], v206 offset:23552
    v_readlane_b32 s43, v222, s45
    v_mul_f32 v155, v71, v71
    v_fma_f32 v152, v152, v180, v181
    v_fma_f32 v153, v153, v180, v181
    v_fma_f32 v154, v154, v180, v181
    s_waitcnt lgkmcnt(12)
    v_mfma_f32_32x32x16_bf16 a[64:79], v[28:31], v[32:35], a[64:79]
    ds_read_b64_tr_b16 v[4:5], v201 offset:34816
    v_readlane_b32 s44, v223, s45
    v_fma_f32 v155, v155, v180, v181
    v_mul_f32 v152, v152, v68
    v_mul_f32 v153, v153, v69
    v_mul_f32 v154, v154, v70
    v_mul_f32 v155, v155, v71
    v_mfma_f32_32x32x16_bf16 a[80:95], v[28:31], v[36:39], a[80:95]
    ds_read_b64_tr_b16 v[6:7], v201 offset:37888
    s_add_u32 s45, s45, 1
    v_exp_f32 v152, v152
    v_exp_f32 v153, v153
    v_exp_f32 v154, v154
    v_exp_f32 v155, v155
    s_waitcnt vmcnt(15)
    s_barrier
    s_waitcnt lgkmcnt(11)
    v_mfma_f32_32x32x16_bf16 a[0:15], v[40:43], v[52:55], a[0:15]
    ds_read_b64_tr_b16 v[8:9], v202 offset:34816
    ds_read_b64_tr_b16 v[10:11], v202 offset:37888
    s_add_u32 m0, s41, 0
    v_mul_f32 v156, v68, v100
    v_mul_f32 v157, v69, v101
    v_mul_f32 v158, v70, v102
    v_mul_f32 v159, v71, v103
    s_waitcnt lgkmcnt(12)
    v_mfma_f32_32x32x16_bf16 a[16:31], v[40:43], v[56:59], a[16:31]
    ds_read_b128 v[32:35], v206 offset:40960
    s_nop 0
    v_add_f32 v152, 1.0, v152
    v_add_f32 v153, 1.0, v153
    v_add_f32 v154, 1.0, v154
    v_add_f32 v155, 1.0, v155
    s_waitcnt lgkmcnt(11)
    v_mfma_f32_32x32x16_bf16 a[32:47], v[44:47], v[52:55], a[32:47]
    ds_read_b64_tr_b16 v[20:21], v200 offset:49152
    ds_read_b64_tr_b16 v[22:23], v200 offset:52224
    buffer_load_dwordx4 v208, s[8:11], s43 offen sc1 lds
    v_rcp_f32 v152, v152
    v_rcp_f32 v153, v153
    v_rcp_f32 v154, v154
    v_rcp_f32 v155, v155
    v_mfma_f32_32x32x16_bf16 a[48:63], v[44:47], v[56:59], a[48:63]
    ds_read_b128 v[36:39], v206 offset:43008
    buffer_load_dwordx4 v208, s[8:11], s43 offen offset:1024 sc1 lds
    v_mul_f32 v156, v156, v152
    v_mul_f32 v157, v157, v153
    v_mul_f32 v158, v158, v154
    v_mul_f32 v159, v159, v155
    s_waitcnt lgkmcnt(12)
    v_mfma_f32_32x32x16_bf16 a[64:79], v[48:51], v[52:55], a[64:79]
    ds_read_b64_tr_b16 v[24:25], v201 offset:49152
    s_add_u32 m0, s42, 0
    v_cvt_pk_bf16_f32 v162, v156, v157
    v_cvt_pk_bf16_f32 v163, v158, v159
    buffer_store_dwordx4 v[160:163], v179, s[16:19], s27 offen offset:0 sc1
    v_mul_f32 v152, v72, v72
    v_mul_f32 v153, v73, v73
    v_mfma_f32_32x32x16_bf16 a[80:95], v[48:51], v[56:59], a[80:95]
    ds_read_b64_tr_b16 v[26:27], v201 offset:52224
    s_nop 0
    v_mul_f32 v154, v74, v74
    v_mul_f32 v155, v75, v75
    v_fma_f32 v152, v152, v180, v181
    v_fma_f32 v153, v153, v180, v181
    s_waitcnt lgkmcnt(11)
    v_mfma_f32_32x32x16_bf16 a[0:15], v[0:3], v[12:15], a[0:15]
    ds_read_b64_tr_b16 v[28:29], v202 offset:49152
    ds_read_b64_tr_b16 v[30:31], v202 offset:52224
    buffer_load_dwordx4 v209, s[52:55], s44 offen offset:0 lds
    v_fma_f32 v154, v154, v180, v181
    v_fma_f32 v155, v155, v180, v181
    v_mul_f32 v152, v152, v72
    v_mul_f32 v153, v153, v73
    s_waitcnt lgkmcnt(12)
    v_mfma_f32_32x32x16_bf16 a[16:31], v[0:3], v[16:19], a[16:31]
    ds_read_b128 v[52:55], v206 offset:41984
    buffer_load_dwordx4 v210, s[52:55], s44 offen offset:1024 lds
    v_mul_f32 v154, v154, v74
    v_mul_f32 v155, v155, v75
    v_exp_f32 v152, v152
    v_exp_f32 v153, v153
    s_waitcnt lgkmcnt(11)
    v_mfma_f32_32x32x16_bf16 a[32:47], v[4:7], v[12:15], a[32:47]
    ds_read_b64_tr_b16 v[40:41], v200 offset:55296
    ds_read_b64_tr_b16 v[42:43], v200 offset:58368
    buffer_load_dwordx4 v211, s[52:55], s44 offen offset:2048 lds
    v_exp_f32 v154, v154
    v_exp_f32 v155, v155
    v_mul_f32 v156, v72, v104
    v_mul_f32 v157, v73, v105
    v_mfma_f32_32x32x16_bf16 a[48:63], v[4:7], v[16:19], a[48:63]
    ds_read_b128 v[56:59], v206 offset:44032
    v_readlane_b32 s43, v222, s45
    v_mul_f32 v158, v74, v106
    v_mul_f32 v159, v75, v107
    v_add_f32 v152, 1.0, v152
    v_add_f32 v153, 1.0, v153
    v_add_f32 v154, 1.0, v154
    s_waitcnt lgkmcnt(12)
    v_mfma_f32_32x32x16_bf16 a[64:79], v[8:11], v[12:15], a[64:79]
    ds_read_b64_tr_b16 v[44:45], v201 offset:55296
    v_readlane_b32 s44, v223, s45
    v_add_f32 v155, 1.0, v155
    v_rcp_f32 v152, v152
    v_rcp_f32 v153, v153
    v_rcp_f32 v154, v154
    v_mfma_f32_32x32x16_bf16 a[80:95], v[8:11], v[16:19], a[80:95]
    ds_read_b64_tr_b16 v[46:47], v201 offset:58368
    s_add_u32 s45, s45, 1
    v_rcp_f32 v155, v155
    v_mul_f32 v156, v156, v152
    v_mul_f32 v157, v157, v153
    v_mul_f32 v158, v158, v154
    s_waitcnt vmcnt(16)
    s_barrier
    s_waitcnt lgkmcnt(11)
    v_mfma_f32_32x32x16_bf16 a[0:15], v[20:23], v[32:35], a[0:15]
    ds_read_b64_tr_b16 v[48:49], v202 offset:55296
    ds_read_b64_tr_b16 v[50:51], v202 offset:58368
    s_add_u32 m0, s41, 20480
    v_mul_f32 v159, v159, v155
    v_cvt_pk_bf16_f32 v164, v156, v157
    v_cvt_pk_bf16_f32 v165, v158, v159
    v_mul_f32 v152, v76, v76
    s_waitcnt lgkmcnt(12)
    v_mfma_f32_32x32x16_bf16 a[16:31], v[20:23], v[36:39], a[16:31]
    ds_read_b128 v[12:15], v206 offset:61440
    s_nop 0
    v_mul_f32 v153, v77, v77
    v_mul_f32 v154, v78, v78
    v_mul_f32 v155, v79, v79
    v_fma_f32 v152, v152, v180, v181
    s_waitcnt lgkmcnt(11)
    v_mfma_f32_32x32x16_bf16 a[32:47], v[24:27], v[32:35], a[32:47]
    ds_read_b64_tr_b16 v[0:1], v203 offset:4096
    ds_read_b64_tr_b16 v[2:3], v203 offset:7168
    buffer_load_dwordx4 v208, s[8:11], s43 offen sc1 lds
    v_fma_f32 v153, v153, v180, v181
    v_fma_f32 v154, v154, v180, v181
    v_fma_f32 v155, v155, v180, v181
    v_mul_f32 v152, v152, v76
    v_mfma_f32_32x32x16_bf16 a[48:63], v[24:27], v[36:39], a[48:63]
    ds_read_b128 v[16:19], v206 offset:63488
    buffer_load_dwordx4 v208, s[8:11], s43 offen offset:1024 sc1 lds
    v_mul_f32 v153, v153, v77
    v_mul_f32 v154, v154, v78
    v_mul_f32 v155, v155, v79
    v_exp_f32 v152, v152
    v_exp_f32 v153, v153
    s_waitcnt lgkmcnt(12)
    v_mfma_f32_32x32x16_bf16 a[64:79], v[28:31], v[32:35], a[64:79]
    ds_read_b64_tr_b16 v[4:5], v204 offset:4096
    s_add_u32 m0, s42, 20480
    v_exp_f32 v154, v154
    v_exp_f32 v155, v155
    v_mul_f32 v156, v76, v108
    v_mul_f32 v157, v77, v109
    v_mfma_f32_32x32x16_bf16 a[80:95], v[28:31], v[36:39], a[80:95]
    ds_read_b64_tr_b16 v[6:7], v204 offset:7168
    s_nop 0
    v_mul_f32 v158, v78, v110
    v_mul_f32 v159, v79, v111
    v_add_f32 v152, 1.0, v152
    v_add_f32 v153, 1.0, v153
    s_waitcnt lgkmcnt(11)
    v_mfma_f32_32x32x16_bf16 a[0:15], v[40:43], v[52:55], a[0:15]
    ds_read_b64_tr_b16 v[8:9], v205 offset:4096
    ds_read_b64_tr_b16 v[10:11], v205 offset:7168
    buffer_load_dwordx4 v209, s[52:55], s44 offen offset:0 lds
    v_add_f32 v154, 1.0, v154
    v_add_f32 v155, 1.0, v155
    v_rcp_f32 v152, v152
    v_rcp_f32 v153, v153
    s_waitcnt lgkmcnt(12)
    v_mfma_f32_32x32x16_bf16 a[16:31], v[40:43], v[56:59], a[16:31]
    ds_read_b128 v[32:35], v206 offset:62464
    buffer_load_dwordx4 v210, s[52:55], s44 offen offset:1024 lds
    v_rcp_f32 v154, v154
    v_rcp_f32 v155, v155
    v_mul_f32 v156, v156, v152
    v_mul_f32 v157, v157, v153
    s_waitcnt lgkmcnt(11)
    v_mfma_f32_32x32x16_bf16 a[32:47], v[44:47], v[52:55], a[32:47]
    ds_read_b64_tr_b16 v[20:21], v203 offset:10240
    ds_read_b64_tr_b16 v[22:23], v203 offset:13312
    buffer_load_dwordx4 v211, s[52:55], s44 offen offset:2048 lds
    v_mul_f32 v158, v158, v154
    v_mul_f32 v159, v159, v155
    v_cvt_pk_bf16_f32 v166, v156, v157
    v_cvt_pk_bf16_f32 v167, v158, v159
    buffer_store_dwordx4 v[164:167], v179, s[16:19], s27 offen offset:1024 sc1
    v_mfma_f32_32x32x16_bf16 a[48:63], v[44:47], v[56:59], a[48:63]
    ds_read_b128 v[36:39], v206 offset:64512
    v_readlane_b32 s43, v222, s45
    v_mul_f32 v152, v80, v80
    v_mul_f32 v153, v81, v81
    v_mul_f32 v154, v82, v82
    v_mul_f32 v155, v83, v83
    s_waitcnt lgkmcnt(12)
    v_mfma_f32_32x32x16_bf16 a[64:79], v[48:51], v[52:55], a[64:79]
    ds_read_b64_tr_b16 v[24:25], v204 offset:10240
    v_readlane_b32 s44, v223, s45
    v_fma_f32 v152, v152, v180, v181
    v_fma_f32 v153, v153, v180, v181
    v_fma_f32 v154, v154, v180, v181
    v_fma_f32 v155, v155, v180, v181
    v_mfma_f32_32x32x16_bf16 a[80:95], v[48:51], v[56:59], a[80:95]
    ds_read_b64_tr_b16 v[26:27], v204 offset:13312
    s_add_u32 s45, s45, 1
    v_mul_f32 v152, v152, v80
    v_mul_f32 v153, v153, v81
    v_mul_f32 v154, v154, v82
    v_mul_f32 v155, v155, v83
    s_waitcnt vmcnt(17)
    s_barrier
    s_add_u32 s62, s61, 0
    buffer_load_dwordx4 v[216:219], v221, s[56:59], s62 offen sc0 sc1
    s_waitcnt lgkmcnt(11)
    v_mfma_f32_32x32x16_bf16 a[0:15], v[0:3], v[12:15], a[0:15]
    ds_read_b64_tr_b16 v[28:29], v205 offset:10240
    ds_read_b64_tr_b16 v[30:31], v205 offset:13312
    s_add_u32 m0, s41, 40960
    v_exp_f32 v152, v152
    v_exp_f32 v153, v153
    v_exp_f32 v154, v154
    v_exp_f32 v155, v155
    s_waitcnt lgkmcnt(12)
    v_mfma_f32_32x32x16_bf16 a[16:31], v[0:3], v[16:19], a[16:31]
    ds_read_b128 v[52:55], v207 offset:16384
    s_nop 0
    v_mul_f32 v156, v80, v112
    v_mul_f32 v157, v81, v113
    v_mul_f32 v158, v82, v114
    v_mul_f32 v159, v83, v115
    s_waitcnt lgkmcnt(11)
    v_mfma_f32_32x32x16_bf16 a[32:47], v[4:7], v[12:15], a[32:47]
    ds_read_b64_tr_b16 v[40:41], v203 offset:24576
    ds_read_b64_tr_b16 v[42:43], v203 offset:27648
    buffer_load_dwordx4 v208, s[8:11], s43 offen sc1 lds
    v_add_f32 v152, 1.0, v152
    v_add_f32 v153, 1.0, v153
    v_add_f32 v154, 1.0, v154
    v_add_f32 v155, 1.0, v155
    v_rcp_f32 v152, v152
    v_mfma_f32_32x32x16_bf16 a[48:63], v[4:7], v[16:19], a[48:63]
    ds_read_b128 v[56:59], v207 offset:18432
    buffer_load_dwordx4 v208, s[8:11], s43 offen offset:1024 sc1 lds
    v_rcp_f32 v153, v153
    v_rcp_f32 v154, v154
    v_rcp_f32 v155, v155
    v_mul_f32 v156, v156, v152
    s_waitcnt lgkmcnt(12)
    v_mfma_f32_32x32x16_bf16 a[64:79], v[8:11], v[12:15], a[64:79]
    ds_read_b64_tr_b16 v[44:45], v204 offset:24576
    s_add_u32 m0, s42, 40960
    v_mul_f32 v157, v157, v153
    v_mul_f32 v158, v158, v154
    v_mul_f32 v159, v159, v155
    v_cvt_pk_bf16_f32 v160, v156, v157
    v_mfma_f32_32x32x16_bf16 a[80:95], v[8:11], v[16:19], a[80:95]
    ds_read_b64_tr_b16 v[46:47], v204 offset:27648
    s_nop 0
    v_cvt_pk_bf16_f32 v161, v158, v159
    v_mul_f32 v152, v84, v84
    v_mul_f32 v153, v85, v85
    v_mul_f32 v154, v86, v86
    s_waitcnt lgkmcnt(11)
    v_mfma_f32_32x32x16_bf16 a[0:15], v[20:23], v[32:35], a[0:15]
    ds_read_b64_tr_b16 v[48:49], v205 offset:24576
    ds_read_b64_tr_b16 v[50:51], v205 offset:27648
    buffer_load_dwordx4 v209, s[52:55], s44 offen offset:0 lds
    v_mul_f32 v155, v87, v87
    v_fma_f32 v152, v152, v180, v181
    v_fma_f32 v153, v153, v180, v181
    v_fma_f32 v154, v154, v180, v181
    s_waitcnt lgkmcnt(12)
    v_mfma_f32_32x32x16_bf16 a[16:31], v[20:23], v[36:39], a[16:31]
    ds_read_b128 v[12:15], v207 offset:17408
    buffer_load_dwordx4 v210, s[52:55], s44 offen offset:1024 lds
    v_fma_f32 v155, v155, v180, v181
    v_mul_f32 v152, v152, v84
    v_mul_f32 v153, v153, v85
    v_mul_f32 v154, v154, v86
    v_mul_f32 v155, v155, v87
    s_waitcnt lgkmcnt(11)
    v_mfma_f32_32x32x16_bf16 a[32:47], v[24:27], v[32:35], a[32:47]
    ds_read_b64_tr_b16 v[0:1], v203 offset:30720
    ds_read_b64_tr_b16 v[2:3], v203 offset:33792
    buffer_load_dwordx4 v211, s[52:55], s44 offen offset:2048 lds
    v_exp_f32 v152, v152
    v_exp_f32 v153, v153
    v_exp_f32 v154, v154
    v_exp_f32 v155, v155
    v_mfma_f32_32x32x16_bf16 a[48:63], v[24:27], v[36:39], a[48:63]
    ds_read_b128 v[16:19], v207 offset:19456
    v_readlane_b32 s43, v222, s45
    v_mul_f32 v156, v84, v116
    v_mul_f32 v157, v85, v117
    v_mul_f32 v158, v86, v118
    v_mul_f32 v159, v87, v119
    s_waitcnt lgkmcnt(12)
    v_mfma_f32_32x32x16_bf16 a[64:79], v[28:31], v[32:35], a[64:79]
    ds_read_b64_tr_b16 v[4:5], v204 offset:30720
    v_readlane_b32 s44, v223, s45
    v_add_f32 v152, 1.0, v152
    v_add_f32 v153, 1.0, v153
    v_add_f32 v154, 1.0, v154
    v_add_f32 v155, 1.0, v155
    v_mfma_f32_32x32x16_bf16 a[80:95], v[28:31], v[36:39], a[80:95]
    ds_read_b64_tr_b16 v[6:7], v204 offset:33792
    s_add_u32 s45, s45, 1
    v_rcp_f32 v152, v152
    v_rcp_f32 v153, v153
    v_rcp_f32 v154, v154
    v_rcp_f32 v155, v155
    s_waitcnt vmcnt(18)
    s_barrier
    s_waitcnt lgkmcnt(11)
    v_mfma_f32_32x32x16_bf16 a[0:15], v[40:43], v[52:55], a[0:15]
    ds_read_b64_tr_b16 v[8:9], v205 offset:30720
    ds_read_b64_tr_b16 v[10:11], v205 offset:33792
    s_add_u32 m0, s41, 61440
    v_mul_f32 v156, v156, v152
    v_mul_f32 v157, v157, v153
    v_mul_f32 v158, v158, v154
    v_mul_f32 v159, v159, v155
    s_waitcnt lgkmcnt(12)
    v_mfma_f32_32x32x16_bf16 a[16:31], v[40:43], v[56:59], a[16:31]
    ds_read_b128 v[32:35], v207 offset:36864
    s_nop 0
    v_cvt_pk_bf16_f32 v162, v156, v157
    v_cvt_pk_bf16_f32 v163, v158, v159
    buffer_store_dwordx4 v[160:163], v179, s[16:19], s28 offen offset:0 sc1
    v_mul_f32 v152, v88, v88
    v_mul_f32 v153, v89, v89
    s_waitcnt lgkmcnt(11)
    v_mfma_f32_32x32x16_bf16 a[32:47], v[44:47], v[52:55], a[32:47]
    ds_read_b64_tr_b16 v[20:21], v203 offset:45056
    ds_read_b64_tr_b16 v[22:23], v203 offset:48128
    buffer_load_dwordx4 v208, s[8:11], s43 offen sc1 lds
    v_mul_f32 v154, v90, v90
    v_mul_f32 v155, v91, v91
    v_fma_f32 v152, v152, v180, v181
    v_fma_f32 v153, v153, v180, v181
    v_mfma_f32_32x32x16_bf16 a[48:63], v[44:47], v[56:59], a[48:63]
    ds_read_b128 v[36:39], v207 offset:38912
    buffer_load_dwordx4 v208, s[8:11], s43 offen offset:1024 sc1 lds
    v_fma_f32 v154, v154, v180, v181
    v_fma_f32 v155, v155, v180, v181
    v_mul_f32 v152, v152, v88
    v_mul_f32 v153, v153, v89
    s_waitcnt lgkmcnt(12)
    v_mfma_f32_32x32x16_bf16 a[64:79], v[48:51], v[52:55], a[64:79]
    ds_read_b64_tr_b16 v[24:25], v204 offset:45056
    s_add_u32 m0, s42, 61440
    v_mul_f32 v154, v154, v90
    v_mul_f32 v155, v155, v91
    v_exp_f32 v152, v152
    v_exp_f32 v153, v153
    v_mfma_f32_32x32x16_bf16 a[80:95], v[48:51], v[56:59], a[80:95]
    ds_read_b64_tr_b16 v[26:27], v204 offset:48128
    s_nop 0
    v_exp_f32 v154, v154
    v_exp_f32 v155, v155
    v_mul_f32 v156, v88, v120
    v_mul_f32 v157, v89, v121
    s_waitcnt lgkmcnt(11)
    v_mfma_f32_32x32x16_bf16 a[0:15], v[0:3], v[12:15], a[0:15]
    ds_read_b64_tr_b16 v[28:29], v205 offset:45056
    ds_read_b64_tr_b16 v[30:31], v205 offset:48128
    buffer_load_dwordx4 v209, s[52:55], s44 offen offset:0 lds
    v_mul_f32 v158, v90, v122
    v_mul_f32 v159, v91, v123
    v_add_f32 v152, 1.0, v152
    v_add_f32 v153, 1.0, v153
    v_add_f32 v154, 1.0, v154
    s_waitcnt lgkmcnt(12)
    v_mfma_f32_32x32x16_bf16 a[16:31], v[0:3], v[16:19], a[16:31]
    ds_read_b128 v[52:55], v207 offset:37888
    buffer_load_dwordx4 v210, s[52:55], s44 offen offset:1024 lds
    v_add_f32 v155, 1.0, v155
    v_rcp_f32 v152, v152
    v_rcp_f32 v153, v153
    v_rcp_f32 v154, v154
    s_waitcnt lgkmcnt(11)
    v_mfma_f32_32x32x16_bf16 a[32:47], v[4:7], v[12:15], a[32:47]
    ds_read_b64_tr_b16 v[40:41], v203 offset:51200
    ds_read_b64_tr_b16 v[42:43], v203 offset:54272
    buffer_load_dwordx4 v211, s[52:55], s44 offen offset:2048 lds
    v_rcp_f32 v155, v155
    v_mul_f32 v156, v156, v152
    v_mul_f32 v157, v157, v153
    v_mul_f32 v158, v158, v154
    v_mfma_f32_32x32x16_bf16 a[48:63], v[4:7], v[16:19], a[48:63]
    ds_read_b128 v[56:59], v207 offset:39936
    v_readlane_b32 s43, v222, s45
    v_mul_f32 v159, v159, v155
    v_cvt_pk_bf16_f32 v164, v156, v157
    v_cvt_pk_bf16_f32 v165, v158, v159
    v_mul_f32 v152, v92, v92
    s_waitcnt lgkmcnt(12)
    v_mfma_f32_32x32x16_bf16 a[64:79], v[8:11], v[12:15], a[64:79]
    ds_read_b64_tr_b16 v[44:45], v204 offset:51200
    v_readlane_b32 s44, v223, s45
    v_mul_f32 v153, v93, v93
    v_mul_f32 v154, v94, v94
    v_mul_f32 v155, v95, v95
    v_fma_f32 v152, v152, v180, v181
    v_mfma_f32_32x32x16_bf16 a[80:95], v[8:11], v[16:19], a[80:95]
    ds_read_b64_tr_b16 v[46:47], v204 offset:54272
    s_add_u32 s45, s45, 1
    v_fma_f32 v153, v153, v180, v181
    v_fma_f32 v154, v154, v180, v181
    v_fma_f32 v155, v155, v180, v181
    v_mul_f32 v152, v152, v92
    s_waitcnt vmcnt(18)
    s_barrier
    s_waitcnt lgkmcnt(11)
    v_mfma_f32_32x32x16_bf16 a[0:15], v[20:23], v[32:35], a[0:15]
    ds_read_b64_tr_b16 v[48:49], v205 offset:51200
    ds_read_b64_tr_b16 v[50:51], v205 offset:54272
    s_add_u32 m0, s41, 81920
    v_mul_f32 v153, v153, v93
    v_mul_f32 v154, v154, v94
    v_mul_f32 v155, v155, v95
    v_exp_f32 v152, v152
    v_exp_f32 v153, v153
    s_waitcnt lgkmcnt(12)
    v_mfma_f32_32x32x16_bf16 a[16:31], v[20:23], v[36:39], a[16:31]
    ds_read_b128 v[12:15], v206 offset:0
    s_nop 0
    v_exp_f32 v154, v154
    v_exp_f32 v155, v155
    v_mul_f32 v156, v92, v124
    v_mul_f32 v157, v93, v125
    s_waitcnt lgkmcnt(11)
    v_mfma_f32_32x32x16_bf16 a[32:47], v[24:27], v[32:35], a[32:47]
    ds_read_b64_tr_b16 v[0:1], v200 offset:8192
    ds_read_b64_tr_b16 v[2:3], v200 offset:11264
    buffer_load_dwordx4 v208, s[8:11], s43 offen sc1 lds
    v_mul_f32 v158, v94, v126
    v_mul_f32 v159, v95, v127
    v_add_f32 v152, 1.0, v152
    v_add_f32 v153, 1.0, v153
    v_mfma_f32_32x32x16_bf16 a[48:63], v[24:27], v[36:39], a[48:63]
    ds_read_b128 v[16:19], v206 offset:2048
    buffer_load_dwordx4 v208, s[8:11], s43 offen offset:1024 sc1 lds
    v_add_f32 v154, 1.0, v154
    v_add_f32 v155, 1.0, v155
    v_rcp_f32 v152, v152
    v_rcp_f32 v153, v153
    s_waitcnt lgkmcnt(12)
    v_mfma_f32_32x32x16_bf16 a[64:79], v[28:31], v[32:35], a[64:79]
    ds_read_b64_tr_b16 v[4:5], v201 offset:8192
    s_add_u32 m0, s42, 81920
    v_rcp_f32 v154, v154
    v_rcp_f32 v155, v155
    v_mul_f32 v156, v156, v152
    v_mul_f32 v157, v157, v153
    v_mfma_f32_32x32x16_bf16 a[80:95], v[28:31], v[36:39], a[80:95]
    ds_read_b64_tr_b16 v[6:7], v201 offset:11264
    s_nop 0
    v_mul_f32 v158, v158, v154
    v_mul_f32 v159, v159, v155
    v_cvt_pk_bf16_f32 v166, v156, v157
    v_cvt_pk_bf16_f32 v167, v158, v159
    buffer_store_dwordx4 v[164:167], v179, s[16:19], s28 offen offset:1024 sc1
    s_waitcnt lgkmcnt(11)
    v_mfma_f32_32x32x16_bf16 a[0:15], v[40:43], v[52:55], a[0:15]
    ds_read_b64_tr_b16 v[8:9], v202 offset:8192
    ds_read_b64_tr_b16 v[10:11], v202 offset:11264
    buffer_load_dwordx4 v209, s[52:55], s44 offen offset:0 lds
    s_waitcnt lgkmcnt(12)
    v_mfma_f32_32x32x16_bf16 a[16:31], v[40:43], v[56:59], a[16:31]
    ds_read_b128 v[32:35], v206 offset:1024
    buffer_load_dwordx4 v210, s[52:55], s44 offen offset:1024 lds
    s_waitcnt lgkmcnt(11)
    v_mfma_f32_32x32x16_bf16 a[32:47], v[44:47], v[52:55], a[32:47]
    ds_read_b64_tr_b16 v[20:21], v200 offset:14336
    ds_read_b64_tr_b16 v[22:23], v200 offset:17408
    buffer_load_dwordx4 v211, s[52:55], s44 offen offset:2048 lds
    v_mfma_f32_32x32x16_bf16 a[48:63], v[44:47], v[56:59], a[48:63]
    ds_read_b128 v[36:39], v206 offset:3072
    v_readlane_b32 s43, v222, s45
    s_waitcnt lgkmcnt(12)
    v_mfma_f32_32x32x16_bf16 a[64:79], v[48:51], v[52:55], a[64:79]
    ds_read_b64_tr_b16 v[24:25], v201 offset:14336
    v_readlane_b32 s44, v223, s45
    v_mfma_f32_32x32x16_bf16 a[80:95], v[48:51], v[56:59], a[80:95]
    ds_read_b64_tr_b16 v[26:27], v201 offset:17408
    s_add_u32 s45, s45, 1
    s_waitcnt vmcnt(17)
    v_xor_b32 v214, s65, v216
    v_xor_b32 v215, s65, v217
    v_or_b32 v214, v214, v215
    v_xor_b32 v215, s65, v218
    v_or_b32 v214, v214, v215
    v_xor_b32 v215, s65, v219
    v_or_b32 v214, v214, v215
    v_cmp_ne_u32 vcc, 0, v214
    s_cbranch_vccz gated_mix__ssm_conv_s4d__geglu_ffn__prompt_kernel_ok_19
    s_add_u32 s62, s61, 0
    s_mov_b32 s63, 0x40000
gated_mix__ssm_conv_s4d__geglu_ffn__prompt_kernel_poll_20:
    buffer_load_dwordx4 v[228:231], v221, s[56:59], s62 offen sc0 sc1
    s_waitcnt vmcnt(0)
    v_xor_b32 v228, s65, v228
    v_xor_b32 v229, s65, v229
    v_xor_b32 v230, s65, v230
    v_xor_b32 v231, s65, v231
    v_or3_b32 v228, v228, v229, v230
    v_or_b32 v228, v228, v231
    v_cmp_ne_u32 vcc, 0, v228
    s_cbranch_vccz gated_mix__ssm_conv_s4d__geglu_ffn__prompt_kernel_pd_21
    s_sleep 10
    s_sub_u32 s63, s63, 1
    s_cmp_lg_u32 s63, 0
    s_cbranch_scc1 gated_mix__ssm_conv_s4d__geglu_ffn__prompt_kernel_poll_20
gated_mix__ssm_conv_s4d__geglu_ffn__prompt_kernel_pd_21:
gated_mix__ssm_conv_s4d__geglu_ffn__prompt_kernel_ok_19:
    s_mov_b32 s67, 5
    .p2align 6
gated_mix__ssm_conv_s4d__geglu_ffn__prompt_kernel_g2loop:
    s_waitcnt vmcnt(15)
    s_barrier
    s_cmp_eq_u32 s67, 3
    s_cbranch_scc0 nochk_22
    s_waitcnt vmcnt(15)
    v_xor_b32 v214, s65, v216
    v_xor_b32 v215, s65, v217
    v_or_b32 v214, v214, v215
    v_xor_b32 v215, s65, v218
    v_or_b32 v214, v214, v215
    v_xor_b32 v215, s65, v219
    v_or_b32 v214, v214, v215
    v_cmp_ne_u32 vcc, 0, v214
    s_cbranch_vccz gated_mix__ssm_conv_s4d__geglu_ffn__prompt_kernel_ok_23
    s_lshl_b32 s62, s61, 2
    s_add_u32 s62, s62, 12288
    s_mov_b32 s63, 0x40000
gated_mix__ssm_conv_s4d__geglu_ffn__prompt_kernel_poll_24:
    buffer_load_dwordx4 v[228:231], v220, s[56:59], s62 offen sc0 sc1
    s_waitcnt vmcnt(0)
    v_xor_b32 v228, s65, v228
    v_xor_b32 v229, s65, v229
    v_xor_b32 v230, s65, v230
    v_xor_b32 v231, s65, v231
    v_or3_b32 v228, v228, v229, v230
    v_or_b32 v228, v228, v231
    v_cmp_ne_u32 vcc, 0, v228
    s_cbranch_vccz gated_mix__ssm_conv_s4d__geglu_ffn__prompt_kernel_pd_25
    s_sleep 10
    s_sub_u32 s63, s63, 1
    s_cmp_lg_u32 s63, 0
    s_cbranch_scc1 gated_mix__ssm_conv_s4d__geglu_ffn__prompt_kernel_poll_24
gated_mix__ssm_conv_s4d__geglu_ffn__prompt_kernel_pd_25:
gated_mix__ssm_conv_s4d__geglu_ffn__prompt_kernel_ok_23:
nochk_22:
    s_waitcnt lgkmcnt(11)
    v_mfma_f32_32x32x16_bf16 a[0:15], v[0:3], v[12:15], a[0:15]
    ds_read_b64_tr_b16 v[28:29], v202 offset:14336
    ds_read_b64_tr_b16 v[30:31], v202 offset:17408
    s_add_u32 m0, s41, 102400
    s_waitcnt lgkmcnt(12)
    v_mfma_f32_32x32x16_bf16 a[16:31], v[0:3], v[16:19], a[16:31]
    ds_read_b128 v[52:55], v206 offset:20480
    s_nop 0
    s_waitcnt lgkmcnt(11)
    v_mfma_f32_32x32x16_bf16 a[32:47], v[4:7], v[12:15], a[32:47]
    ds_read_b64_tr_b16 v[40:41], v200 offset:28672
    ds_read_b64_tr_b16 v[42:43], v200 offset:31744
    buffer_load_dwordx4 v208, s[8:11], s43 offen sc1 lds
    v_mfma_f32_32x32x16_bf16 a[48:63], v[4:7], v[16:19], a[48:63]
    ds_read_b128 v[56:59], v206 offset:22528
    buffer_load_dwordx4 v208, s[8:11], s43 offen offset:1024 sc1 lds
    s_waitcnt lgkmcnt(12)
    v_mfma_f32_32x32x16_bf16 a[64:79], v[8:11], v[12:15], a[64:79]
    ds_read_b64_tr_b16 v[44:45], v201 offset:28672
    s_add_u32 m0, s42, 102400
    v_mfma_f32_32x32x16_bf16 a[80:95], v[8:11], v[16:19], a[80:95]
    ds_read_b64_tr_b16 v[46:47], v201 offset:31744
    s_nop 0
    s_waitcnt lgkmcnt(11)
    v_mfma_f32_32x32x16_bf16 a[0:15], v[20:23], v[32:35], a[0:15]
    ds_read_b64_tr_b16 v[48:49], v202 offset:28672
    ds_read_b64_tr_b16 v[50:51], v202 offset:31744
    buffer_load_dwordx4 v209, s[52:55], s44 offen offset:0 lds
    s_waitcnt lgkmcnt(12)
    v_mfma_f32_32x32x16_bf16 a[16:31], v[20:23], v[36:39], a[16:31]
    ds_read_b128 v[12:15], v206 offset:21504
    buffer_load_dwordx4 v210, s[52:55], s44 offen offset:1024 lds
    s_waitcnt lgkmcnt(11)
    v_mfma_f32_32x32x16_bf16 a[32:47], v[24:27], v[32:35], a[32:47]
    ds_read_b64_tr_b16 v[0:1], v200 offset:34816
    ds_read_b64_tr_b16 v[2:3], v200 offset:37888
    buffer_load_dwordx4 v211, s[52:55], s44 offen offset:2048 lds
    v_mfma_f32_32x32x16_bf16 a[48:63], v[24:27], v[36:39], a[48:63]
    ds_read_b128 v[16:19], v206 offset:23552
    v_readlane_b32 s43, v222, s45
    s_waitcnt lgkmcnt(12)
    v_mfma_f32_32x32x16_bf16 a[64:79], v[28:31], v[32:35], a[64:79]
    ds_read_b64_tr_b16 v[4:5], v201 offset:34816
    v_readlane_b32 s44, v223, s45
    v_mfma_f32_32x32x16_bf16 a[80:95], v[28:31], v[36:39], a[80:95]
    ds_read_b64_tr_b16 v[6:7], v201 offset:37888
    s_add_u32 s45, s45, 1
    s_waitcnt vmcnt(15)
    s_barrier
    s_cmp_eq_u32 s67, 1
    s_cselect_b32 s10, 0, s10
    s_cselect_b32 s54, 0, s54
    s_waitcnt lgkmcnt(11)
    v_mfma_f32_32x32x16_bf16 a[0:15], v[40:43], v[52:55], a[0:15]
    ds_read_b64_tr_b16 v[8:9], v202 offset:34816
    ds_read_b64_tr_b16 v[10:11], v202 offset:37888
    s_add_u32 m0, s41, 0
    s_waitcnt lgkmcnt(12)
    v_mfma_f32_32x32x16_bf16 a[16:31], v[40:43], v[56:59], a[16:31]
    ds_read_b128 v[32:35], v206 offset:40960
    s_nop 0
    s_waitcnt lgkmcnt(11)
    v_mfma_f32_32x32x16_bf16 a[32:47], v[44:47], v[52:55], a[32:47]
    ds_read_b64_tr_b16 v[20:21], v200 offset:49152
    ds_read_b64_tr_b16 v[22:23], v200 offset:52224
    buffer_load_dwordx4 v208, s[8:11], s43 offen sc1 lds
    v_mfma_f32_32x32x16_bf16 a[48:63], v[44:47], v[56:59], a[48:63]
    ds_read_b128 v[36:39], v206 offset:43008
    buffer_load_dwordx4 v208, s[8:11], s43 offen offset:1024 sc1 lds
    s_waitcnt lgkmcnt(12)
    v_mfma_f32_32x32x16_bf16 a[64:79], v[48:51], v[52:55], a[64:79]
    ds_read_b64_tr_b16 v[24:25], v201 offset:49152
    s_add_u32 m0, s42, 0
    v_mfma_f32_32x32x16_bf16 a[80:95], v[48:51], v[56:59], a[80:95]
    ds_read_b64_tr_b16 v[26:27], v201 offset:52224
    s_nop 0
    s_waitcnt lgkmcnt(11)
    v_mfma_f32_32x32x16_bf16 a[0:15], v[0:3], v[12:15], a[0:15]
    ds_read_b64_tr_b16 v[28:29], v202 offset:49152
    ds_read_b64_tr_b16 v[30:31], v202 offset:52224
    buffer_load_dwordx4 v209, s[52:55], s44 offen offset:0 lds
    s_waitcnt lgkmcnt(12)
    v_mfma_f32_32x32x16_bf16 a[16:31], v[0:3], v[16:19], a[16:31]
    ds_read_b128 v[52:55], v206 offset:41984
    buffer_load_dwordx4 v210, s[52:55], s44 offen offset:1024 lds
    s_waitcnt lgkmcnt(11)
    v_mfma_f32_32x32x16_bf16 a[32:47], v[4:7], v[12:15], a[32:47]
    ds_read_b64_tr_b16 v[40:41], v200 offset:55296
    ds_read_b64_tr_b16 v[42:43], v200 offset:58368
    buffer_load_dwordx4 v211, s[52:55], s44 offen offset:2048 lds
    v_mfma_f32_32x32x16_bf16 a[48:63], v[4:7], v[16:19], a[48:63]
    ds_read_b128 v[56:59], v206 offset:44032
    v_readlane_b32 s43, v222, s45
    s_waitcnt lgkmcnt(12)
    v_mfma_f32_32x32x16_bf16 a[64:79], v[8:11], v[12:15], a[64:79]
    ds_read_b64_tr_b16 v[44:45], v201 offset:55296
    v_readlane_b32 s44, v223, s45
    v_mfma_f32_32x32x16_bf16 a[80:95], v[8:11], v[16:19], a[80:95]
    ds_read_b64_tr_b16 v[46:47], v201 offset:58368
    s_add_u32 s45, s45, 1
    s_waitcnt vmcnt(15)
    s_barrier
    s_waitcnt lgkmcnt(11)
    v_mfma_f32_32x32x16_bf16 a[0:15], v[20:23], v[32:35], a[0:15]
    ds_read_b64_tr_b16 v[48:49], v202 offset:55296
    ds_read_b64_tr_b16 v[50:51], v202 offset:58368
    s_add_u32 m0, s41, 20480
    s_waitcnt lgkmcnt(12)
    v_mfma_f32_32x32x16_bf16 a[16:31], v[20:23], v[36:39], a[16:31]
    ds_read_b128 v[12:15], v206 offset:61440
    s_nop 0
    s_waitcnt lgkmcnt(11)
    v_mfma_f32_32x32x16_bf16 a[32:47], v[24:27], v[32:35], a[32:47]
    ds_read_b64_tr_b16 v[0:1], v203 offset:4096
    ds_read_b64_tr_b16 v[2:3], v203 offset:7168
    buffer_load_dwordx4 v208, s[8:11], s43 offen sc1 lds
    v_mfma_f32_32x32x16_bf16 a[48:63], v[24:27], v[36:39], a[48:63]
    ds_read_b128 v[16:19], v206 offset:63488
    buffer_load_dwordx4 v208, s[8:11], s43 offen offset:1024 sc1 lds
    s_waitcnt lgkmcnt(12)
    v_mfma_f32_32x32x16_bf16 a[64:79], v[28:31], v[32:35], a[64:79]
    ds_read_b64_tr_b16 v[4:5], v204 offset:4096
    s_add_u32 m0, s42, 20480
    v_mfma_f32_32x32x16_bf16 a[80:95], v[28:31], v[36:39], a[80:95]
    ds_read_b64_tr_b16 v[6:7], v204 offset:7168
    s_nop 0
    s_waitcnt lgkmcnt(11)
    v_mfma_f32_32x32x16_bf16 a[0:15], v[40:43], v[52:55], a[0:15]
    ds_read_b64_tr_b16 v[8:9], v205 offset:4096
    ds_read_b64_tr_b16 v[10:11], v205 offset:7168
    buffer_load_dwordx4 v209, s[52:55], s44 offen offset:0 lds
    s_waitcnt lgkmcnt(12)
    v_mfma_f32_32x32x16_bf16 a[16:31], v[40:43], v[56:59], a[16:31]
    ds_read_b128 v[32:35], v206 offset:62464
    buffer_load_dwordx4 v210, s[52:55], s44 offen offset:1024 lds
    s_waitcnt lgkmcnt(11)
    v_mfma_f32_32x32x16_bf16 a[32:47], v[44:47], v[52:55], a[32:47]
    ds_read_b64_tr_b16 v[20:21], v203 offset:10240
    ds_read_b64_tr_b16 v[22:23], v203 offset:13312
    buffer_load_dwordx4 v211, s[52:55], s44 offen offset:2048 lds
    v_mfma_f32_32x32x16_bf16 a[48:63], v[44:47], v[56:59], a[48:63]
    ds_read_b128 v[36:39], v206 offset:64512
    v_readlane_b32 s43, v222, s45
    s_waitcnt lgkmcnt(12)
    v_mfma_f32_32x32x16_bf16 a[64:79], v[48:51], v[52:55], a[64:79]
    ds_read_b64_tr_b16 v[24:25], v204 offset:10240
    v_readlane_b32 s44, v223, s45
    v_mfma_f32_32x32x16_bf16 a[80:95], v[48:51], v[56:59], a[80:95]
    ds_read_b64_tr_b16 v[26:27], v204 offset:13312
    s_add_u32 s45, s45, 1
    s_waitcnt vmcnt(15)
    s_barrier
    s_cmp_eq_u32 s67, 4
    s_cbranch_scc0 nohf2_26
    s_lshl_b32 s62, s61, 2
    s_add_u32 s62, s62, 12288
    buffer_load_dwordx4 v[216:219], v220, s[56:59], s62 offen sc0 sc1
nohf2_26:
    s_waitcnt lgkmcnt(11)
    v_mfma_f32_32x32x16_bf16 a[0:15], v[0:3], v[12:15], a[0:15]
    ds_read_b64_tr_b16 v[28:29], v205 offset:10240
    ds_read_b64_tr_b16 v[30:31], v205 offset:13312
    s_add_u32 m0, s41, 40960
    s_waitcnt lgkmcnt(12)
    v_mfma_f32_32x32x16_bf16 a[16:31], v[0:3], v[16:19], a[16:31]
    ds_read_b128 v[52:55], v207 offset:16384
    s_nop 0
    s_waitcnt lgkmcnt(11)
    v_mfma_f32_32x32x16_bf16 a[32:47], v[4:7], v[12:15], a[32:47]
    ds_read_b64_tr_b16 v[40:41], v203 offset:24576
    ds_read_b64_tr_b16 v[42:43], v203 offset:27648
    buffer_load_dwordx4 v208, s[8:11], s43 offen sc1 lds
    v_mfma_f32_32x32x16_bf16 a[48:63], v[4:7], v[16:19], a[48:63]
    ds_read_b128 v[56:59], v207 offset:18432
    buffer_load_dwordx4 v208, s[8:11], s43 offen offset:1024 sc1 lds
    s_waitcnt lgkmcnt(12)
    v_mfma_f32_32x32x16_bf16 a[64:79], v[8:11], v[12:15], a[64:79]
    ds_read_b64_tr_b16 v[44:45], v204 offset:24576
    s_add_u32 m0, s42, 40960
    v_mfma_f32_32x32x16_bf16 a[80:95], v[8:11], v[16:19], a[80:95]
    ds_read_b64_tr_b16 v[46:47], v204 offset:27648
    s_nop 0
    s_waitcnt lgkmcnt(11)
    v_mfma_f32_32x32x16_bf16 a[0:15], v[20:23], v[32:35], a[0:15]
    ds_read_b64_tr_b16 v[48:49], v205 offset:24576
    ds_read_b64_tr_b16 v[50:51], v205 offset:27648
    buffer_load_dwordx4 v209, s[52:55], s44 offen offset:0 lds
    s_waitcnt lgkmcnt(12)
    v_mfma_f32_32x32x16_bf16 a[16:31], v[20:23], v[36:39], a[16:31]
    ds_read_b128 v[12:15], v207 offset:17408
    buffer_load_dwordx4 v210, s[52:55], s44 offen offset:1024 lds
    s_waitcnt lgkmcnt(11)
    v_mfma_f32_32x32x16_bf16 a[32:47], v[24:27], v[32:35], a[32:47]
    ds_read_b64_tr_b16 v[0:1], v203 offset:30720
    ds_read_b64_tr_b16 v[2:3], v203 offset:33792
    buffer_load_dwordx4 v211, s[52:55], s44 offen offset:2048 lds
    v_mfma_f32_32x32x16_bf16 a[48:63], v[24:27], v[36:39], a[48:63]
    ds_read_b128 v[16:19], v207 offset:19456
    v_readlane_b32 s43, v222, s45
    s_waitcnt lgkmcnt(12)
    v_mfma_f32_32x32x16_bf16 a[64:79], v[28:31], v[32:35], a[64:79]
    ds_read_b64_tr_b16 v[4:5], v204 offset:30720
    v_readlane_b32 s44, v223, s45
    v_mfma_f32_32x32x16_bf16 a[80:95], v[28:31], v[36:39], a[80:95]
    ds_read_b64_tr_b16 v[6:7], v204 offset:33792
    s_add_u32 s45, s45, 1
    s_waitcnt vmcnt(15)
    s_cmp_eq_u32 s67, 5
    s_cbranch_scc0 nodrain_27
    s_waitcnt vmcnt(0)
nodrain_27:
    s_barrier
    s_cmp_eq_u32 s67, 5
    s_cbranch_scc0 hf2_28
    s_cmp_eq_u32 s20, 0
    s_cbranch_scc0 hf2_28
    s_lshl_b32 s62, s64, 2
    s_add_u32 s62, s62, 12288
    v_mov_b32 v212, s65
    v_lshlrev_b32 v213, 2, v182
    s_mov_b64 exec, 15
    buffer_store_dword v212, v213, s[56:59], s62 offen sc0 sc1
    s_mov_b64 exec, -1
hf2_28:
    s_waitcnt lgkmcnt(11)
    v_mfma_f32_32x32x16_bf16 a[0:15], v[40:43], v[52:55], a[0:15]
    ds_read_b64_tr_b16 v[8:9], v205 offset:30720
    ds_read_b64_tr_b16 v[10:11], v205 offset:33792
    s_add_u32 m0, s41, 61440
    s_waitcnt lgkmcnt(12)
    v_mfma_f32_32x32x16_bf16 a[16:31], v[40:43], v[56:59], a[16:31]
    ds_read_b128 v[32:35], v207 offset:36864
    s_nop 0
    s_waitcnt lgkmcnt(11)
    v_mfma_f32_32x32x16_bf16 a[32:47], v[44:47], v[52:55], a[32:47]
    ds_read_b64_tr_b16 v[20:21], v203 offset:45056
    ds_read_b64_tr_b16 v[22:23], v203 offset:48128
    buffer_load_dwordx4 v208, s[8:11], s43 offen sc1 lds
    v_mfma_f32_32x32x16_bf16 a[48:63], v[44:47], v[56:59], a[48:63]
    ds_read_b128 v[36:39], v207 offset:38912
    buffer_load_dwordx4 v208, s[8:11], s43 offen offset:1024 sc1 lds
    s_waitcnt lgkmcnt(12)
    v_mfma_f32_32x32x16_bf16 a[64:79], v[48:51], v[52:55], a[64:79]
    ds_read_b64_tr_b16 v[24:25], v204 offset:45056
    s_add_u32 m0, s42, 61440
    v_mfma_f32_32x32x16_bf16 a[80:95], v[48:51], v[56:59], a[80:95]
    ds_read_b64_tr_b16 v[26:27], v204 offset:48128
    s_nop 0
    s_waitcnt lgkmcnt(11)
    v_mfma_f32_32x32x16_bf16 a[0:15], v[0:3], v[12:15], a[0:15]
    ds_read_b64_tr_b16 v[28:29], v205 offset:45056
    ds_read_b64_tr_b16 v[30:31], v205 offset:48128
    buffer_load_dwordx4 v209, s[52:55], s44 offen offset:0 lds
    s_waitcnt lgkmcnt(12)
    v_mfma_f32_32x32x16_bf16 a[16:31], v[0:3], v[16:19], a[16:31]
    ds_read_b128 v[52:55], v207 offset:37888
    buffer_load_dwordx4 v210, s[52:55], s44 offen offset:1024 lds
    s_waitcnt lgkmcnt(11)
    v_mfma_f32_32x32x16_bf16 a[32:47], v[4:7], v[12:15], a[32:47]
    ds_read_b64_tr_b16 v[40:41], v203 offset:51200
    ds_read_b64_tr_b16 v[42:43], v203 offset:54272
    buffer_load_dwordx4 v211, s[52:55], s44 offen offset:2048 lds
    v_mfma_f32_32x32x16_bf16 a[48:63], v[4:7], v[16:19], a[48:63]
    ds_read_b128 v[56:59], v207 offset:39936
    v_readlane_b32 s43, v222, s45
    s_waitcnt lgkmcnt(12)
    v_mfma_f32_32x32x16_bf16 a[64:79], v[8:11], v[12:15], a[64:79]
    ds_read_b64_tr_b16 v[44:45], v204 offset:51200
    v_readlane_b32 s44, v223, s45
    v_mfma_f32_32x32x16_bf16 a[80:95], v[8:11], v[16:19], a[80:95]
    ds_read_b64_tr_b16 v[46:47], v204 offset:54272
    s_add_u32 s45, s45, 1
    s_waitcnt vmcnt(15)
    s_barrier
    s_waitcnt lgkmcnt(11)
    v_mfma_f32_32x32x16_bf16 a[0:15], v[20:23], v[32:35], a[0:15]
    ds_read_b64_tr_b16 v[48:49], v205 offset:51200
    ds_read_b64_tr_b16 v[50:51], v205 offset:54272
    s_add_u32 m0, s41, 81920
    s_waitcnt lgkmcnt(12)
    v_mfma_f32_32x32x16_bf16 a[16:31], v[20:23], v[36:39], a[16:31]
    ds_read_b128 v[12:15], v206 offset:0
    s_nop 0
    s_waitcnt lgkmcnt(11)
    v_mfma_f32_32x32x16_bf16 a[32:47], v[24:27], v[32:35], a[32:47]
    ds_read_b64_tr_b16 v[0:1], v200 offset:8192
    ds_read_b64_tr_b16 v[2:3], v200 offset:11264
    buffer_load_dwordx4 v208, s[8:11], s43 offen sc1 lds
    v_mfma_f32_32x32x16_bf16 a[48:63], v[24:27], v[36:39], a[48:63]
    ds_read_b128 v[16:19], v206 offset:2048
    buffer_load_dwordx4 v208, s[8:11], s43 offen offset:1024 sc1 lds
    s_waitcnt lgkmcnt(12)
    v_mfma_f32_32x32x16_bf16 a[64:79], v[28:31], v[32:35], a[64:79]
    ds_read_b64_tr_b16 v[4:5], v201 offset:8192
    s_add_u32 m0, s42, 81920
    v_mfma_f32_32x32x16_bf16 a[80:95], v[28:31], v[36:39], a[80:95]
    ds_read_b64_tr_b16 v[6:7], v201 offset:11264
    s_nop 0
    s_waitcnt lgkmcnt(11)
    v_mfma_f32_32x32x16_bf16 a[0:15], v[40:43], v[52:55], a[0:15]
    ds_read_b64_tr_b16 v[8:9], v202 offset:8192
    ds_read_b64_tr_b16 v[10:11], v202 offset:11264
    buffer_load_dwordx4 v209, s[52:55], s44 offen offset:0 lds
    s_waitcnt lgkmcnt(12)
    v_mfma_f32_32x32x16_bf16 a[16:31], v[40:43], v[56:59], a[16:31]
    ds_read_b128 v[32:35], v206 offset:1024
    buffer_load_dwordx4 v210, s[52:55], s44 offen offset:1024 lds
    s_waitcnt lgkmcnt(11)
    v_mfma_f32_32x32x16_bf16 a[32:47], v[44:47], v[52:55], a[32:47]
    ds_read_b64_tr_b16 v[20:21], v200 offset:14336
    ds_read_b64_tr_b16 v[22:23], v200 offset:17408
    buffer_load_dwordx4 v211, s[52:55], s44 offen offset:2048 lds
    v_mfma_f32_32x32x16_bf16 a[48:63], v[44:47], v[56:59], a[48:63]
    ds_read_b128 v[36:39], v206 offset:3072
    v_readlane_b32 s43, v222, s45
    s_waitcnt lgkmcnt(12)
    v_mfma_f32_32x32x16_bf16 a[64:79], v[48:51], v[52:55], a[64:79]
    ds_read_b64_tr_b16 v[24:25], v201 offset:14336
    v_readlane_b32 s44, v223, s45
    v_mfma_f32_32x32x16_bf16 a[80:95], v[48:51], v[56:59], a[80:95]
    ds_read_b64_tr_b16 v[26:27], v201 offset:17408
    s_add_u32 s45, s45, 1
    s_sub_u32 s67, s67, 1
    s_cmp_lg_u32 s67, 0
    s_cbranch_scc1 gated_mix__ssm_conv_s4d__geglu_ffn__prompt_kernel_g2loop
    s_add_u32 s16, s4, 18874368
    s_addc_u32 s17, s5, 0
    s_mov_b32 s18, 9437184
    s_mov_b32 s19, 0x20000
    s_lshl_b32 s62, s47, 2
    s_lshl_b32 s26, s66, 1
    s_add_u32 s22, s62, s26
    s_mul_i32 s26, s48, 6
    s_mul_i32 s62, s49, 3
    s_add_u32 s23, s62, s26
    s_mul_i32 s62, s22, 18
    s_add_u32 s62, s62, s23
    s_lshl_b32 s21, s62, 11
    s_mul_i32 s26, s46, 2359296
    s_add_u32 s40, s21, s26
    s_load_dwordx2 s[8:9], s[0:1], 0
    s_load_dwordx2 s[12:13], s[0:1], 48
    s_load_dwordx2 s[52:53], s[0:1], 96
    s_nop 7
    s_cmp_eq_u32 s46, 1
    s_cbranch_scc1 gated_mix__ssm_conv_s4d__geglu_ffn__prompt_kernel_v_30
    s_cmp_eq_u32 s46, 2
    s_cbranch_scc1 gated_mix__ssm_conv_s4d__geglu_ffn__prompt_kernel_v_31
    s_cmp_eq_u32 s46, 3
    s_cbranch_scc1 gated_mix__ssm_conv_s4d__geglu_ffn__prompt_kernel_v_32
gated_mix__ssm_conv_s4d__geglu_ffn__prompt_kernel_v_29:
    s_add_u32 s26, s40, 0
    v_accvgpr_read_b32 v68, a8
    v_accvgpr_read_b32 v69, a9
    v_accvgpr_read_b32 v70, a10
    v_accvgpr_read_b32 v71, a11
    v_accvgpr_read_b32 v72, a12
    v_accvgpr_read_b32 v73, a13
    v_accvgpr_read_b32 v74, a14
    v_accvgpr_read_b32 v75, a15
    v_cvt_pk_bf16_f32 v120, v68, v69
    v_cvt_pk_bf16_f32 v121, v70, v71
    v_cvt_pk_bf16_f32 v122, v72, v73
    v_cvt_pk_bf16_f32 v123, v74, v75
    buffer_store_dwordx4 v[120:123], v208, s[16:19], s26 offen offset:1024 sc1
    s_add_u32 s26, s40, 36864
    v_accvgpr_read_b32 v60, a16
    v_accvgpr_read_b32 v61, a17
    v_accvgpr_read_b32 v62, a18
    v_accvgpr_read_b32 v63, a19
    v_accvgpr_read_b32 v64, a20
    v_accvgpr_read_b32 v65, a21
    v_accvgpr_read_b32 v66, a22
    v_accvgpr_read_b32 v67, a23
    v_cvt_pk_bf16_f32 v124, v60, v61
    v_cvt_pk_bf16_f32 v125, v62, v63
    v_cvt_pk_bf16_f32 v126, v64, v65
    v_cvt_pk_bf16_f32 v127, v66, v67
    buffer_store_dwordx4 v[124:127], v208, s[16:19], s26 offen offset:0 sc1
    v_accvgpr_read_b32 v68, a24
    v_accvgpr_read_b32 v69, a25
    v_accvgpr_read_b32 v70, a26
    v_accvgpr_read_b32 v71, a27
    v_accvgpr_read_b32 v72, a28
    v_accvgpr_read_b32 v73, a29
    v_accvgpr_read_b32 v74, a30
    v_accvgpr_read_b32 v75, a31
    v_cvt_pk_bf16_f32 v120, v68, v69
    v_cvt_pk_bf16_f32 v121, v70, v71
    v_cvt_pk_bf16_f32 v122, v72, v73
    v_cvt_pk_bf16_f32 v123, v74, v75
    buffer_store_dwordx4 v[120:123], v208, s[16:19], s26 offen offset:1024 sc1
    s_add_u32 s26, s40, 2048
    v_accvgpr_read_b32 v60, a40
    v_accvgpr_read_b32 v61, a41
    v_accvgpr_read_b32 v62, a42
    v_accvgpr_read_b32 v63, a43
    v_accvgpr_read_b32 v64, a44
    v_accvgpr_read_b32 v65, a45
    v_accvgpr_read_b32 v66, a46
    v_accvgpr_read_b32 v67, a47
    v_cvt_pk_bf16_f32 v124, v60, v61
    v_cvt_pk_bf16_f32 v125, v62, v63
    v_cvt_pk_bf16_f32 v126, v64, v65
    v_cvt_pk_bf16_f32 v127, v66, v67
    buffer_store_dwordx4 v[124:127], v208, s[16:19], s26 offen offset:1024 sc1
    s_add_u32 s26, s40, 38912
    v_accvgpr_read_b32 v68, a48
    v_accvgpr_read_b32 v69, a49
    v_accvgpr_read_b32 v70, a50
    v_accvgpr_read_b32 v71, a51
    v_accvgpr_read_b32 v72, a52
    v_accvgpr_read_b32 v73, a53
    v_accvgpr_read_b32 v74, a54
    v_accvgpr_read_b32 v75, a55
    v_cvt_pk_bf16_f32 v120, v68, v69
    v_cvt_pk_bf16_f32 v121, v70, v71
    v_cvt_pk_bf16_f32 v122, v72, v73
    v_cvt_pk_bf16_f32 v123, v74, v75
    buffer_store_dwordx4 v[120:123], v208, s[16:19], s26 offen offset:0 sc1
    v_accvgpr_read_b32 v60, a56
    v_accvgpr_read_b32 v61, a57
    v_accvgpr_read_b32 v62, a58
    v_accvgpr_read_b32 v63, a59
    v_accvgpr_read_b32 v64, a60
    v_accvgpr_read_b32 v65, a61
    v_accvgpr_read_b32 v66, a62
    v_accvgpr_read_b32 v67, a63
    v_cvt_pk_bf16_f32 v124, v60, v61
    v_cvt_pk_bf16_f32 v125, v62, v63
    v_cvt_pk_bf16_f32 v126, v64, v65
    v_cvt_pk_bf16_f32 v127, v66, v67
    buffer_store_dwordx4 v[124:127], v208, s[16:19], s26 offen offset:1024 sc1
    s_add_u32 s26, s40, 4096
    v_accvgpr_read_b32 v68, a72
    v_accvgpr_read_b32 v69, a73
    v_accvgpr_read_b32 v70, a74
    v_accvgpr_read_b32 v71, a75
    v_accvgpr_read_b32 v72, a76
    v_accvgpr_read_b32 v73, a77
    v_accvgpr_read_b32 v74, a78
    v_accvgpr_read_b32 v75, a79
    v_cvt_pk_bf16_f32 v120, v68, v69
    v_cvt_pk_bf16_f32 v121, v70, v71
    v_cvt_pk_bf16_f32 v122, v72, v73
    v_cvt_pk_bf16_f32 v123, v74, v75
    buffer_store_dwordx4 v[120:123], v208, s[16:19], s26 offen offset:1024 sc1
    s_add_u32 s26, s40, 40960
    v_accvgpr_read_b32 v60, a80
    v_accvgpr_read_b32 v61, a81
    v_accvgpr_read_b32 v62, a82
    v_accvgpr_read_b32 v63, a83
    v_accvgpr_read_b32 v64, a84
    v_accvgpr_read_b32 v65, a85
    v_accvgpr_read_b32 v66, a86
    v_accvgpr_read_b32 v67, a87
    v_cvt_pk_bf16_f32 v124, v60, v61
    v_cvt_pk_bf16_f32 v125, v62, v63
    v_cvt_pk_bf16_f32 v126, v64, v65
    v_cvt_pk_bf16_f32 v127, v66, v67
    buffer_store_dwordx4 v[124:127], v208, s[16:19], s26 offen offset:0 sc1
    v_accvgpr_read_b32 v68, a88
    v_accvgpr_read_b32 v69, a89
    v_accvgpr_read_b32 v70, a90
    v_accvgpr_read_b32 v71, a91
    v_accvgpr_read_b32 v72, a92
    v_accvgpr_read_b32 v73, a93
    v_accvgpr_read_b32 v74, a94
    v_accvgpr_read_b32 v75, a95
    v_cvt_pk_bf16_f32 v120, v68, v69
    v_cvt_pk_bf16_f32 v121, v70, v71
    v_cvt_pk_bf16_f32 v122, v72, v73
    v_cvt_pk_bf16_f32 v123, v74, v75
    buffer_store_dwordx4 v[120:123], v208, s[16:19], s26 offen offset:1024 sc1
    v_accvgpr_read_b32 v96, a0
    v_accvgpr_read_b32 v97, a1
    v_accvgpr_read_b32 v98, a2
    v_accvgpr_read_b32 v99, a3
    v_accvgpr_read_b32 v100, a4
    v_accvgpr_read_b32 v101, a5
    v_accvgpr_read_b32 v102, a6
    v_accvgpr_read_b32 v103, a7
    v_accvgpr_read_b32 v104, a32
    v_accvgpr_read_b32 v105, a33
    v_accvgpr_read_b32 v106, a34
    v_accvgpr_read_b32 v107, a35
    v_accvgpr_read_b32 v108, a36
    v_accvgpr_read_b32 v109, a37
    v_accvgpr_read_b32 v110, a38
    v_accvgpr_read_b32 v111, a39
    v_accvgpr_read_b32 v112, a64
    v_accvgpr_read_b32 v113, a65
    v_accvgpr_read_b32 v114, a66
    v_accvgpr_read_b32 v115, a67
    v_accvgpr_read_b32 v116, a68
    v_accvgpr_read_b32 v117, a69
    v_accvgpr_read_b32 v118, a70
    v_accvgpr_read_b32 v119, a71
    s_branch gated_mix__ssm_conv_s4d__geglu_ffn__prompt_kernel_vd_33
gated_mix__ssm_conv_s4d__geglu_ffn__prompt_kernel_v_30:
    s_add_u32 s26, s40, 0
    v_accvgpr_read_b32 v68, a0
    v_accvgpr_read_b32 v69, a1
    v_accvgpr_read_b32 v70, a2
    v_accvgpr_read_b32 v71, a3
    v_accvgpr_read_b32 v72, a4
    v_accvgpr_read_b32 v73, a5
    v_accvgpr_read_b32 v74, a6
    v_accvgpr_read_b32 v75, a7
    v_cvt_pk_bf16_f32 v120, v68, v69
    v_cvt_pk_bf16_f32 v121, v70, v71
    v_cvt_pk_bf16_f32 v122, v72, v73
    v_cvt_pk_bf16_f32 v123, v74, v75
    buffer_store_dwordx4 v[120:123], v208, s[16:19], s26 offen offset:0 sc1
    s_add_u32 s26, s40, 36864
    v_accvgpr_read_b32 v60, a16
    v_accvgpr_read_b32 v61, a17
    v_accvgpr_read_b32 v62, a18
    v_accvgpr_read_b32 v63, a19
    v_accvgpr_read_b32 v64, a20
    v_accvgpr_read_b32 v65, a21
    v_accvgpr_read_b32 v66, a22
    v_accvgpr_read_b32 v67, a23
    v_cvt_pk_bf16_f32 v124, v60, v61
    v_cvt_pk_bf16_f32 v125, v62, v63
    v_cvt_pk_bf16_f32 v126, v64, v65
    v_cvt_pk_bf16_f32 v127, v66, v67
    buffer_store_dwordx4 v[124:127], v208, s[16:19], s26 offen offset:0 sc1
    v_accvgpr_read_b32 v68, a24
    v_accvgpr_read_b32 v69, a25
    v_accvgpr_read_b32 v70, a26
    v_accvgpr_read_b32 v71, a27
    v_accvgpr_read_b32 v72, a28
    v_accvgpr_read_b32 v73, a29
    v_accvgpr_read_b32 v74, a30
    v_accvgpr_read_b32 v75, a31
    v_cvt_pk_bf16_f32 v120, v68, v69
    v_cvt_pk_bf16_f32 v121, v70, v71
    v_cvt_pk_bf16_f32 v122, v72, v73
    v_cvt_pk_bf16_f32 v123, v74, v75
    buffer_store_dwordx4 v[120:123], v208, s[16:19], s26 offen offset:1024 sc1
    s_add_u32 s26, s40, 2048
    v_accvgpr_read_b32 v60, a32
    v_accvgpr_read_b32 v61, a33
    v_accvgpr_read_b32 v62, a34
    v_accvgpr_read_b32 v63, a35
    v_accvgpr_read_b32 v64, a36
    v_accvgpr_read_b32 v65, a37
    v_accvgpr_read_b32 v66, a38
    v_accvgpr_read_b32 v67, a39
    v_cvt_pk_bf16_f32 v124, v60, v61
    v_cvt_pk_bf16_f32 v125, v62, v63
    v_cvt_pk_bf16_f32 v126, v64, v65
    v_cvt_pk_bf16_f32 v127, v66, v67
    buffer_store_dwordx4 v[124:127], v208, s[16:19], s26 offen offset:0 sc1
    s_add_u32 s26, s40, 38912
    v_accvgpr_read_b32 v68, a48
    v_accvgpr_read_b32 v69, a49
    v_accvgpr_read_b32 v70, a50
    v_accvgpr_read_b32 v71, a51
    v_accvgpr_read_b32 v72, a52
    v_accvgpr_read_b32 v73, a53
    v_accvgpr_read_b32 v74, a54
    v_accvgpr_read_b32 v75, a55
    v_cvt_pk_bf16_f32 v120, v68, v69
    v_cvt_pk_bf16_f32 v121, v70, v71
    v_cvt_pk_bf16_f32 v122, v72, v73
    v_cvt_pk_bf16_f32 v123, v74, v75
    buffer_store_dwordx4 v[120:123], v208, s[16:19], s26 offen offset:0 sc1
    v_accvgpr_read_b32 v60, a56
    v_accvgpr_read_b32 v61, a57
    v_accvgpr_read_b32 v62, a58
    v_accvgpr_read_b32 v63, a59
    v_accvgpr_read_b32 v64, a60
    v_accvgpr_read_b32 v65, a61
    v_accvgpr_read_b32 v66, a62
    v_accvgpr_read_b32 v67, a63
    v_cvt_pk_bf16_f32 v124, v60, v61
    v_cvt_pk_bf16_f32 v125, v62, v63
    v_cvt_pk_bf16_f32 v126, v64, v65
    v_cvt_pk_bf16_f32 v127, v66, v67
    buffer_store_dwordx4 v[124:127], v208, s[16:19], s26 offen offset:1024 sc1
    s_add_u32 s26, s40, 4096
    v_accvgpr_read_b32 v68, a64
    v_accvgpr_read_b32 v69, a65
    v_accvgpr_read_b32 v70, a66
    v_accvgpr_read_b32 v71, a67
    v_accvgpr_read_b32 v72, a68
    v_accvgpr_read_b32 v73, a69
    v_accvgpr_read_b32 v74, a70
    v_accvgpr_read_b32 v75, a71
    v_cvt_pk_bf16_f32 v120, v68, v69
    v_cvt_pk_bf16_f32 v121, v70, v71
    v_cvt_pk_bf16_f32 v122, v72, v73
    v_cvt_pk_bf16_f32 v123, v74, v75
    buffer_store_dwordx4 v[120:123], v208, s[16:19], s26 offen offset:0 sc1
    s_add_u32 s26, s40, 40960
    v_accvgpr_read_b32 v60, a80
    v_accvgpr_read_b32 v61, a81
    v_accvgpr_read_b32 v62, a82
    v_accvgpr_read_b32 v63, a83
    v_accvgpr_read_b32 v64, a84
    v_accvgpr_read_b32 v65, a85
    v_accvgpr_read_b32 v66, a86
    v_accvgpr_read_b32 v67, a87
    v_cvt_pk_bf16_f32 v124, v60, v61
    v_cvt_pk_bf16_f32 v125, v62, v63
    v_cvt_pk_bf16_f32 v126, v64, v65
    v_cvt_pk_bf16_f32 v127, v66, v67
    buffer_store_dwordx4 v[124:127], v208, s[16:19], s26 offen offset:0 sc1
    v_accvgpr_read_b32 v68, a88
    v_accvgpr_read_b32 v69, a89
    v_accvgpr_read_b32 v70, a90
    v_accvgpr_read_b32 v71, a91
    v_accvgpr_read_b32 v72, a92
    v_accvgpr_read_b32 v73, a93
    v_accvgpr_read_b32 v74, a94
    v_accvgpr_read_b32 v75, a95
    v_cvt_pk_bf16_f32 v120, v68, v69
    v_cvt_pk_bf16_f32 v121, v70, v71
    v_cvt_pk_bf16_f32 v122, v72, v73
    v_cvt_pk_bf16_f32 v123, v74, v75
    buffer_store_dwordx4 v[120:123], v208, s[16:19], s26 offen offset:1024 sc1
    v_accvgpr_read_b32 v96, a8
    v_accvgpr_read_b32 v97, a9
    v_accvgpr_read_b32 v98, a10
    v_accvgpr_read_b32 v99, a11
    v_accvgpr_read_b32 v100, a12
    v_accvgpr_read_b32 v101, a13
    v_accvgpr_read_b32 v102, a14
    v_accvgpr_read_b32 v103, a15
    v_accvgpr_read_b32 v104, a40
    v_accvgpr_read_b32 v105, a41
    v_accvgpr_read_b32 v106, a42
    v_accvgpr_read_b32 v107, a43
    v_accvgpr_read_b32 v108, a44
    v_accvgpr_read_b32 v109, a45
    v_accvgpr_read_b32 v110, a46
    v_accvgpr_read_b32 v111, a47
    v_accvgpr_read_b32 v112, a72
    v_accvgpr_read_b32 v113, a73
    v_accvgpr_read_b32 v114, a74
    v_accvgpr_read_b32 v115, a75
    v_accvgpr_read_b32 v116, a76
    v_accvgpr_read_b32 v117, a77
    v_accvgpr_read_b32 v118, a78
    v_accvgpr_read_b32 v119, a79
    s_branch gated_mix__ssm_conv_s4d__geglu_ffn__prompt_kernel_vd_33
gated_mix__ssm_conv_s4d__geglu_ffn__prompt_kernel_v_31:
    s_add_u32 s26, s40, 0
    v_accvgpr_read_b32 v68, a0
    v_accvgpr_read_b32 v69, a1
    v_accvgpr_read_b32 v70, a2
    v_accvgpr_read_b32 v71, a3
    v_accvgpr_read_b32 v72, a4
    v_accvgpr_read_b32 v73, a5
    v_accvgpr_read_b32 v74, a6
    v_accvgpr_read_b32 v75, a7
    v_cvt_pk_bf16_f32 v120, v68, v69
    v_cvt_pk_bf16_f32 v121, v70, v71
    v_cvt_pk_bf16_f32 v122, v72, v73
    v_cvt_pk_bf16_f32 v123, v74, v75
    buffer_store_dwordx4 v[120:123], v208, s[16:19], s26 offen offset:0 sc1
    v_accvgpr_read_b32 v60, a8
    v_accvgpr_read_b32 v61, a9
    v_accvgpr_read_b32 v62, a10
    v_accvgpr_read_b32 v63, a11
    v_accvgpr_read_b32 v64, a12
    v_accvgpr_read_b32 v65, a13
    v_accvgpr_read_b32 v66, a14
    v_accvgpr_read_b32 v67, a15
    v_cvt_pk_bf16_f32 v124, v60, v61
    v_cvt_pk_bf16_f32 v125, v62, v63
    v_cvt_pk_bf16_f32 v126, v64, v65
    v_cvt_pk_bf16_f32 v127, v66, v67
    buffer_store_dwordx4 v[124:127], v208, s[16:19], s26 offen offset:1024 sc1
    s_add_u32 s26, s40, 36864
    v_accvgpr_read_b32 v68, a24
    v_accvgpr_read_b32 v69, a25
    v_accvgpr_read_b32 v70, a26
    v_accvgpr_read_b32 v71, a27
    v_accvgpr_read_b32 v72, a28
    v_accvgpr_read_b32 v73, a29
    v_accvgpr_read_b32 v74, a30
    v_accvgpr_read_b32 v75, a31
    v_cvt_pk_bf16_f32 v120, v68, v69
    v_cvt_pk_bf16_f32 v121, v70, v71
    v_cvt_pk_bf16_f32 v122, v72, v73
    v_cvt_pk_bf16_f32 v123, v74, v75
    buffer_store_dwordx4 v[120:123], v208, s[16:19], s26 offen offset:1024 sc1
    s_add_u32 s26, s40, 2048
    v_accvgpr_read_b32 v60, a32
    v_accvgpr_read_b32 v61, a33
    v_accvgpr_read_b32 v62, a34
    v_accvgpr_read_b32 v63, a35
    v_accvgpr_read_b32 v64, a36
    v_accvgpr_read_b32 v65, a37
    v_accvgpr_read_b32 v66, a38
    v_accvgpr_read_b32 v67, a39
    v_cvt_pk_bf16_f32 v124, v60, v61
    v_cvt_pk_bf16_f32 v125, v62, v63
    v_cvt_pk_bf16_f32 v126, v64, v65
    v_cvt_pk_bf16_f32 v127, v66, v67
    buffer_store_dwordx4 v[124:127], v208, s[16:19], s26 offen offset:0 sc1
    v_accvgpr_read_b32 v68, a40
    v_accvgpr_read_b32 v69, a41
    v_accvgpr_read_b32 v70, a42
    v_accvgpr_read_b32 v71, a43
    v_accvgpr_read_b32 v72, a44
    v_accvgpr_read_b32 v73, a45
    v_accvgpr_read_b32 v74, a46
    v_accvgpr_read_b32 v75, a47
    v_cvt_pk_bf16_f32 v120, v68, v69
    v_cvt_pk_bf16_f32 v121, v70, v71
    v_cvt_pk_bf16_f32 v122, v72, v73
    v_cvt_pk_bf16_f32 v123, v74, v75
    buffer_store_dwordx4 v[120:123], v208, s[16:19], s26 offen offset:1024 sc1
    s_add_u32 s26, s40, 38912
    v_accvgpr_read_b32 v60, a56
    v_accvgpr_read_b32 v61, a57
    v_accvgpr_read_b32 v62, a58
    v_accvgpr_read_b32 v63, a59
    v_accvgpr_read_b32 v64, a60
    v_accvgpr_read_b32 v65, a61
    v_accvgpr_read_b32 v66, a62
    v_accvgpr_read_b32 v67, a63
    v_cvt_pk_bf16_f32 v124, v60, v61
    v_cvt_pk_bf16_f32 v125, v62, v63
    v_cvt_pk_bf16_f32 v126, v64, v65
    v_cvt_pk_bf16_f32 v127, v66, v67
    buffer_store_dwordx4 v[124:127], v208, s[16:19], s26 offen offset:1024 sc1
    s_add_u32 s26, s40, 4096
    v_accvgpr_read_b32 v68, a64
    v_accvgpr_read_b32 v69, a65
    v_accvgpr_read_b32 v70, a66
    v_accvgpr_read_b32 v71, a67
    v_accvgpr_read_b32 v72, a68
    v_accvgpr_read_b32 v73, a69
    v_accvgpr_read_b32 v74, a70
    v_accvgpr_read_b32 v75, a71
    v_cvt_pk_bf16_f32 v120, v68, v69
    v_cvt_pk_bf16_f32 v121, v70, v71
    v_cvt_pk_bf16_f32 v122, v72, v73
    v_cvt_pk_bf16_f32 v123, v74, v75
    buffer_store_dwordx4 v[120:123], v208, s[16:19], s26 offen offset:0 sc1
    v_accvgpr_read_b32 v60, a72
    v_accvgpr_read_b32 v61, a73
    v_accvgpr_read_b32 v62, a74
    v_accvgpr_read_b32 v63, a75
    v_accvgpr_read_b32 v64, a76
    v_accvgpr_read_b32 v65, a77
    v_accvgpr_read_b32 v66, a78
    v_accvgpr_read_b32 v67, a79
    v_cvt_pk_bf16_f32 v124, v60, v61
    v_cvt_pk_bf16_f32 v125, v62, v63
    v_cvt_pk_bf16_f32 v126, v64, v65
    v_cvt_pk_bf16_f32 v127, v66, v67
    buffer_store_dwordx4 v[124:127], v208, s[16:19], s26 offen offset:1024 sc1
    s_add_u32 s26, s40, 40960
    v_accvgpr_read_b32 v68, a88
    v_accvgpr_read_b32 v69, a89
    v_accvgpr_read_b32 v70, a90
    v_accvgpr_read_b32 v71, a91
    v_accvgpr_read_b32 v72, a92
    v_accvgpr_read_b32 v73, a93
    v_accvgpr_read_b32 v74, a94
    v_accvgpr_read_b32 v75, a95
    v_cvt_pk_bf16_f32 v120, v68, v69
    v_cvt_pk_bf16_f32 v121, v70, v71
    v_cvt_pk_bf16_f32 v122, v72, v73
    v_cvt_pk_bf16_f32 v123, v74, v75
    buffer_store_dwordx4 v[120:123], v208, s[16:19], s26 offen offset:1024 sc1
    v_accvgpr_read_b32 v96, a16
    v_accvgpr_read_b32 v97, a17
    v_accvgpr_read_b32 v98, a18
    v_accvgpr_read_b32 v99, a19
    v_accvgpr_read_b32 v100, a20
    v_accvgpr_read_b32 v101, a21
    v_accvgpr_read_b32 v102, a22
    v_accvgpr_read_b32 v103, a23
    v_accvgpr_read_b32 v104, a48
    v_accvgpr_read_b32 v105, a49
    v_accvgpr_read_b32 v106, a50
    v_accvgpr_read_b32 v107, a51
    v_accvgpr_read_b32 v108, a52
    v_accvgpr_read_b32 v109, a53
    v_accvgpr_read_b32 v110, a54
    v_accvgpr_read_b32 v111, a55
    v_accvgpr_read_b32 v112, a80
    v_accvgpr_read_b32 v113, a81
    v_accvgpr_read_b32 v114, a82
    v_accvgpr_read_b32 v115, a83
    v_accvgpr_read_b32 v116, a84
    v_accvgpr_read_b32 v117, a85
    v_accvgpr_read_b32 v118, a86
    v_accvgpr_read_b32 v119, a87
    s_branch gated_mix__ssm_conv_s4d__geglu_ffn__prompt_kernel_vd_33
gated_mix__ssm_conv_s4d__geglu_ffn__prompt_kernel_v_32:
    s_add_u32 s26, s40, 0
    v_accvgpr_read_b32 v68, a0
    v_accvgpr_read_b32 v69, a1
    v_accvgpr_read_b32 v70, a2
    v_accvgpr_read_b32 v71, a3
    v_accvgpr_read_b32 v72, a4
    v_accvgpr_read_b32 v73, a5
    v_accvgpr_read_b32 v74, a6
    v_accvgpr_read_b32 v75, a7
    v_cvt_pk_bf16_f32 v120, v68, v69
    v_cvt_pk_bf16_f32 v121, v70, v71
    v_cvt_pk_bf16_f32 v122, v72, v73
    v_cvt_pk_bf16_f32 v123, v74, v75
    buffer_store_dwordx4 v[120:123], v208, s[16:19], s26 offen offset:0 sc1
    v_accvgpr_read_b32 v60, a8
    v_accvgpr_read_b32 v61, a9
    v_accvgpr_read_b32 v62, a10
    v_accvgpr_read_b32 v63, a11
    v_accvgpr_read_b32 v64, a12
    v_accvgpr_read_b32 v65, a13
    v_accvgpr_read_b32 v66, a14
    v_accvgpr_read_b32 v67, a15
    v_cvt_pk_bf16_f32 v124, v60, v61
    v_cvt_pk_bf16_f32 v125, v62, v63
    v_cvt_pk_bf16_f32 v126, v64, v65
    v_cvt_pk_bf16_f32 v127, v66, v67
    buffer_store_dwordx4 v[124:127], v208, s[16:19], s26 offen offset:1024 sc1
    s_add_u32 s26, s40, 36864
    v_accvgpr_read_b32 v68, a16
    v_accvgpr_read_b32 v69, a17
    v_accvgpr_read_b32 v70, a18
    v_accvgpr_read_b32 v71, a19
    v_accvgpr_read_b32 v72, a20
    v_accvgpr_read_b32 v73, a21
    v_accvgpr_read_b32 v74, a22
    v_accvgpr_read_b32 v75, a23
    v_cvt_pk_bf16_f32 v120, v68, v69
    v_cvt_pk_bf16_f32 v121, v70, v71
    v_cvt_pk_bf16_f32 v122, v72, v73
    v_cvt_pk_bf16_f32 v123, v74, v75
    buffer_store_dwordx4 v[120:123], v208, s[16:19], s26 offen offset:0 sc1
    s_add_u32 s26, s40, 2048
    v_accvgpr_read_b32 v60, a32
    v_accvgpr_read_b32 v61, a33
    v_accvgpr_read_b32 v62, a34
    v_accvgpr_read_b32 v63, a35
    v_accvgpr_read_b32 v64, a36
    v_accvgpr_read_b32 v65, a37
    v_accvgpr_read_b32 v66, a38
    v_accvgpr_read_b32 v67, a39
    v_cvt_pk_bf16_f32 v124, v60, v61
    v_cvt_pk_bf16_f32 v125, v62, v63
    v_cvt_pk_bf16_f32 v126, v64, v65
    v_cvt_pk_bf16_f32 v127, v66, v67
    buffer_store_dwordx4 v[124:127], v208, s[16:19], s26 offen offset:0 sc1
    v_accvgpr_read_b32 v68, a40
    v_accvgpr_read_b32 v69, a41
    v_accvgpr_read_b32 v70, a42
    v_accvgpr_read_b32 v71, a43
    v_accvgpr_read_b32 v72, a44
    v_accvgpr_read_b32 v73, a45
    v_accvgpr_read_b32 v74, a46
    v_accvgpr_read_b32 v75, a47
    v_cvt_pk_bf16_f32 v120, v68, v69
    v_cvt_pk_bf16_f32 v121, v70, v71
    v_cvt_pk_bf16_f32 v122, v72, v73
    v_cvt_pk_bf16_f32 v123, v74, v75
    buffer_store_dwordx4 v[120:123], v208, s[16:19], s26 offen offset:1024 sc1
    s_add_u32 s26, s40, 38912
    v_accvgpr_read_b32 v60, a48
    v_accvgpr_read_b32 v61, a49
    v_accvgpr_read_b32 v62, a50
    v_accvgpr_read_b32 v63, a51
    v_accvgpr_read_b32 v64, a52
    v_accvgpr_read_b32 v65, a53
    v_accvgpr_read_b32 v66, a54
    v_accvgpr_read_b32 v67, a55
    v_cvt_pk_bf16_f32 v124, v60, v61
    v_cvt_pk_bf16_f32 v125, v62, v63
    v_cvt_pk_bf16_f32 v126, v64, v65
    v_cvt_pk_bf16_f32 v127, v66, v67
    buffer_store_dwordx4 v[124:127], v208, s[16:19], s26 offen offset:0 sc1
    s_add_u32 s26, s40, 4096
    v_accvgpr_read_b32 v68, a64
    v_accvgpr_read_b32 v69, a65
    v_accvgpr_read_b32 v70, a66
    v_accvgpr_read_b32 v71, a67
    v_accvgpr_read_b32 v72, a68
    v_accvgpr_read_b32 v73, a69
    v_accvgpr_read_b32 v74, a70
    v_accvgpr_read_b32 v75, a71
    v_cvt_pk_bf16_f32 v120, v68, v69
    v_cvt_pk_bf16_f32 v121, v70, v71
    v_cvt_pk_bf16_f32 v122, v72, v73
    v_cvt_pk_bf16_f32 v123, v74, v75
    buffer_store_dwordx4 v[120:123], v208, s[16:19], s26 offen offset:0 sc1
    v_accvgpr_read_b32 v60, a72
    v_accvgpr_read_b32 v61, a73
    v_accvgpr_read_b32 v62, a74
    v_accvgpr_read_b32 v63, a75
    v_accvgpr_read_b32 v64, a76
    v_accvgpr_read_b32 v65, a77
    v_accvgpr_read_b32 v66, a78
    v_accvgpr_read_b32 v67, a79
    v_cvt_pk_bf16_f32 v124, v60, v61
    v_cvt_pk_bf16_f32 v125, v62, v63
    v_cvt_pk_bf16_f32 v126, v64, v65
    v_cvt_pk_bf16_f32 v127, v66, v67
    buffer_store_dwordx4 v[124:127], v208, s[16:19], s26 offen offset:1024 sc1
    s_add_u32 s26, s40, 40960
    v_accvgpr_read_b32 v68, a80
    v_accvgpr_read_b32 v69, a81
    v_accvgpr_read_b32 v70, a82
    v_accvgpr_read_b32 v71, a83
    v_accvgpr_read_b32 v72, a84
    v_accvgpr_read_b32 v73, a85
    v_accvgpr_read_b32 v74, a86
    v_accvgpr_read_b32 v75, a87
    v_cvt_pk_bf16_f32 v120, v68, v69
    v_cvt_pk_bf16_f32 v121, v70, v71
    v_cvt_pk_bf16_f32 v122, v72, v73
    v_cvt_pk_bf16_f32 v123, v74, v75
    buffer_store_dwordx4 v[120:123], v208, s[16:19], s26 offen offset:0 sc1
    v_accvgpr_read_b32 v96, a24
    v_accvgpr_read_b32 v97, a25
    v_accvgpr_read_b32 v98, a26
    v_accvgpr_read_b32 v99, a27
    v_accvgpr_read_b32 v100, a28
    v_accvgpr_read_b32 v101, a29
    v_accvgpr_read_b32 v102, a30
    v_accvgpr_read_b32 v103, a31
    v_accvgpr_read_b32 v104, a56
    v_accvgpr_read_b32 v105, a57
    v_accvgpr_read_b32 v106, a58
    v_accvgpr_read_b32 v107, a59
    v_accvgpr_read_b32 v108, a60
    v_accvgpr_read_b32 v109, a61
    v_accvgpr_read_b32 v110, a62
    v_accvgpr_read_b32 v111, a63
    v_accvgpr_read_b32 v112, a88
    v_accvgpr_read_b32 v113, a89
    v_accvgpr_read_b32 v114, a90
    v_accvgpr_read_b32 v115, a91
    v_accvgpr_read_b32 v116, a92
    v_accvgpr_read_b32 v117, a93
    v_accvgpr_read_b32 v118, a94
    v_accvgpr_read_b32 v119, a95
gated_mix__ssm_conv_s4d__geglu_ffn__prompt_kernel_vd_33:
    s_lshr_b32 s62, s46, 1
    s_add_u32 s22, s22, s62
    s_and_b32 s26, s46, 1
    v_and_b32 v212, 31, v182
    v_lshrrev_b32 v213, 5, v182
    v_mul_u32_u24 v214, 1152, v212
    v_lshlrev_b32 v215, 5, v213
    v_add_u32 v214, v214, v215
    s_lshl_b32 s31, s23, 6
    s_lshl_b32 s62, s26, 4
    s_add_u32 s31, s31, s62
    s_mul_i32 s30, s22, 36864
    s_add_u32 s30, s30, s31
    v_lshlrev_b32 v216, 16, v213
    v_lshlrev_b32 v217, 1, v212
    v_add_u32 v216, v216, v217
    s_lshl_b32 s29, s23, 17
    s_lshl_b32 s62, s26, 15
    s_add_u32 s29, s29, s62
    s_lshl_b32 s62, s22, 6
    s_add_u32 s29, s29, s62
    v_lshlrev_b32 v217, 2, v212
    s_waitcnt lgkmcnt(0)
    s_mov_b32 s10, 2359296
    s_mov_b32 s11, 0x20000
    s_mov_b32 s14, 1152
    s_mov_b32 s15, 0x20000
    s_mov_b32 s54, 2359296
    s_mov_b32 s55, 0x20000
    buffer_load_dwordx4 v[0:3], v214, s[8:11], s30 offen offset:0
    buffer_load_dwordx4 v[12:15], v215, s[12:15], s31 offen offset:0
    buffer_load_dwordx4 v[4:7], v214, s[8:11], s30 offen offset:64
    buffer_load_dwordx4 v[16:19], v215, s[12:15], s31 offen offset:64
    buffer_load_dwordx4 v[8:11], v214, s[8:11], s30 offen offset:128
    buffer_load_dwordx4 v[20:23], v215, s[12:15], s31 offen offset:128
    v_lshlrev_b32 v218, 4, v182
    s_lshl_b32 s62, s23, 7
    s_add_u32 s62, s62, 1792
    v_add_u32 v218, s62, v218
    s_lshl_b32 s62, s22, 4
    s_add_u32 s62, s62, 4096
    v_mov_b32 v219, s62
    v_cmp_le_u32 vcc, 24, v182
    s_nop 1
    v_cndmask_b32 v218, v218, v219, vcc
    s_waitcnt vmcnt(0)
    s_mul_i32 s62, s47, 3
    s_add_u32 s62, s62, s48
    s_lshl_b32 s62, s62, 2
    s_add_u32 s62, s62, s20
    s_lshl_b32 s28, s62, 4
    s_add_u32 s28, s28, 8192
    s_lshl_b32 s62, s46, 2
    s_add_u32 s62, s62, s28
    v_mov_b32 v220, s65
    v_mov_b32 v221, 0
    s_mov_b64 exec, 1
    buffer_store_dword v220, v221, s[56:59], s62 offen sc0 sc1
    s_mov_b64 exec, -1
    s_mov_b32 s63, 0x40000
gated_mix__ssm_conv_s4d__geglu_ffn__prompt_kernel_poll_34:
    buffer_load_dwordx4 v[228:231], v218, s[56:59], 0 offen sc0 sc1
    s_waitcnt vmcnt(0)
    v_xor_b32 v228, s65, v228
    v_xor_b32 v229, s65, v229
    v_xor_b32 v230, s65, v230
    v_xor_b32 v231, s65, v231
    v_or3_b32 v228, v228, v229, v230
    v_or_b32 v228, v228, v231
    v_cmp_ne_u32 vcc, 0, v228
    s_cbranch_vccz gated_mix__ssm_conv_s4d__geglu_ffn__prompt_kernel_pd_35
    s_sleep 10
    s_sub_u32 s63, s63, 1
    s_cmp_lg_u32 s63, 0
    s_cbranch_scc1 gated_mix__ssm_conv_s4d__geglu_ffn__prompt_kernel_poll_34
gated_mix__ssm_conv_s4d__geglu_ffn__prompt_kernel_pd_35:
    s_add_u32 s32, s4, 44040192
    s_addc_u32 s33, s5, 0
    s_mov_b32 s34, 2359296
    s_mov_b32 s35, 0x20000
    s_add_u32 s36, s4, 47185920
    s_addc_u32 s37, s5, 0
    s_mov_b32 s38, 8192
    s_mov_b32 s39, 0x20000
    s_add_u32 s62, s29, 0
    buffer_load_ushort v24, v216, s[32:35], s62 offen sc1
    s_add_u32 s62, s29, 4096
    buffer_load_ushort v25, v216, s[32:35], s62 offen sc1
    s_add_u32 s62, s29, 8192
    buffer_load_ushort v26, v216, s[32:35], s62 offen sc1
    s_add_u32 s62, s29, 12288
    buffer_load_ushort v27, v216, s[32:35], s62 offen sc1
    s_add_u32 s62, s29, 16384
    buffer_load_ushort v28, v216, s[32:35], s62 offen sc1
    s_add_u32 s62, s29, 20480
    buffer_load_ushort v29, v216, s[32:35], s62 offen sc1
    s_add_u32 s62, s29, 24576
    buffer_load_ushort v30, v216, s[32:35], s62 offen sc1
    s_add_u32 s62, s29, 28672
    buffer_load_ushort v31, v216, s[32:35], s62 offen sc1
    s_add_u32 s62, s29, 131072
    buffer_load_ushort v32, v216, s[32:35], s62 offen sc1
    s_add_u32 s62, s29, 135168
    buffer_load_ushort v33, v216, s[32:35], s62 offen sc1
    s_add_u32 s62, s29, 139264
    buffer_load_ushort v34, v216, s[32:35], s62 offen sc1
    s_add_u32 s62, s29, 143360
    buffer_load_ushort v35, v216, s[32:35], s62 offen sc1
    s_add_u32 s62, s29, 147456
    buffer_load_ushort v36, v216, s[32:35], s62 offen sc1
    s_add_u32 s62, s29, 151552
    buffer_load_ushort v37, v216, s[32:35], s62 offen sc1
    s_add_u32 s62, s29, 155648
    buffer_load_ushort v38, v216, s[32:35], s62 offen sc1
    s_add_u32 s62, s29, 159744
    buffer_load_ushort v39, v216, s[32:35], s62 offen sc1
    s_add_u32 s62, s29, 262144
    buffer_load_ushort v40, v216, s[32:35], s62 offen sc1
    s_add_u32 s62, s29, 266240
    buffer_load_ushort v41, v216, s[32:35], s62 offen sc1
    s_add_u32 s62, s29, 270336
    buffer_load_ushort v42, v216, s[32:35], s62 offen sc1
    s_add_u32 s62, s29, 274432
    buffer_load_ushort v43, v216, s[32:35], s62 offen sc1
    s_add_u32 s62, s29, 278528
    buffer_load_ushort v44, v216, s[32:35], s62 offen sc1
    s_add_u32 s62, s29, 282624
    buffer_load_ushort v45, v216, s[32:35], s62 offen sc1
    s_add_u32 s62, s29, 286720
    buffer_load_ushort v46, v216, s[32:35], s62 offen sc1
    s_add_u32 s62, s29, 290816
    buffer_load_ushort v47, v216, s[32:35], s62 offen sc1
    s_lshl_b32 s62, s22, 7
    buffer_load_dword v128, v217, s[36:39], s62 offen sc1
    v_mov_b32 v218, 0
    s_mov_b32 s63, 0x40000
gated_mix__ssm_conv_s4d__geglu_ffn__prompt_kernel_poll_36:
    buffer_load_dwordx4 v[228:231], v218, s[56:59], s28 offen sc0 sc1
    s_waitcnt vmcnt(0)
    v_xor_b32 v228, s65, v228
    v_xor_b32 v229, s65, v229
    v_xor_b32 v230, s65, v230
    v_xor_b32 v231, s65, v231
    v_or3_b32 v228, v228, v229, v230
    v_or_b32 v228, v228, v231
    v_cmp_ne_u32 vcc, 0, v228
    s_cbranch_vccz gated_mix__ssm_conv_s4d__geglu_ffn__prompt_kernel_pd_37
    s_sleep 10
    s_sub_u32 s63, s63, 1
    s_cmp_lg_u32 s63, 0
    s_cbranch_scc1 gated_mix__ssm_conv_s4d__geglu_ffn__prompt_kernel_poll_36
gated_mix__ssm_conv_s4d__geglu_ffn__prompt_kernel_pd_37:
    s_mul_i32 s62, s22, 18
    s_add_u32 s62, s62, s23
    s_lshl_b32 s21, s62, 11
    s_lshl_b32 s62, s26, 10
    s_add_u32 s21, s21, s62
    s_add_u32 s62, s46, 1
    s_and_b32 s62, s62, 3
    s_mul_i32 s62, s62, 2359296
    s_add_u32 s62, s62, s21
    buffer_load_dwordx4 v[48:51], v208, s[16:19], s62 offen offset:0 sc1
    buffer_load_dwordx4 v[52:55], v208, s[16:19], s62 offen offset:2048 sc1
    s_add_u32 s40, s62, 4096
    buffer_load_dwordx4 v[56:59], v208, s[16:19], s40 offen sc1
    s_add_u32 s62, s46, 2
    s_and_b32 s62, s62, 3
    s_mul_i32 s62, s62, 2359296
    s_add_u32 s62, s62, s21
    buffer_load_dwordx4 v[60:63], v208, s[16:19], s62 offen offset:0 sc1
    buffer_load_dwordx4 v[64:67], v208, s[16:19], s62 offen offset:2048 sc1
    s_add_u32 s40, s62, 4096
    buffer_load_dwordx4 v[68:71], v208, s[16:19], s40 offen sc1
    s_add_u32 s62, s46, 3
    s_and_b32 s62, s62, 3
    s_mul_i32 s62, s62, 2359296
    s_add_u32 s62, s62, s21
    buffer_load_dwordx4 v[72:75], v208, s[16:19], s62 offen offset:0 sc1
    buffer_load_dwordx4 v[76:79], v208, s[16:19], s62 offen offset:2048 sc1
    s_add_u32 s40, s62, 4096
    buffer_load_dwordx4 v[80:83], v208, s[16:19], s40 offen sc1
    v_sub_f32 v129, 1.0, v128
    v_cvt_pk_bf16_f32 v129, v129, v129
    v_and_b32 v129, 0xffff0000, v129
    v_lshlrev_b32 v218, 16, v0
    v_and_b32 v219, 0xffff0000, v0
    v_lshlrev_b32 v220, 16, v12
    v_and_b32 v221, 0xffff0000, v12
    v_mul_f32 v218, v218, v220
    v_mul_f32 v219, v219, v221
    v_cvt_pk_bf16_f32 v218, v218, v219
    v_and_b32 v219, 0xffff0000, v218
    v_lshlrev_b32 v218, 16, v218
    v_lshlrev_b32 v220, 16, v24
    v_lshlrev_b32 v221, 16, v25
    v_add_f32 v218, v218, v220
    v_add_f32 v219, v219, v221
    v_cvt_pk_bf16_f32 v218, v218, v219
    v_and_b32 v219, 0xffff0000, v218
    v_lshlrev_b32 v218, 16, v218
    v_mul_f32 v218, v218, v128
    v_mul_f32 v219, v219, v128
    v_cvt_pk_bf16_f32 v24, v218, v219
    v_lshlrev_b32 v218, 16, v1
    v_and_b32 v219, 0xffff0000, v1
    v_lshlrev_b32 v220, 16, v13
    v_and_b32 v221, 0xffff0000, v13
    v_mul_f32 v218, v218, v220
    v_mul_f32 v219, v219, v221
    v_cvt_pk_bf16_f32 v218, v218, v219
    v_and_b32 v219, 0xffff0000, v218
    v_lshlrev_b32 v218, 16, v218
    v_lshlrev_b32 v220, 16, v26
    v_lshlrev_b32 v221, 16, v27
    v_add_f32 v218, v218, v220
    v_add_f32 v219, v219, v221
    v_cvt_pk_bf16_f32 v218, v218, v219
    v_and_b32 v219, 0xffff0000, v218
    v_lshlrev_b32 v218, 16, v218
    v_mul_f32 v218, v218, v128
    v_mul_f32 v219, v219, v128
    v_cvt_pk_bf16_f32 v26, v218, v219
    v_lshlrev_b32 v218, 16, v2
    v_and_b32 v219, 0xffff0000, v2
    v_lshlrev_b32 v220, 16, v14
    v_and_b32 v221, 0xffff0000, v14
    v_mul_f32 v218, v218, v220
    v_mul_f32 v219, v219, v221
    v_cvt_pk_bf16_f32 v218, v218, v219
    v_and_b32 v219, 0xffff0000, v218
    v_lshlrev_b32 v218, 16, v218
    v_lshlrev_b32 v220, 16, v28
    v_lshlrev_b32 v221, 16, v29
    v_add_f32 v218, v218, v220
    v_add_f32 v219, v219, v221
    v_cvt_pk_bf16_f32 v218, v218, v219
    v_and_b32 v219, 0xffff0000, v218
    v_lshlrev_b32 v218, 16, v218
    v_mul_f32 v218, v218, v128
    v_mul_f32 v219, v219, v128
    v_cvt_pk_bf16_f32 v28, v218, v219
    v_lshlrev_b32 v218, 16, v3
    v_and_b32 v219, 0xffff0000, v3
    v_lshlrev_b32 v220, 16, v15
    v_and_b32 v221, 0xffff0000, v15
    v_mul_f32 v218, v218, v220
    v_mul_f32 v219, v219, v221
    v_cvt_pk_bf16_f32 v218, v218, v219
    v_and_b32 v219, 0xffff0000, v218
    v_lshlrev_b32 v218, 16, v218
    v_lshlrev_b32 v220, 16, v30
    v_lshlrev_b32 v221, 16, v31
    v_add_f32 v218, v218, v220
    v_add_f32 v219, v219, v221
    v_cvt_pk_bf16_f32 v218, v218, v219
    v_and_b32 v219, 0xffff0000, v218
    v_lshlrev_b32 v218, 16, v218
    v_mul_f32 v218, v218, v128
    v_mul_f32 v219, v219, v128
    v_cvt_pk_bf16_f32 v30, v218, v219
    v_lshlrev_b32 v218, 16, v4
    v_and_b32 v219, 0xffff0000, v4
    v_lshlrev_b32 v220, 16, v16
    v_and_b32 v221, 0xffff0000, v16
    v_mul_f32 v218, v218, v220
    v_mul_f32 v219, v219, v221
    v_cvt_pk_bf16_f32 v218, v218, v219
    v_and_b32 v219, 0xffff0000, v218
    v_lshlrev_b32 v218, 16, v218
    v_lshlrev_b32 v220, 16, v32
    v_lshlrev_b32 v221, 16, v33
    v_add_f32 v218, v218, v220
    v_add_f32 v219, v219, v221
    v_cvt_pk_bf16_f32 v218, v218, v219
    v_and_b32 v219, 0xffff0000, v218
    v_lshlrev_b32 v218, 16, v218
    v_mul_f32 v218, v218, v128
    v_mul_f32 v219, v219, v128
    v_cvt_pk_bf16_f32 v32, v218, v219
    v_lshlrev_b32 v218, 16, v5
    v_and_b32 v219, 0xffff0000, v5
    v_lshlrev_b32 v220, 16, v17
    v_and_b32 v221, 0xffff0000, v17
    v_mul_f32 v218, v218, v220
    v_mul_f32 v219, v219, v221
    v_cvt_pk_bf16_f32 v218, v218, v219
    v_and_b32 v219, 0xffff0000, v218
    v_lshlrev_b32 v218, 16, v218
    v_lshlrev_b32 v220, 16, v34
    v_lshlrev_b32 v221, 16, v35
    v_add_f32 v218, v218, v220
    v_add_f32 v219, v219, v221
    v_cvt_pk_bf16_f32 v218, v218, v219
    v_and_b32 v219, 0xffff0000, v218
    v_lshlrev_b32 v218, 16, v218
    v_mul_f32 v218, v218, v128
    v_mul_f32 v219, v219, v128
    v_cvt_pk_bf16_f32 v34, v218, v219
    v_lshlrev_b32 v218, 16, v6
    v_and_b32 v219, 0xffff0000, v6
    v_lshlrev_b32 v220, 16, v18
    v_and_b32 v221, 0xffff0000, v18
    v_mul_f32 v218, v218, v220
    v_mul_f32 v219, v219, v221
    v_cvt_pk_bf16_f32 v218, v218, v219
    v_and_b32 v219, 0xffff0000, v218
    v_lshlrev_b32 v218, 16, v218
    v_lshlrev_b32 v220, 16, v36
    v_lshlrev_b32 v221, 16, v37
    v_add_f32 v218, v218, v220
    v_add_f32 v219, v219, v221
    v_cvt_pk_bf16_f32 v218, v218, v219
    v_and_b32 v219, 0xffff0000, v218
    v_lshlrev_b32 v218, 16, v218
    v_mul_f32 v218, v218, v128
    v_mul_f32 v219, v219, v128
    v_cvt_pk_bf16_f32 v36, v218, v219
    v_lshlrev_b32 v218, 16, v7
    v_and_b32 v219, 0xffff0000, v7
    v_lshlrev_b32 v220, 16, v19
    v_and_b32 v221, 0xffff0000, v19
    v_mul_f32 v218, v218, v220
    v_mul_f32 v219, v219, v221
    v_cvt_pk_bf16_f32 v218, v218, v219
    v_and_b32 v219, 0xffff0000, v218
    v_lshlrev_b32 v218, 16, v218
    v_lshlrev_b32 v220, 16, v38
    v_lshlrev_b32 v221, 16, v39
    v_add_f32 v218, v218, v220
    v_add_f32 v219, v219, v221
    v_cvt_pk_bf16_f32 v218, v218, v219
    v_and_b32 v219, 0xffff0000, v218
    v_lshlrev_b32 v218, 16, v218
    v_mul_f32 v218, v218, v128
    v_mul_f32 v219, v219, v128
    v_cvt_pk_bf16_f32 v38, v218, v219
    v_lshlrev_b32 v218, 16, v8
    v_and_b32 v219, 0xffff0000, v8
    v_lshlrev_b32 v220, 16, v20
    v_and_b32 v221, 0xffff0000, v20
    v_mul_f32 v218, v218, v220
    v_mul_f32 v219, v219, v221
    v_cvt_pk_bf16_f32 v218, v218, v219
    v_and_b32 v219, 0xffff0000, v218
    v_lshlrev_b32 v218, 16, v218
    v_lshlrev_b32 v220, 16, v40
    v_lshlrev_b32 v221, 16, v41
    v_add_f32 v218, v218, v220
    v_add_f32 v219, v219, v221
    v_cvt_pk_bf16_f32 v218, v218, v219
    v_and_b32 v219, 0xffff0000, v218
    v_lshlrev_b32 v218, 16, v218
    v_mul_f32 v218, v218, v128
    v_mul_f32 v219, v219, v128
    v_cvt_pk_bf16_f32 v40, v218, v219
    v_lshlrev_b32 v218, 16, v9
    v_and_b32 v219, 0xffff0000, v9
    v_lshlrev_b32 v220, 16, v21
    v_and_b32 v221, 0xffff0000, v21
    v_mul_f32 v218, v218, v220
    v_mul_f32 v219, v219, v221
    v_cvt_pk_bf16_f32 v218, v218, v219
    v_and_b32 v219, 0xffff0000, v218
    v_lshlrev_b32 v218, 16, v218
    v_lshlrev_b32 v220, 16, v42
    v_lshlrev_b32 v221, 16, v43
    v_add_f32 v218, v218, v220
    v_add_f32 v219, v219, v221
    v_cvt_pk_bf16_f32 v218, v218, v219
    v_and_b32 v219, 0xffff0000, v218
    v_lshlrev_b32 v218, 16, v218
    v_mul_f32 v218, v218, v128
    v_mul_f32 v219, v219, v128
    v_cvt_pk_bf16_f32 v42, v218, v219
    v_lshlrev_b32 v218, 16, v10
    v_and_b32 v219, 0xffff0000, v10
    v_lshlrev_b32 v220, 16, v22
    v_and_b32 v221, 0xffff0000, v22
    v_mul_f32 v218, v218, v220
    v_mul_f32 v219, v219, v221
    v_cvt_pk_bf16_f32 v218, v218, v219
    v_and_b32 v219, 0xffff0000, v218
    v_lshlrev_b32 v218, 16, v218
    v_lshlrev_b32 v220, 16, v44
    v_lshlrev_b32 v221, 16, v45
    v_add_f32 v218, v218, v220
    v_add_f32 v219, v219, v221
    v_cvt_pk_bf16_f32 v218, v218, v219
    v_and_b32 v219, 0xffff0000, v218
    v_lshlrev_b32 v218, 16, v218
    v_mul_f32 v218, v218, v128
    v_mul_f32 v219, v219, v128
    v_cvt_pk_bf16_f32 v44, v218, v219
    v_lshlrev_b32 v218, 16, v11
    v_and_b32 v219, 0xffff0000, v11
    v_lshlrev_b32 v220, 16, v23
    v_and_b32 v221, 0xffff0000, v23
    v_mul_f32 v218, v218, v220
    v_mul_f32 v219, v219, v221
    v_cvt_pk_bf16_f32 v218, v218, v219
    v_and_b32 v219, 0xffff0000, v218
    v_lshlrev_b32 v218, 16, v218
    v_lshlrev_b32 v220, 16, v46
    v_lshlrev_b32 v221, 16, v47
    v_add_f32 v218, v218, v220
    v_add_f32 v219, v219, v221
    v_cvt_pk_bf16_f32 v218, v218, v219
    v_and_b32 v219, 0xffff0000, v218
    v_lshlrev_b32 v218, 16, v218
    v_mul_f32 v218, v218, v128
    v_mul_f32 v219, v219, v128
    v_cvt_pk_bf16_f32 v46, v218, v219
    s_waitcnt vmcnt(0)
    v_lshlrev_b32 v218, 16, v48
    v_and_b32 v219, 0xffff0000, v48
    v_add_f32 v96, v96, v218
    v_add_f32 v97, v97, v219
    v_lshlrev_b32 v218, 16, v60
    v_and_b32 v219, 0xffff0000, v60
    v_add_f32 v96, v96, v218
    v_add_f32 v97, v97, v219
    v_lshlrev_b32 v218, 16, v72
    v_and_b32 v219, 0xffff0000, v72
    v_add_f32 v96, v96, v218
    v_add_f32 v97, v97, v219
    v_cvt_pk_bf16_f32 v220, v96, v97
    v_and_b32 v221, 0xffff0000, v220
    v_lshlrev_b32 v220, 16, v220
    v_mul_f32 v220, v220, v129
    v_mul_f32 v221, v221, v129
    v_cvt_pk_bf16_f32 v220, v220, v221
    v_and_b32 v221, 0xffff0000, v220
    v_lshlrev_b32 v220, 16, v220
    v_and_b32 v219, 0xffff0000, v24
    v_lshlrev_b32 v218, 16, v24
    v_add_f32 v218, v218, v220
    v_add_f32 v219, v219, v221
    v_cvt_pk_bf16_f32 v0, v218, v219
    v_lshlrev_b32 v218, 16, v49
    v_and_b32 v219, 0xffff0000, v49
    v_add_f32 v98, v98, v218
    v_add_f32 v99, v99, v219
    v_lshlrev_b32 v218, 16, v61
    v_and_b32 v219, 0xffff0000, v61
    v_add_f32 v98, v98, v218
    v_add_f32 v99, v99, v219
    v_lshlrev_b32 v218, 16, v73
    v_and_b32 v219, 0xffff0000, v73
    v_add_f32 v98, v98, v218
    v_add_f32 v99, v99, v219
    v_cvt_pk_bf16_f32 v220, v98, v99
    v_and_b32 v221, 0xffff0000, v220
    v_lshlrev_b32 v220, 16, v220
    v_mul_f32 v220, v220, v129
    v_mul_f32 v221, v221, v129
    v_cvt_pk_bf16_f32 v220, v220, v221
    v_and_b32 v221, 0xffff0000, v220
    v_lshlrev_b32 v220, 16, v220
    v_and_b32 v219, 0xffff0000, v26
    v_lshlrev_b32 v218, 16, v26
    v_add_f32 v218, v218, v220
    v_add_f32 v219, v219, v221
    v_cvt_pk_bf16_f32 v1, v218, v219
    v_lshlrev_b32 v218, 16, v50
    v_and_b32 v219, 0xffff0000, v50
    v_add_f32 v100, v100, v218
    v_add_f32 v101, v101, v219
    v_lshlrev_b32 v218, 16, v62
    v_and_b32 v219, 0xffff0000, v62
    v_add_f32 v100, v100, v218
    v_add_f32 v101, v101, v219
    v_lshlrev_b32 v218, 16, v74
    v_and_b32 v219, 0xffff0000, v74
    v_add_f32 v100, v100, v218
    v_add_f32 v101, v101, v219
    v_cvt_pk_bf16_f32 v220, v100, v101
    v_and_b32 v221, 0xffff0000, v220
    v_lshlrev_b32 v220, 16, v220
    v_mul_f32 v220, v220, v129
    v_mul_f32 v221, v221, v129
    v_cvt_pk_bf16_f32 v220, v220, v221
    v_and_b32 v221, 0xffff0000, v220
    v_lshlrev_b32 v220, 16, v220
    v_and_b32 v219, 0xffff0000, v28
    v_lshlrev_b32 v218, 16, v28
    v_add_f32 v218, v218, v220
    v_add_f32 v219, v219, v221
    v_cvt_pk_bf16_f32 v2, v218, v219
    v_lshlrev_b32 v218, 16, v51
    v_and_b32 v219, 0xffff0000, v51
    v_add_f32 v102, v102, v218
    v_add_f32 v103, v103, v219
    v_lshlrev_b32 v218, 16, v63
    v_and_b32 v219, 0xffff0000, v63
    v_add_f32 v102, v102, v218
    v_add_f32 v103, v103, v219
    v_lshlrev_b32 v218, 16, v75
    v_and_b32 v219, 0xffff0000, v75
    v_add_f32 v102, v102, v218
    v_add_f32 v103, v103, v219
    v_cvt_pk_bf16_f32 v220, v102, v103
    v_and_b32 v221, 0xffff0000, v220
    v_lshlrev_b32 v220, 16, v220
    v_mul_f32 v220, v220, v129
    v_mul_f32 v221, v221, v129
    v_cvt_pk_bf16_f32 v220, v220, v221
    v_and_b32 v221, 0xffff0000, v220
    v_lshlrev_b32 v220, 16, v220
    v_and_b32 v219, 0xffff0000, v30
    v_lshlrev_b32 v218, 16, v30
    v_add_f32 v218, v218, v220
    v_add_f32 v219, v219, v221
    v_cvt_pk_bf16_f32 v3, v218, v219
    buffer_store_dwordx4 v[0:3], v214, s[52:55], s30 offen offset:0 sc1
    v_lshlrev_b32 v218, 16, v52
    v_and_b32 v219, 0xffff0000, v52
    v_add_f32 v104, v104, v218
    v_add_f32 v105, v105, v219
    v_lshlrev_b32 v218, 16, v64
    v_and_b32 v219, 0xffff0000, v64
    v_add_f32 v104, v104, v218
    v_add_f32 v105, v105, v219
    v_lshlrev_b32 v218, 16, v76
    v_and_b32 v219, 0xffff0000, v76
    v_add_f32 v104, v104, v218
    v_add_f32 v105, v105, v219
    v_cvt_pk_bf16_f32 v220, v104, v105
    v_and_b32 v221, 0xffff0000, v220
    v_lshlrev_b32 v220, 16, v220
    v_mul_f32 v220, v220, v129
    v_mul_f32 v221, v221, v129
    v_cvt_pk_bf16_f32 v220, v220, v221
    v_and_b32 v221, 0xffff0000, v220
    v_lshlrev_b32 v220, 16, v220
    v_and_b32 v219, 0xffff0000, v32
    v_lshlrev_b32 v218, 16, v32
    v_add_f32 v218, v218, v220
    v_add_f32 v219, v219, v221
    v_cvt_pk_bf16_f32 v4, v218, v219
    v_lshlrev_b32 v218, 16, v53
    v_and_b32 v219, 0xffff0000, v53
    v_add_f32 v106, v106, v218
    v_add_f32 v107, v107, v219
    v_lshlrev_b32 v218, 16, v65
    v_and_b32 v219, 0xffff0000, v65
    v_add_f32 v106, v106, v218
    v_add_f32 v107, v107, v219
    v_lshlrev_b32 v218, 16, v77
    v_and_b32 v219, 0xffff0000, v77
    v_add_f32 v106, v106, v218
    v_add_f32 v107, v107, v219
    v_cvt_pk_bf16_f32 v220, v106, v107
    v_and_b32 v221, 0xffff0000, v220
    v_lshlrev_b32 v220, 16, v220
    v_mul_f32 v220, v220, v129
    v_mul_f32 v221, v221, v129
    v_cvt_pk_bf16_f32 v220, v220, v221
    v_and_b32 v221, 0xffff0000, v220
    v_lshlrev_b32 v220, 16, v220
    v_and_b32 v219, 0xffff0000, v34
    v_lshlrev_b32 v218, 16, v34
    v_add_f32 v218, v218, v220
    v_add_f32 v219, v219, v221
    v_cvt_pk_bf16_f32 v5, v218, v219
    v_lshlrev_b32 v218, 16, v54
    v_and_b32 v219, 0xffff0000, v54
    v_add_f32 v108, v108, v218
    v_add_f32 v109, v109, v219
    v_lshlrev_b32 v218, 16, v66
    v_and_b32 v219, 0xffff0000, v66
    v_add_f32 v108, v108, v218
    v_add_f32 v109, v109, v219
    v_lshlrev_b32 v218, 16, v78
    v_and_b32 v219, 0xffff0000, v78
    v_add_f32 v108, v108, v218
    v_add_f32 v109, v109, v219
    v_cvt_pk_bf16_f32 v220, v108, v109
    v_and_b32 v221, 0xffff0000, v220
    v_lshlrev_b32 v220, 16, v220
    v_mul_f32 v220, v220, v129
    v_mul_f32 v221, v221, v129
    v_cvt_pk_bf16_f32 v220, v220, v221
    v_and_b32 v221, 0xffff0000, v220
    v_lshlrev_b32 v220, 16, v220
    v_and_b32 v219, 0xffff0000, v36
    v_lshlrev_b32 v218, 16, v36
    v_add_f32 v218, v218, v220
    v_add_f32 v219, v219, v221
    v_cvt_pk_bf16_f32 v6, v218, v219
    v_lshlrev_b32 v218, 16, v55
    v_and_b32 v219, 0xffff0000, v55
    v_add_f32 v110, v110, v218
    v_add_f32 v111, v111, v219
    v_lshlrev_b32 v218, 16, v67
    v_and_b32 v219, 0xffff0000, v67
    v_add_f32 v110, v110, v218
    v_add_f32 v111, v111, v219
    v_lshlrev_b32 v218, 16, v79
    v_and_b32 v219, 0xffff0000, v79
    v_add_f32 v110, v110, v218
    v_add_f32 v111, v111, v219
    v_cvt_pk_bf16_f32 v220, v110, v111
    v_and_b32 v221, 0xffff0000, v220
    v_lshlrev_b32 v220, 16, v220
    v_mul_f32 v220, v220, v129
    v_mul_f32 v221, v221, v129
    v_cvt_pk_bf16_f32 v220, v220, v221
    v_and_b32 v221, 0xffff0000, v220
    v_lshlrev_b32 v220, 16, v220
    v_and_b32 v219, 0xffff0000, v38
    v_lshlrev_b32 v218, 16, v38
    v_add_f32 v218, v218, v220
    v_add_f32 v219, v219, v221
    v_cvt_pk_bf16_f32 v7, v218, v219
    buffer_store_dwordx4 v[4:7], v214, s[52:55], s30 offen offset:64 sc1
    v_lshlrev_b32 v218, 16, v56
    v_and_b32 v219, 0xffff0000, v56
    v_add_f32 v112, v112, v218
    v_add_f32 v113, v113, v219
    v_lshlrev_b32 v218, 16, v68
    v_and_b32 v219, 0xffff0000, v68
    v_add_f32 v112, v112, v218
    v_add_f32 v113, v113, v219
    v_lshlrev_b32 v218, 16, v80
    v_and_b32 v219, 0xffff0000, v80
    v_add_f32 v112, v112, v218
    v_add_f32 v113, v113, v219
    v_cvt_pk_bf16_f32 v220, v112, v113
    v_and_b32 v221, 0xffff0000, v220
    v_lshlrev_b32 v220, 16, v220
    v_mul_f32 v220, v220, v129
    v_mul_f32 v221, v221, v129
    v_cvt_pk_bf16_f32 v220, v220, v221
    v_and_b32 v221, 0xffff0000, v220
    v_lshlrev_b32 v220, 16, v220
    v_and_b32 v219, 0xffff0000, v40
    v_lshlrev_b32 v218, 16, v40
    v_add_f32 v218, v218, v220
    v_add_f32 v219, v219, v221
    v_cvt_pk_bf16_f32 v8, v218, v219
    v_lshlrev_b32 v218, 16, v57
    v_and_b32 v219, 0xffff0000, v57
    v_add_f32 v114, v114, v218
    v_add_f32 v115, v115, v219
    v_lshlrev_b32 v218, 16, v69
    v_and_b32 v219, 0xffff0000, v69
    v_add_f32 v114, v114, v218
    v_add_f32 v115, v115, v219
    v_lshlrev_b32 v218, 16, v81
    v_and_b32 v219, 0xffff0000, v81
    v_add_f32 v114, v114, v218
    v_add_f32 v115, v115, v219
    v_cvt_pk_bf16_f32 v220, v114, v115
    v_and_b32 v221, 0xffff0000, v220
    v_lshlrev_b32 v220, 16, v220
    v_mul_f32 v220, v220, v129
    v_mul_f32 v221, v221, v129
    v_cvt_pk_bf16_f32 v220, v220, v221
    v_and_b32 v221, 0xffff0000, v220
    v_lshlrev_b32 v220, 16, v220
    v_and_b32 v219, 0xffff0000, v42
    v_lshlrev_b32 v218, 16, v42
    v_add_f32 v218, v218, v220
    v_add_f32 v219, v219, v221
    v_cvt_pk_bf16_f32 v9, v218, v219
    v_lshlrev_b32 v218, 16, v58
    v_and_b32 v219, 0xffff0000, v58
    v_add_f32 v116, v116, v218
    v_add_f32 v117, v117, v219
    v_lshlrev_b32 v218, 16, v70
    v_and_b32 v219, 0xffff0000, v70
    v_add_f32 v116, v116, v218
    v_add_f32 v117, v117, v219
    v_lshlrev_b32 v218, 16, v82
    v_and_b32 v219, 0xffff0000, v82
    v_add_f32 v116, v116, v218
    v_add_f32 v117, v117, v219
    v_cvt_pk_bf16_f32 v220, v116, v117
    v_and_b32 v221, 0xffff0000, v220
    v_lshlrev_b32 v220, 16, v220
    v_mul_f32 v220, v220, v129
    v_mul_f32 v221, v221, v129
    v_cvt_pk_bf16_f32 v220, v220, v221
    v_and_b32 v221, 0xffff0000, v220
    v_lshlrev_b32 v220, 16, v220
    v_and_b32 v219, 0xffff0000, v44
    v_lshlrev_b32 v218, 16, v44
    v_add_f32 v218, v218, v220
    v_add_f32 v219, v219, v221
    v_cvt_pk_bf16_f32 v10, v218, v219
    v_lshlrev_b32 v218, 16, v59
    v_and_b32 v219, 0xffff0000, v59
    v_add_f32 v118, v118, v218
    v_add_f32 v119, v119, v219
    v_lshlrev_b32 v218, 16, v71
    v_and_b32 v219, 0xffff0000, v71
    v_add_f32 v118, v118, v218
    v_add_f32 v119, v119, v219
    v_lshlrev_b32 v218, 16, v83
    v_and_b32 v219, 0xffff0000, v83
    v_add_f32 v118, v118, v218
    v_add_f32 v119, v119, v219
    v_cvt_pk_bf16_f32 v220, v118, v119
    v_and_b32 v221, 0xffff0000, v220
    v_lshlrev_b32 v220, 16, v220
    v_mul_f32 v220, v220, v129
    v_mul_f32 v221, v221, v129
    v_cvt_pk_bf16_f32 v220, v220, v221
    v_and_b32 v221, 0xffff0000, v220
    v_lshlrev_b32 v220, 16, v220
    v_and_b32 v219, 0xffff0000, v46
    v_lshlrev_b32 v218, 16, v46
    v_add_f32 v218, v218, v220
    v_add_f32 v219, v219, v221
    v_cvt_pk_bf16_f32 v11, v218, v219
    buffer_store_dwordx4 v[8:11], v214, s[52:55], s30 offen offset:128 sc1
    s_branch gated_mix__ssm_conv_s4d__geglu_ffn__prompt_kernel_fin
gated_mix__ssm_conv_s4d__geglu_ffn__prompt_kernel_notg2:
    s_load_dwordx2 s[52:53], s[0:1], 80
    s_sub_u32 s50, s62, 24
    s_lshl_b32 s50, s50, 2
    s_add_u32 s50, s50, s20
    s_mul_i32 s50, s50, 216
    s_lshr_b32 s51, s3, 1
    s_mul_i32 s51, s51, 1327104
    s_waitcnt lgkmcnt(0)
    s_mov_b32 s54, 5308416
    s_mov_b32 s55, 0x20000
    v_add_u32 v200, s50, v182
    v_lshlrev_b32 v201, 7, v200
    v_add_u32 v201, s51, v201
    v_add_u32 v202, 147456, v201
    v_cmp_le_u32 vcc, 1728, v200
    s_nop 1
    v_cndmask_b32 v201, v201, v202, vcc
    v_add_u32 v202, 147456, v201
    v_cmp_le_u32 vcc, 3456, v200
    s_nop 1
    v_cndmask_b32 v201, v201, v202, vcc
    v_add_u32 v202, 147456, v201
    v_cmp_le_u32 vcc, 5184, v200
    s_nop 1
    v_cndmask_b32 v201, v201, v202, vcc
    v_mov_b32 v202, 0x7f000000
    v_cmp_gt_u32 vcc, 54, v182
    s_nop 1
    v_cndmask_b32 v201, v202, v201, vcc
    buffer_load_dword v204, v201, s[52:55], 0 offen
    v_add_u32 v200, s50, v182
    v_add_u32 v200, 54, v200
    v_lshlrev_b32 v201, 7, v200
    v_add_u32 v201, s51, v201
    v_add_u32 v202, 147456, v201
    v_cmp_le_u32 vcc, 1728, v200
    s_nop 1
    v_cndmask_b32 v201, v201, v202, vcc
    v_add_u32 v202, 147456, v201
    v_cmp_le_u32 vcc, 3456, v200
    s_nop 1
    v_cndmask_b32 v201, v201, v202, vcc
    v_add_u32 v202, 147456, v201
    v_cmp_le_u32 vcc, 5184, v200
    s_nop 1
    v_cndmask_b32 v201, v201, v202, vcc
    v_mov_b32 v202, 0x7f000000
    v_cmp_gt_u32 vcc, 54, v182
    s_nop 1
    v_cndmask_b32 v201, v202, v201, vcc
    buffer_load_dword v205, v201, s[52:55], 0 offen
    v_add_u32 v200, s50, v182
    v_add_u32 v200, 108, v200
    v_lshlrev_b32 v201, 7, v200
    v_add_u32 v201, s51, v201
    v_add_u32 v202, 147456, v201
    v_cmp_le_u32 vcc, 1728, v200
    s_nop 1
    v_cndmask_b32 v201, v201, v202, vcc
    v_add_u32 v202, 147456, v201
    v_cmp_le_u32 vcc, 3456, v200
    s_nop 1
    v_cndmask_b32 v201, v201, v202, vcc
    v_add_u32 v202, 147456, v201
    v_cmp_le_u32 vcc, 5184, v200
    s_nop 1
    v_cndmask_b32 v201, v201, v202, vcc
    v_mov_b32 v202, 0x7f000000
    v_cmp_gt_u32 vcc, 54, v182
    s_nop 1
    v_cndmask_b32 v201, v202, v201, vcc
    buffer_load_dword v206, v201, s[52:55], 0 offen
    v_add_u32 v200, s50, v182
    v_add_u32 v200, 162, v200
    v_lshlrev_b32 v201, 7, v200
    v_add_u32 v201, s51, v201
    v_add_u32 v202, 147456, v201
    v_cmp_le_u32 vcc, 1728, v200
    s_nop 1
    v_cndmask_b32 v201, v201, v202, vcc
    v_add_u32 v202, 147456, v201
    v_cmp_le_u32 vcc, 3456, v200
    s_nop 1
    v_cndmask_b32 v201, v201, v202, vcc
    v_add_u32 v202, 147456, v201
    v_cmp_le_u32 vcc, 5184, v200
    s_nop 1
    v_cndmask_b32 v201, v201, v202, vcc
    v_mov_b32 v202, 0x7f000000
    v_cmp_gt_u32 vcc, 54, v182
    s_nop 1
    v_cndmask_b32 v201, v202, v201, vcc
    buffer_load_dword v207, v201, s[52:55], 0 offen
    s_nop 7
    v_mul_f32 v152, v64, v64
    v_mul_f32 v153, v65, v65
    v_mul_f32 v154, v66, v66
    v_mul_f32 v155, v67, v67
    v_fma_f32 v152, v152, v180, v181
    v_fma_f32 v153, v153, v180, v181
    v_fma_f32 v154, v154, v180, v181
    v_fma_f32 v155, v155, v180, v181
    v_mul_f32 v152, v152, v64
    v_mul_f32 v153, v153, v65
    v_mul_f32 v154, v154, v66
    v_mul_f32 v155, v155, v67
    v_exp_f32 v152, v152
    v_exp_f32 v153, v153
    v_exp_f32 v154, v154
    v_exp_f32 v155, v155
    v_mul_f32 v156, v64, v96
    v_mul_f32 v157, v65, v97
    v_mul_f32 v158, v66, v98
    v_mul_f32 v159, v67, v99
    v_add_f32 v152, 1.0, v152
    v_add_f32 v153, 1.0, v153
    v_add_f32 v154, 1.0, v154
    v_add_f32 v155, 1.0, v155
    v_rcp_f32 v152, v152
    v_rcp_f32 v153, v153
    v_rcp_f32 v154, v154
    v_rcp_f32 v155, v155
    v_mul_f32 v156, v156, v152
    v_mul_f32 v157, v157, v153
    v_mul_f32 v158, v158, v154
    v_mul_f32 v159, v159, v155
    v_cvt_pk_bf16_f32 v160, v156, v157
    v_cvt_pk_bf16_f32 v161, v158, v159
    v_mul_f32 v152, v68, v68
    v_mul_f32 v153, v69, v69
    v_mul_f32 v154, v70, v70
    v_mul_f32 v155, v71, v71
    v_fma_f32 v152, v152, v180, v181
    v_fma_f32 v153, v153, v180, v181
    v_fma_f32 v154, v154, v180, v181
    v_fma_f32 v155, v155, v180, v181
    v_mul_f32 v152, v152, v68
    v_mul_f32 v153, v153, v69
    v_mul_f32 v154, v154, v70
    v_mul_f32 v155, v155, v71
    v_exp_f32 v152, v152
    v_exp_f32 v153, v153
    v_exp_f32 v154, v154
    v_exp_f32 v155, v155
    v_mul_f32 v156, v68, v100
    v_mul_f32 v157, v69, v101
    v_mul_f32 v158, v70, v102
    v_mul_f32 v159, v71, v103
    v_add_f32 v152, 1.0, v152
    v_add_f32 v153, 1.0, v153
    v_add_f32 v154, 1.0, v154
    v_add_f32 v155, 1.0, v155
    v_rcp_f32 v152, v152
    v_rcp_f32 v153, v153
    v_rcp_f32 v154, v154
    v_rcp_f32 v155, v155
    v_mul_f32 v156, v156, v152
    v_mul_f32 v157, v157, v153
    v_mul_f32 v158, v158, v154
    v_mul_f32 v159, v159, v155
    v_cvt_pk_bf16_f32 v162, v156, v157
    v_cvt_pk_bf16_f32 v163, v158, v159
    buffer_store_dwordx4 v[160:163], v179, s[16:19], s27 offen offset:0 sc1
    v_mul_f32 v152, v72, v72
    v_mul_f32 v153, v73, v73
    v_mul_f32 v154, v74, v74
    v_mul_f32 v155, v75, v75
    v_fma_f32 v152, v152, v180, v181
    v_fma_f32 v153, v153, v180, v181
    v_fma_f32 v154, v154, v180, v181
    v_fma_f32 v155, v155, v180, v181
    v_mul_f32 v152, v152, v72
    v_mul_f32 v153, v153, v73
    v_mul_f32 v154, v154, v74
    v_mul_f32 v155, v155, v75
    v_exp_f32 v152, v152
    v_exp_f32 v153, v153
    v_exp_f32 v154, v154
    v_exp_f32 v155, v155
    v_mul_f32 v156, v72, v104
    v_mul_f32 v157, v73, v105
    v_mul_f32 v158, v74, v106
    v_mul_f32 v159, v75, v107
    v_add_f32 v152, 1.0, v152
    v_add_f32 v153, 1.0, v153
    v_add_f32 v154, 1.0, v154
    v_add_f32 v155, 1.0, v155
    v_rcp_f32 v152, v152
    v_rcp_f32 v153, v153
    v_rcp_f32 v154, v154
    v_rcp_f32 v155, v155
    v_mul_f32 v156, v156, v152
    v_mul_f32 v157, v157, v153
    v_mul_f32 v158, v158, v154
    v_mul_f32 v159, v159, v155
    v_cvt_pk_bf16_f32 v164, v156, v157
    v_cvt_pk_bf16_f32 v165, v158, v159
    v_mul_f32 v152, v76, v76
    v_mul_f32 v153, v77, v77
    v_mul_f32 v154, v78, v78
    v_mul_f32 v155, v79, v79
    v_fma_f32 v152, v152, v180, v181
    v_fma_f32 v153, v153, v180, v181
    v_fma_f32 v154, v154, v180, v181
    v_fma_f32 v155, v155, v180, v181
    v_mul_f32 v152, v152, v76
    v_mul_f32 v153, v153, v77
    v_mul_f32 v154, v154, v78
    v_mul_f32 v155, v155, v79
    v_exp_f32 v152, v152
    v_exp_f32 v153, v153
    v_exp_f32 v154, v154
    v_exp_f32 v155, v155
    v_mul_f32 v156, v76, v108
    v_mul_f32 v157, v77, v109
    v_mul_f32 v158, v78, v110
    v_mul_f32 v159, v79, v111
    v_add_f32 v152, 1.0, v152
    v_add_f32 v153, 1.0, v153
    v_add_f32 v154, 1.0, v154
    v_add_f32 v155, 1.0, v155
    v_rcp_f32 v152, v152
    v_rcp_f32 v153, v153
    v_rcp_f32 v154, v154
    v_rcp_f32 v155, v155
    v_mul_f32 v156, v156, v152
    v_mul_f32 v157, v157, v153
    v_mul_f32 v158, v158, v154
    v_mul_f32 v159, v159, v155
    v_cvt_pk_bf16_f32 v166, v156, v157
    v_cvt_pk_bf16_f32 v167, v158, v159
    buffer_store_dwordx4 v[164:167], v179, s[16:19], s27 offen offset:1024 sc1
    v_mul_f32 v152, v80, v80
    v_mul_f32 v153, v81, v81
    v_mul_f32 v154, v82, v82
    v_mul_f32 v155, v83, v83
    v_fma_f32 v152, v152, v180, v181
    v_fma_f32 v153, v153, v180, v181
    v_fma_f32 v154, v154, v180, v181
    v_fma_f32 v155, v155, v180, v181
    v_mul_f32 v152, v152, v80
    v_mul_f32 v153, v153, v81
    v_mul_f32 v154, v154, v82
    v_mul_f32 v155, v155, v83
    v_exp_f32 v152, v152
    v_exp_f32 v153, v153
    v_exp_f32 v154, v154
    v_exp_f32 v155, v155
    v_mul_f32 v156, v80, v112
    v_mul_f32 v157, v81, v113
    v_mul_f32 v158, v82, v114
    v_mul_f32 v159, v83, v115
    v_add_f32 v152, 1.0, v152
    v_add_f32 v153, 1.0, v153
    v_add_f32 v154, 1.0, v154
    v_add_f32 v155, 1.0, v155
    v_rcp_f32 v152, v152
    v_rcp_f32 v153, v153
    v_rcp_f32 v154, v154
    v_rcp_f32 v155, v155
    v_mul_f32 v156, v156, v152
    v_mul_f32 v157, v157, v153
    v_mul_f32 v158, v158, v154
    v_mul_f32 v159, v159, v155
    v_cvt_pk_bf16_f32 v160, v156, v157
    v_cvt_pk_bf16_f32 v161, v158, v159
    v_mul_f32 v152, v84, v84
    v_mul_f32 v153, v85, v85
    v_mul_f32 v154, v86, v86
    v_mul_f32 v155, v87, v87
    v_fma_f32 v152, v152, v180, v181
    v_fma_f32 v153, v153, v180, v181
    v_fma_f32 v154, v154, v180, v181
    v_fma_f32 v155, v155, v180, v181
    v_mul_f32 v152, v152, v84
    v_mul_f32 v153, v153, v85
    v_mul_f32 v154, v154, v86
    v_mul_f32 v155, v155, v87
    v_exp_f32 v152, v152
    v_exp_f32 v153, v153
    v_exp_f32 v154, v154
    v_exp_f32 v155, v155
    v_mul_f32 v156, v84, v116
    v_mul_f32 v157, v85, v117
    v_mul_f32 v158, v86, v118
    v_mul_f32 v159, v87, v119
    v_add_f32 v152, 1.0, v152
    v_add_f32 v153, 1.0, v153
    v_add_f32 v154, 1.0, v154
    v_add_f32 v155, 1.0, v155
    v_rcp_f32 v152, v152
    v_rcp_f32 v153, v153
    v_rcp_f32 v154, v154
    v_rcp_f32 v155, v155
    v_mul_f32 v156, v156, v152
    v_mul_f32 v157, v157, v153
    v_mul_f32 v158, v158, v154
    v_mul_f32 v159, v159, v155
    v_cvt_pk_bf16_f32 v162, v156, v157
    v_cvt_pk_bf16_f32 v163, v158, v159
    buffer_store_dwordx4 v[160:163], v179, s[16:19], s28 offen offset:0 sc1
    v_mul_f32 v152, v88, v88
    v_mul_f32 v153, v89, v89
    v_mul_f32 v154, v90, v90
    v_mul_f32 v155, v91, v91
    v_fma_f32 v152, v152, v180, v181
    v_fma_f32 v153, v153, v180, v181
    v_fma_f32 v154, v154, v180, v181
    v_fma_f32 v155, v155, v180, v181
    v_mul_f32 v152, v152, v88
    v_mul_f32 v153, v153, v89
    v_mul_f32 v154, v154, v90
    v_mul_f32 v155, v155, v91
    v_exp_f32 v152, v152
    v_exp_f32 v153, v153
    v_exp_f32 v154, v154
    v_exp_f32 v155, v155
    v_mul_f32 v156, v88, v120
    v_mul_f32 v157, v89, v121
    v_mul_f32 v158, v90, v122
    v_mul_f32 v159, v91, v123
    v_add_f32 v152, 1.0, v152
    v_add_f32 v153, 1.0, v153
    v_add_f32 v154, 1.0, v154
    v_add_f32 v155, 1.0, v155
    v_rcp_f32 v152, v152
    v_rcp_f32 v153, v153
    v_rcp_f32 v154, v154
    v_rcp_f32 v155, v155
    v_mul_f32 v156, v156, v152
    v_mul_f32 v157, v157, v153
    v_mul_f32 v158, v158, v154
    v_mul_f32 v159, v159, v155
    v_cvt_pk_bf16_f32 v164, v156, v157
    v_cvt_pk_bf16_f32 v165, v158, v159
    v_mul_f32 v152, v92, v92
    v_mul_f32 v153, v93, v93
    v_mul_f32 v154, v94, v94
    v_mul_f32 v155, v95, v95
    v_fma_f32 v152, v152, v180, v181
    v_fma_f32 v153, v153, v180, v181
    v_fma_f32 v154, v154, v180, v181
    v_fma_f32 v155, v155, v180, v181
    v_mul_f32 v152, v152, v92
    v_mul_f32 v153, v153, v93
    v_mul_f32 v154, v154, v94
    v_mul_f32 v155, v155, v95
    v_exp_f32 v152, v152
    v_exp_f32 v153, v153
    v_exp_f32 v154, v154
    v_exp_f32 v155, v155
    v_mul_f32 v156, v92, v124
    v_mul_f32 v157, v93, v125
    v_mul_f32 v158, v94, v126
    v_mul_f32 v159, v95, v127
    v_add_f32 v152, 1.0, v152
    v_add_f32 v153, 1.0, v153
    v_add_f32 v154, 1.0, v154
    v_add_f32 v155, 1.0, v155
    v_rcp_f32 v152, v152
    v_rcp_f32 v153, v153
    v_rcp_f32 v154, v154
    v_rcp_f32 v155, v155
    v_mul_f32 v156, v156, v152
    v_mul_f32 v157, v157, v153
    v_mul_f32 v158, v158, v154
    v_mul_f32 v159, v159, v155
    v_cvt_pk_bf16_f32 v166, v156, v157
    v_cvt_pk_bf16_f32 v167, v158, v159
    buffer_store_dwordx4 v[164:167], v179, s[16:19], s28 offen offset:1024 sc1
    s_cmp_ge_u32 s62, 30
    s_cbranch_scc1 gated_mix__ssm_conv_s4d__geglu_ffn__prompt_kernel_pre_sp
    s_mul_i32 s50, s3, 6
    s_add_u32 s50, s50, s62
    s_sub_u32 s50, s50, 24
    s_lshl_b32 s50, s50, 2
    s_add_u32 s21, s50, s20
    s_movk_i32 s28, 192
    s_cmp_lt_u32 s21, 128
    s_cselect_b32 s26, 3, 2
    s_mov_b32 s61, s21
    s_mov_b32 s29, s26
    s_load_dwordx2 s[44:45], s[0:1], 0
    s_load_dwordx2 s[40:41], s[0:1], 88
    s_mov_b32 s31, s21
    s_mul_i32 s22, s20, 40960
    s_add_u32 s8, s4, 37748720
    s_addc_u32 s9, s5, 0
    s_mov_b32 s10, 2396176
    s_mov_b32 s11, 0x20000
    s_add_u32 s12, s4, 40894464
    s_addc_u32 s13, s5, 0
    s_mov_b32 s14, 2359296
    s_mov_b32 s15, 0x20000
    v_lshlrev_b32 v168, 4, v182
    v_xor_b32 v196, s65, v196
    v_xor_b32 v197, s65, v197
    v_xor_b32 v198, s65, v198
    v_xor_b32 v199, s65, v199
    v_or3_b32 v196, v196, v197, v198
    v_or_b32 v196, v196, v199
    v_cmp_ne_u32 vcc, 0, v196
    s_cbranch_vccz gated_mix__ssm_conv_s4d__geglu_ffn__prompt_kernel_sfok_38
    s_add_u32 s52, s4, 48234496
    s_addc_u32 s53, s5, 0
    s_mov_b32 s54, 16384
    s_mov_b32 s55, 0x20000
    s_movk_i32 s56, 5120
    s_mov_b32 s63, 0x40000
gated_mix__ssm_conv_s4d__geglu_ffn__prompt_kernel_poll_39:
    buffer_load_dwordx4 v[228:231], v168, s[52:55], s56 offen sc0 sc1
    s_waitcnt vmcnt(0)
    v_xor_b32 v228, s65, v228
    v_xor_b32 v229, s65, v229
    v_xor_b32 v230, s65, v230
    v_xor_b32 v231, s65, v231
    v_or3_b32 v228, v228, v229, v230
    v_or_b32 v228, v228, v231
    v_cmp_ne_u32 vcc, 0, v228
    s_cbranch_vccz gated_mix__ssm_conv_s4d__geglu_ffn__prompt_kernel_pd_40
    s_sleep 10
    s_sub_u32 s63, s63, 1
    s_cmp_lg_u32 s63, 0
    s_cbranch_scc1 gated_mix__ssm_conv_s4d__geglu_ffn__prompt_kernel_poll_39
gated_mix__ssm_conv_s4d__geglu_ffn__prompt_kernel_pd_40:
gated_mix__ssm_conv_s4d__geglu_ffn__prompt_kernel_sfok_38:
    s_mul_i32 s27, s21, 4160
    s_add_u32 s27, s27, 8
    s_lshl_b32 s30, s21, 12
    buffer_load_dwordx4 v[208:211], v168, s[12:15], s30 offen offset:0 sc1
    buffer_load_dwordx4 v[212:215], v168, s[12:15], s30 offen offset:1024 sc1
    buffer_load_dwordx4 v[216:219], v168, s[12:15], s30 offen offset:2048 sc1
    buffer_load_dwordx4 v[220:223], v168, s[12:15], s30 offen offset:3072 sc1
    buffer_load_dwordx4 v[226:229], v168, s[8:11], s27 offen offset:8 sc1
    buffer_load_dwordx2 v[224:225], v168, s[8:11], s27 offen offset:0 sc1
    buffer_load_dwordx4 v[232:235], v168, s[8:11], s27 offen offset:1032 sc1
    buffer_load_dwordx2 v[230:231], v168, s[8:11], s27 offen offset:1024 sc1
    buffer_load_dwordx4 v[238:241], v168, s[8:11], s27 offen offset:2056 sc1
    buffer_load_dwordx2 v[236:237], v168, s[8:11], s27 offen offset:2048 sc1
    buffer_load_dwordx4 v[244:247], v168, s[8:11], s27 offen offset:3080 sc1
    buffer_load_dwordx2 v[242:243], v168, s[8:11], s27 offen offset:3072 sc1
    s_add_u32 s24, s27, 4096
    buffer_load_dwordx4 v[250:253], v168, s[8:11], s24 offen offset:8 sc1
    buffer_load_dwordx2 v[248:249], v168, s[8:11], s24 offen offset:0 sc1
    s_add_u32 s36, s21, s28
    s_mul_i32 s27, s36, 4160
    s_add_u32 s27, s27, 8
    s_cmp_gt_u32 s26, 1
    s_cselect_b32 s10, s10, 0
    buffer_load_dwordx4 a[2:5], v168, s[8:11], s27 offen offset:8 sc1
    buffer_load_dwordx2 a[0:1], v168, s[8:11], s27 offen offset:0 sc1
    buffer_load_dwordx4 a[8:11], v168, s[8:11], s27 offen offset:1032 sc1
    buffer_load_dwordx2 a[6:7], v168, s[8:11], s27 offen offset:1024 sc1
    buffer_load_dwordx4 a[14:17], v168, s[8:11], s27 offen offset:2056 sc1
    buffer_load_dwordx2 a[12:13], v168, s[8:11], s27 offen offset:2048 sc1
    buffer_load_dwordx4 a[20:23], v168, s[8:11], s27 offen offset:3080 sc1
    buffer_load_dwordx2 a[18:19], v168, s[8:11], s27 offen offset:3072 sc1
    s_add_u32 s24, s27, 4096
    buffer_load_dwordx4 a[26:29], v168, s[8:11], s24 offen offset:8 sc1
    buffer_load_dwordx2 a[24:25], v168, s[8:11], s24 offen offset:0 sc1
    s_waitcnt vmcnt(0)
    s_barrier
    s_cmp_eq_u32 s20, 0
    s_cbranch_scc0 gated_mix__ssm_conv_s4d__geglu_ffn__prompt_kernel_nhf_41
    s_add_u32 s52, s4, 48234496
    s_addc_u32 s53, s5, 0
    s_mov_b32 s54, 16384
    s_mov_b32 s55, 0x20000
    v_mov_b32 v194, s65
    v_lshlrev_b32 v195, 2, v182
    s_lshl_b32 s57, s64, 2
    s_add_u32 s57, s57, 12288
    s_mov_b64 exec, 15
    buffer_store_dword v194, v195, s[52:55], s57 offen sc0 sc1
    s_mov_b64 exec, 1
    buffer_store_dword v194, v195, s[52:55], s64 offen sc0 sc1
    s_mov_b64 exec, -1
gated_mix__ssm_conv_s4d__geglu_ffn__prompt_kernel_nhf_41:
    s_branch gated_mix__ssm_conv_s4d__geglu_ffn__prompt_kernel_conv
gated_mix__ssm_conv_s4d__geglu_ffn__prompt_kernel_pre_sp:
    s_waitcnt vmcnt(0)
    s_barrier
    s_cmp_eq_u32 s20, 0
    s_cbranch_scc0 gated_mix__ssm_conv_s4d__geglu_ffn__prompt_kernel_nhf_42
    s_add_u32 s52, s4, 48234496
    s_addc_u32 s53, s5, 0
    s_mov_b32 s54, 16384
    s_mov_b32 s55, 0x20000
    v_mov_b32 v194, s65
    v_lshlrev_b32 v195, 2, v182
    s_lshl_b32 s57, s64, 2
    s_add_u32 s57, s57, 12288
    s_mov_b64 exec, 15
    buffer_store_dword v194, v195, s[52:55], s57 offen sc0 sc1
    s_mov_b64 exec, 1
    buffer_store_dword v194, v195, s[52:55], s64 offen sc0 sc1
    s_mov_b64 exec, -1
gated_mix__ssm_conv_s4d__geglu_ffn__prompt_kernel_nhf_42:
gated_mix__ssm_conv_s4d__geglu_ffn__prompt_kernel_g:
    s_lshl_b32 s60, s3, 1
    s_add_u32 s60, s60, s62
    s_sub_u32 s60, s60, 30
    s_and_b32 s31, s20, 1
    s_lshr_b32 s32, s20, 1
    s_lshl_b32 s34, s20, 14
    s_xor_b32 s35, s34, 16384
    s_lshl_b32 s33, s60, 2
    s_add_u32 s33, s33, s32
    s_add_u32 s33, s33, 512
    s_load_dwordx8 s[40:47], s[0:1], 8
    s_load_dwordx2 s[48:49], s[0:1], 40
    s_getpc_b64 s[50:51]
kg_pc_43:
    s_add_u32 s50, s50, kmap_table-kg_pc_43
    s_addc_u32 s51, s51, 0
    s_add_u32 s36, s33, 2
    s_waitcnt lgkmcnt(0)
    s_lshl_b32 s56, s33, 8
    s_lshl_b32 s57, s31, 7
    s_add_u32 s56, s56, s57
    v_lshlrev_b32 v5, 1, v182
    s_mov_b32 s54, 147456
    s_mov_b32 s55, 0x20000
    s_mov_b32 s52, s40
    s_mov_b32 s53, s41
    buffer_load_ushort v144, v5, s[52:55], s56 offen
    s_mov_b32 s52, s42
    s_mov_b32 s53, s43
    buffer_load_ushort v145, v5, s[52:55], s56 offen
    s_mov_b32 s52, s44
    s_mov_b32 s53, s45
    buffer_load_ushort v146, v5, s[52:55], s56 offen
    s_mov_b32 s52, s46
    s_mov_b32 s53, s47
    buffer_load_ushort v147, v5, s[52:55], s56 offen
    s_mov_b32 s52, s48
    s_mov_b32 s53, s49
    s_mov_b32 s54, 1152
    s_lshl_b32 s57, s33, 1
    v_mov_b32 v7, 0
    buffer_load_ushort v148, v7, s[52:55], s57 offen
    s_lshl_b32 s56, s36, 8
    s_lshl_b32 s57, s31, 7
    s_add_u32 s56, s56, s57
    v_lshlrev_b32 v5, 1, v182
    s_mov_b32 s54, 147456
    s_mov_b32 s55, 0x20000
    s_mov_b32 s52, s40
    s_mov_b32 s53, s41
    buffer_load_ushort v150, v5, s[52:55], s56 offen
    s_mov_b32 s52, s42
    s_mov_b32 s53, s43
    buffer_load_ushort v151, v5, s[52:55], s56 offen
    s_mov_b32 s52, s44
    s_mov_b32 s53, s45
    buffer_load_ushort v152, v5, s[52:55], s56 offen
    s_mov_b32 s52, s46
    s_mov_b32 s53, s47
    buffer_load_ushort v153, v5, s[52:55], s56 offen
    s_mov_b32 s52, s48
    s_mov_b32 s53, s49
    s_mov_b32 s54, 1152
    s_lshl_b32 s57, s36, 1
    v_mov_b32 v7, 0
    buffer_load_ushort v154, v7, s[52:55], s57 offen
    s_lshl_b32 s57, s31, 11
    v_lshlrev_b32 v6, 4, v182
    v_add_u32 v6, s57, v6
    global_load_dwordx4 v[72:75], v6, s[50:51]
    global_load_dwordx4 v[76:79], v6, s[50:51] offset:1024
    v_and_b32 v8, 3, v182
    v_lshlrev_b32 v8, 4, v8
    v_add_u32 v8, 4096, v8
    global_load_dwordx4 v[80:83], v8, s[50:51]
    v_lshlrev_b32 v11, 2, v182
    v_add_u32 v11, s34, v11
    v_and_b32 v13, 31, v182
    v_mul_u32_u24 v13, 272, v13
    v_lshrrev_b32 v14, 5, v182
    v_lshlrev_b32 v14, 4, v14
    v_add_u32 v13, v13, v14
    v_add_u32 v13, s34, v13
    s_waitcnt vmcnt(8)
    v_lshlrev_b32 v148, 16, v148
    v_lshlrev_b32 v15, 16, v144
    v_mul_f32 v10, 0x3fb8aa3b, v148
    v_mul_f32 v15, 0x3fb8aa3b, v15
    v_exp_f32 v10, v10
    v_exp_f32 v15, v15
    v_lshlrev_b32 v16, 16, v145
    v_cvt_pk_bf16_f32 v10, v10, v15
    v_and_b32 v15, 0xffff0000, v10
    v_lshlrev_b32 v10, 16, v10
    v_mul_f32 v16, v16, v10
    v_mul_f32 v15, v15, v10
    v_mul_f32 v16, 0x3e22f983, v16
    v_mul_f32 v15, 0xbfb8aa3b, v15
    v_lshlrev_b32 v30, 16, v146
    v_lshlrev_b32 v31, 16, v147
    v_add_f32 v58, v10, v10
    v_mul_f32 v30, v30, v58
    v_mul_f32 v31, v31, v58
    v_mul_f32 v32, 1.0, v15
    v_mul_f32 v38, 0x41000000, v15
    v_mul_f32 v44, 0x43800000, v15
    v_mul_f32 v33, 1.0, v16
    v_mul_f32 v39, 0x41000000, v16
    v_mul_f32 v45, 0x43800000, v16
    v_exp_f32 v32, v32
    v_exp_f32 v38, v38
    v_exp_f32 v44, v44
    v_fract_f32 v33, v33
    v_fract_f32 v39, v39
    v_fract_f32 v45, v45
    v_cos_f32 v18, v33
    v_cos_f32 v24, v39
    v_cos_f32 v26, v45
    v_sin_f32 v19, v33
    v_sin_f32 v25, v39
    v_sin_f32 v27, v45
    v_mul_f32 v18, v18, v32
    v_mul_f32 v24, v24, v38
    v_mul_f32 v26, v26, v44
    v_mul_f32 v19, v19, v32
    v_mul_f32 v25, v25, v38
    v_mul_f32 v27, v27, v44
    v_mul_f32 v40, v18, v18
    v_mul_f32 v46, v24, v24
    v_mul_f32 v41, v18, v19
    v_mul_f32 v47, v24, v25
    v_fma_f32 v20, -v19, v19, v40
    v_fma_f32 v28, -v25, v25, v46
    v_fma_f32 v21, v19, v18, v41
    v_fma_f32 v29, v25, v24, v47
    v_mul_f32 v40, v20, v20
    v_mul_f32 v41, v20, v21
    v_fma_f32 v22, -v21, v21, v40
    v_fma_f32 v23, v21, v20, v41
    v_cvt_pk_bf16_f32 v36, v30, -v31
    v_mul_f32 v40, v30, v26
    v_mov_b32 v44, 1.0
    v_cvt_pk_bf16_f32 v54, v24, v25
    ds_write_b32 v11, v36 offset:0
    v_mul_f32 v41, v30, v27
    v_mov_b32 v45, 0
    ds_write_b32 v11, v54 offset:6032
    v_mul_f32 v34, v30, v18
    v_fma_f32 v56, -v31, v27, v40
    v_cvt_pk_bf16_f32 v48, v44, v45
    v_mul_f32 v52, v24, v28
    v_mul_f32 v35, v30, v19
    v_fma_f32 v57, v31, v26, v41
    ds_write_b32 v11, v48 offset:5760
    v_mul_f32 v53, v24, v29
    v_fma_f32 v32, -v31, v19, v34
    v_cvt_pk_bf16_f32 v42, v56, -v57
    v_cvt_pk_bf16_f32 v48, v28, v29
    v_fma_f32 v50, -v25, v29, v52
    v_fma_f32 v33, v31, v18, v35
    ds_write_b32 v11, v42 offset:2176
    ds_write_b32 v11, v48 offset:6304
    v_fma_f32 v51, v25, v28, v53
    v_cvt_pk_bf16_f32 v36, v32, -v33
    v_mul_f32 v40, v56, v20
    v_mul_f32 v46, v28, v28
    v_cvt_pk_bf16_f32 v54, v50, v51
    ds_write_b32 v11, v36 offset:272
    v_mul_f32 v41, v56, v21
    v_mul_f32 v47, v28, v29
    ds_write_b32 v11, v54 offset:6576
    v_mul_f32 v34, v32, v18
    v_fma_f32 v38, -v57, v21, v40
    v_fma_f32 v44, -v29, v29, v46
    v_mul_f32 v52, v50, v28
    v_mul_f32 v35, v32, v19
    v_fma_f32 v39, v57, v20, v41
    v_fma_f32 v45, v29, v28, v47
    v_mul_f32 v53, v50, v29
    v_fma_f32 v32, -v33, v19, v34
    v_cvt_pk_bf16_f32 v42, v38, -v39
    v_cvt_pk_bf16_f32 v48, v44, v45
    v_fma_f32 v50, -v51, v29, v52
    v_fma_f32 v33, v33, v18, v35
    ds_write_b32 v11, v42 offset:2448
    ds_write_b32 v11, v48 offset:6848
    v_fma_f32 v51, v51, v28, v53
    v_cvt_pk_bf16_f32 v36, v32, -v33
    v_mul_f32 v40, v38, v20
    v_mul_f32 v46, v44, v28
    v_cvt_pk_bf16_f32 v54, v50, v51
    ds_write_b32 v11, v36 offset:544
    v_mul_f32 v41, v38, v21
    v_mul_f32 v47, v44, v29
    ds_write_b32 v11, v54 offset:7120
    v_mul_f32 v34, v32, v18
    v_fma_f32 v38, -v39, v21, v40
    v_fma_f32 v44, -v45, v29, v46
    v_mul_f32 v52, v50, v28
    v_mul_f32 v35, v32, v19
    v_fma_f32 v39, v39, v20, v41
    v_fma_f32 v45, v45, v28, v47
    v_mul_f32 v53, v50, v29
    v_fma_f32 v32, -v33, v19, v34
    v_cvt_pk_bf16_f32 v42, v38, -v39
    v_cvt_pk_bf16_f32 v48, v44, v45
    v_fma_f32 v50, -v51, v29, v52
    v_fma_f32 v33, v33, v18, v35
    ds_write_b32 v11, v42 offset:2720
    ds_write_b32 v11, v48 offset:7392
    v_fma_f32 v51, v51, v28, v53
    v_cvt_pk_bf16_f32 v36, v32, -v33
    v_mul_f32 v40, v38, v20
    v_mul_f32 v46, v44, v28
    v_cvt_pk_bf16_f32 v54, v50, v51
    ds_write_b32 v11, v36 offset:816
    v_mul_f32 v41, v38, v21
    v_mul_f32 v47, v44, v29
    ds_write_b32 v11, v54 offset:7664
    v_mul_f32 v34, v32, v18
    v_fma_f32 v38, -v39, v21, v40
    v_fma_f32 v44, -v45, v29, v46
    v_mul_f32 v52, v50, v28
    v_mul_f32 v35, v32, v19
    v_fma_f32 v39, v39, v20, v41
    v_fma_f32 v45, v45, v28, v47
    v_mul_f32 v53, v50, v29
    v_fma_f32 v32, -v33, v19, v34
    v_cvt_pk_bf16_f32 v42, v38, -v39
    v_cvt_pk_bf16_f32 v48, v44, v45
    v_fma_f32 v50, -v51, v29, v52
    v_fma_f32 v33, v33, v18, v35
    ds_write_b32 v11, v42 offset:2992
    ds_write_b32 v11, v48 offset:7936
    v_fma_f32 v51, v51, v28, v53
    v_cvt_pk_bf16_f32 v36, v32, -v33
    v_mul_f32 v40, v56, v26
    v_mul_f32 v46, v44, v28
    v_cvt_pk_bf16_f32 v54, v50, v51
    ds_write_b32 v11, v36 offset:1088
    v_mul_f32 v41, v56, v27
    v_mul_f32 v47, v44, v29
    ds_write_b32 v11, v54 offset:8208
    v_mul_f32 v34, v32, v18
    v_fma_f32 v56, -v57, v27, v40
    v_fma_f32 v44, -v45, v29, v46
    v_mul_f32 v52, v50, v28
    v_mul_f32 v35, v32, v19
    v_fma_f32 v57, v57, v26, v41
    v_fma_f32 v45, v45, v28, v47
    v_mul_f32 v53, v50, v29
    v_fma_f32 v32, -v33, v19, v34
    v_cvt_pk_bf16_f32 v42, v56, -v57
    v_cvt_pk_bf16_f32 v48, v44, v45
    v_fma_f32 v50, -v51, v29, v52
    v_fma_f32 v33, v33, v18, v35
    ds_write_b32 v11, v42 offset:3264
    ds_write_b32 v11, v48 offset:8480
    v_fma_f32 v51, v51, v28, v53
    v_cvt_pk_bf16_f32 v36, v32, -v33
    v_mul_f32 v40, v56, v22
    v_mul_f32 v46, v44, v28
    v_cvt_pk_bf16_f32 v54, v50, v51
    ds_write_b32 v11, v36 offset:1360
    v_mul_f32 v41, v56, v23
    v_mul_f32 v47, v44, v29
    ds_write_b32 v11, v54 offset:8752
    v_mul_f32 v34, v32, v18
    v_fma_f32 v38, -v57, v23, v40
    v_fma_f32 v44, -v45, v29, v46
    v_mul_f32 v52, v50, v28
    v_mul_f32 v35, v32, v19
    v_fma_f32 v39, v57, v22, v41
    v_fma_f32 v45, v45, v28, v47
    v_mul_f32 v53, v50, v29
    v_fma_f32 v32, -v33, v19, v34
    v_cvt_pk_bf16_f32 v42, v38, -v39
    v_cvt_pk_bf16_f32 v48, v44, v45
    v_fma_f32 v50, -v51, v29, v52
    v_fma_f32 v33, v33, v18, v35
    ds_write_b32 v11, v42 offset:3536
    ds_write_b32 v11, v48 offset:9024
    v_fma_f32 v51, v51, v28, v53
    v_cvt_pk_bf16_f32 v36, v32, -v33
    v_mul_f32 v40, v56, v26
    v_mul_f32 v46, v44, v28
    v_cvt_pk_bf16_f32 v54, v50, v51
    ds_write_b32 v11, v36 offset:1632
    v_mul_f32 v41, v56, v27
    v_mul_f32 v47, v44, v29
    ds_write_b32 v11, v54 offset:9296
    v_mul_f32 v34, v32, v18
    v_fma_f32 v56, -v57, v27, v40
    v_fma_f32 v44, -v45, v29, v46
    v_mul_f32 v52, v50, v28
    v_mul_f32 v35, v32, v19
    v_fma_f32 v57, v57, v26, v41
    v_fma_f32 v45, v45, v28, v47
    v_mul_f32 v53, v50, v29
    v_fma_f32 v32, -v33, v19, v34
    v_cvt_pk_bf16_f32 v42, v56, -v57
    v_cvt_pk_bf16_f32 v48, v44, v45
    v_fma_f32 v50, -v51, v29, v52
    v_fma_f32 v33, v33, v18, v35
    ds_write_b32 v11, v42 offset:3808
    ds_write_b32 v11, v48 offset:9568
    v_fma_f32 v51, v51, v28, v53
    v_cvt_pk_bf16_f32 v36, v32, -v33
    v_mul_f32 v40, v56, v22
    v_mul_f32 v46, v44, v28
    v_cvt_pk_bf16_f32 v54, v50, v51
    ds_write_b32 v11, v36 offset:1904
    v_mul_f32 v41, v56, v23
    v_mul_f32 v47, v44, v29
    ds_write_b32 v11, v54 offset:9840
    v_fma_f32 v38, -v57, v23, v40
    v_fma_f32 v44, -v45, v29, v46
    v_mul_f32 v52, v50, v28
    v_fma_f32 v39, v57, v22, v41
    v_fma_f32 v45, v45, v28, v47
    v_mul_f32 v53, v50, v29
    v_cvt_pk_bf16_f32 v42, v38, -v39
    v_cvt_pk_bf16_f32 v48, v44, v45
    v_fma_f32 v50, -v51, v29, v52
    ds_write_b32 v11, v42 offset:4080
    ds_write_b32 v11, v48 offset:10112
    v_fma_f32 v51, v51, v28, v53
    v_mul_f32 v40, v56, v26
    v_mul_f32 v46, v44, v28
    v_cvt_pk_bf16_f32 v54, v50, v51
    v_mul_f32 v41, v56, v27
    v_mul_f32 v47, v44, v29
    ds_write_b32 v11, v54 offset:10384
    v_fma_f32 v56, -v57, v27, v40
    v_fma_f32 v44, -v45, v29, v46
    v_mul_f32 v52, v50, v28
    v_fma_f32 v57, v57, v26, v41
    v_fma_f32 v45, v45, v28, v47
    v_mul_f32 v53, v50, v29
    v_cvt_pk_bf16_f32 v42, v56, -v57
    v_cvt_pk_bf16_f32 v48, v44, v45
    v_fma_f32 v50, -v51, v29, v52
    ds_write_b32 v11, v42 offset:4352
    ds_write_b32 v11, v48 offset:10656
    v_fma_f32 v51, v51, v28, v53
    v_mul_f32 v40, v56, v26
    v_mul_f32 v46, v44, v28
    v_cvt_pk_bf16_f32 v54, v50, v51
    v_mul_f32 v41, v56, v27
    v_mul_f32 v47, v44, v29
    ds_write_b32 v11, v54 offset:10928
    v_fma_f32 v56, -v57, v27, v40
    v_fma_f32 v44, -v45, v29, v46
    v_mul_f32 v52, v50, v28
    v_fma_f32 v57, v57, v26, v41
    v_fma_f32 v45, v45, v28, v47
    v_mul_f32 v53, v50, v29
    v_cvt_pk_bf16_f32 v42, v56, -v57
    v_cvt_pk_bf16_f32 v48, v44, v45
    v_fma_f32 v50, -v51, v29, v52
    ds_write_b32 v11, v42 offset:4624
    ds_write_b32 v11, v48 offset:11200
    v_fma_f32 v51, v51, v28, v53
    v_mul_f32 v40, v56, v26
    v_mul_f32 v46, v44, v28
    v_cvt_pk_bf16_f32 v54, v50, v51
    v_mul_f32 v41, v56, v27
    v_mul_f32 v47, v44, v29
    ds_write_b32 v11, v54 offset:11472
    v_fma_f32 v56, -v57, v27, v40
    v_fma_f32 v44, -v45, v29, v46
    v_mul_f32 v52, v50, v28
    v_fma_f32 v57, v57, v26, v41
    v_fma_f32 v45, v45, v28, v47
    v_mul_f32 v53, v50, v29
    v_cvt_pk_bf16_f32 v42, v56, -v57
    v_cvt_pk_bf16_f32 v48, v44, v45
    v_fma_f32 v50, -v51, v29, v52
    ds_write_b32 v11, v42 offset:4896
    ds_write_b32 v11, v48 offset:11744
    v_fma_f32 v51, v51, v28, v53
    v_mul_f32 v40, v56, v26
    v_mul_f32 v46, v44, v28
    v_cvt_pk_bf16_f32 v54, v50, v51
    v_mul_f32 v41, v56, v27
    v_mul_f32 v47, v44, v29
    ds_write_b32 v11, v54 offset:12016
    v_fma_f32 v56, -v57, v27, v40
    v_fma_f32 v44, -v45, v29, v46
    v_mul_f32 v52, v50, v28
    v_fma_f32 v57, v57, v26, v41
    v_fma_f32 v45, v45, v28, v47
    v_mul_f32 v53, v50, v29
    v_cvt_pk_bf16_f32 v42, v56, -v57
    v_cvt_pk_bf16_f32 v48, v44, v45
    v_fma_f32 v50, -v51, v29, v52
    ds_write_b32 v11, v42 offset:5168
    ds_write_b32 v11, v48 offset:12288
    v_fma_f32 v51, v51, v28, v53
    v_mul_f32 v40, v56, v26
    v_mul_f32 v46, v44, v28
    v_cvt_pk_bf16_f32 v54, v50, v51
    v_mul_f32 v41, v56, v27
    v_mul_f32 v47, v44, v29
    ds_write_b32 v11, v54 offset:12560
    v_fma_f32 v56, -v57, v27, v40
    v_fma_f32 v44, -v45, v29, v46
    v_mul_f32 v52, v50, v28
    v_fma_f32 v57, v57, v26, v41
    v_fma_f32 v45, v45, v28, v47
    v_mul_f32 v53, v50, v29
    v_cvt_pk_bf16_f32 v42, v56, -v57
    v_cvt_pk_bf16_f32 v48, v44, v45
    v_fma_f32 v50, -v51, v29, v52
    ds_write_b32 v11, v42 offset:5440
    ds_write_b32 v11, v48 offset:12832
    v_fma_f32 v51, v51, v28, v53
    v_mul_f32 v46, v44, v28
    v_cvt_pk_bf16_f32 v54, v50, v51
    v_mul_f32 v47, v44, v29
    ds_write_b32 v11, v54 offset:13104
    v_fma_f32 v44, -v45, v29, v46
    v_mul_f32 v52, v50, v28
    v_fma_f32 v45, v45, v28, v47
    v_mul_f32 v53, v50, v29
    v_cvt_pk_bf16_f32 v48, v44, v45
    v_fma_f32 v50, -v51, v29, v52
    ds_write_b32 v11, v48 offset:13376
    v_fma_f32 v51, v51, v28, v53
    v_mul_f32 v46, v44, v28
    v_cvt_pk_bf16_f32 v54, v50, v51
    v_mul_f32 v47, v44, v29
    ds_write_b32 v11, v54 offset:13648
    v_fma_f32 v44, -v45, v29, v46
    v_mul_f32 v52, v50, v28
    v_fma_f32 v45, v45, v28, v47
    v_mul_f32 v53, v50, v29
    v_cvt_pk_bf16_f32 v48, v44, v45
    v_fma_f32 v50, -v51, v29, v52
    ds_write_b32 v11, v48 offset:13920
    v_fma_f32 v51, v51, v28, v53
    v_cvt_pk_bf16_f32 v54, v50, v51
    ds_write_b32 v11, v54 offset:14192
    s_waitcnt lgkmcnt(0)
    ds_read_b128 v[112:115], v13 offset:0
    ds_read_b128 v[116:119], v13 offset:5760
    ds_read_b128 v[120:123], v13 offset:32
    ds_read_b128 v[124:127], v13 offset:5792
    ds_read_b128 v[128:131], v13 offset:64
    ds_read_b128 v[132:135], v13 offset:5824
    ds_read_b128 v[136:139], v13 offset:96
    ds_read_b128 v[140:143], v13 offset:5856
    s_waitcnt lgkmcnt(6)
    v_mfma_f32_32x32x16_bf16 v[96:111], v[112:115], v[116:119], 0
    s_nop 3
    ds_read_b128 v[112:115], v13 offset:128
    ds_read_b128 v[116:119], v13 offset:5888
    s_waitcnt lgkmcnt(6)
    v_mfma_f32_32x32x16_bf16 v[96:111], v[120:123], v[124:127], v[96:111]
    s_nop 3
    ds_read_b128 v[120:123], v13 offset:160
    ds_read_b128 v[124:127], v13 offset:5920
    s_waitcnt lgkmcnt(6)
    v_mfma_f32_32x32x16_bf16 v[96:111], v[128:131], v[132:135], v[96:111]
    s_nop 3
    ds_read_b128 v[128:131], v13 offset:192
    ds_read_b128 v[132:135], v13 offset:5952
    s_waitcnt lgkmcnt(6)
    v_mfma_f32_32x32x16_bf16 v[96:111], v[136:139], v[140:143], v[96:111]
    s_nop 3
    ds_read_b128 v[136:139], v13 offset:224
    ds_read_b128 v[140:143], v13 offset:5984
    s_waitcnt lgkmcnt(6)
    v_mfma_f32_32x32x16_bf16 v[96:111], v[112:115], v[116:119], v[96:111]
    s_waitcnt lgkmcnt(4)
    v_mfma_f32_32x32x16_bf16 v[96:111], v[120:123], v[124:127], v[96:111]
    s_waitcnt lgkmcnt(2)
    v_mfma_f32_32x32x16_bf16 v[96:111], v[128:131], v[132:135], v[96:111]
    s_waitcnt lgkmcnt(0)
    v_mfma_f32_32x32x16_bf16 v[96:111], v[136:139], v[140:143], v[96:111]
    v_lshlrev_b32 v60, 4, v182
    v_add_u32 v61, s35, v60
    v_add_u32 v60, s34, v60
    s_nop 7
    s_nop 3
    ds_write_b128 v60, v[96:99] offset:0
    ds_write_b128 v60, v[100:103] offset:1024
    ds_write_b128 v60, v[104:107] offset:2048
    s_waitcnt lgkmcnt(0)
    s_barrier
    ds_read_b128 v[112:115], v61 offset:0
    ds_read_b128 v[116:119], v61 offset:1024
    ds_read_b128 v[120:123], v61 offset:2048
    v_and_b32 v60, 31, v182
    v_lshlrev_b32 v60, 1, v60
    v_lshrrev_b32 v61, 5, v182
    v_lshlrev_b32 v61, 8, v61
    v_add_u32 v60, v60, v61
    v_add_u32 v60, s34, v60
    v_mov_b32 v58, s34
    s_add_u32 s52, s4, 37748736
    s_addc_u32 s53, s5, 0
    s_mov_b32 s54, 2396160
    s_mov_b32 s55, 0x20000
    s_mul_i32 s56, s33, 4160
    s_waitcnt lgkmcnt(0)
    v_add_f32 v96, v96, v112
    v_add_f32 v97, v97, v113
    v_add_f32 v98, v98, v114
    v_add_f32 v99, v99, v115
    v_add_f32 v100, v100, v116
    v_add_f32 v101, v101, v117
    v_add_f32 v102, v102, v118
    v_add_f32 v103, v103, v119
    v_add_f32 v104, v104, v120
    v_add_f32 v105, v105, v121
    v_add_f32 v106, v106, v122
    v_add_f32 v107, v107, v123
    v_cvt_pk_bf16_f32 v32, v96, v97
    ds_write_b16 v60, v32 offset:14464
    ds_write_b16_d16_hi v60, v32 offset:14528
    v_cvt_pk_bf16_f32 v38, v98, v99
    ds_write_b16 v60, v38 offset:14592
    ds_write_b16_d16_hi v60, v38 offset:14656
    v_cvt_pk_bf16_f32 v44, v100, v101
    ds_write_b16 v60, v44 offset:14976
    ds_write_b16_d16_hi v60, v44 offset:15040
    v_cvt_pk_bf16_f32 v50, v102, v103
    ds_write_b16 v60, v50 offset:15104
    ds_write_b16_d16_hi v60, v50 offset:15168
    v_cvt_pk_bf16_f32 v32, v104, v105
    ds_write_b16 v60, v32 offset:15488
    ds_write_b16_d16_hi v60, v32 offset:15552
    v_cvt_pk_bf16_f32 v38, v106, v107
    ds_write_b16 v60, v38 offset:15616
    ds_write_b16_d16_hi v60, v38 offset:15680
    v_mov_b32 v59, 0
    ds_write_b16 v58, v59 offset:15808
    s_waitcnt vmcnt(0) lgkmcnt(0)
    v_add_u32_sdwa v32, v58, v72 dst_sel:DWORD dst_unused:UNUSED_PAD src0_sel:DWORD src1_sel:WORD_0
    v_add_u32_sdwa v33, v58, v72 dst_sel:DWORD dst_unused:UNUSED_PAD src0_sel:DWORD src1_sel:WORD_1
    v_add_u32_sdwa v34, v58, v73 dst_sel:DWORD dst_unused:UNUSED_PAD src0_sel:DWORD src1_sel:WORD_0
    v_add_u32_sdwa v35, v58, v73 dst_sel:DWORD dst_unused:UNUSED_PAD src0_sel:DWORD src1_sel:WORD_1
    v_add_u32_sdwa v36, v58, v74 dst_sel:DWORD dst_unused:UNUSED_PAD src0_sel:DWORD src1_sel:WORD_0
    v_add_u32_sdwa v37, v58, v74 dst_sel:DWORD dst_unused:UNUSED_PAD src0_sel:DWORD src1_sel:WORD_1
    v_add_u32_sdwa v38, v58, v75 dst_sel:DWORD dst_unused:UNUSED_PAD src0_sel:DWORD src1_sel:WORD_0
    v_add_u32_sdwa v39, v58, v75 dst_sel:DWORD dst_unused:UNUSED_PAD src0_sel:DWORD src1_sel:WORD_1
    v_add_u32_sdwa v40, v58, v76 dst_sel:DWORD dst_unused:UNUSED_PAD src0_sel:DWORD src1_sel:WORD_0
    v_add_u32_sdwa v41, v58, v76 dst_sel:DWORD dst_unused:UNUSED_PAD src0_sel:DWORD src1_sel:WORD_1
    v_add_u32_sdwa v42, v58, v77 dst_sel:DWORD dst_unused:UNUSED_PAD src0_sel:DWORD src1_sel:WORD_0
    v_add_u32_sdwa v43, v58, v77 dst_sel:DWORD dst_unused:UNUSED_PAD src0_sel:DWORD src1_sel:WORD_1
    v_add_u32_sdwa v44, v58, v78 dst_sel:DWORD dst_unused:UNUSED_PAD src0_sel:DWORD src1_sel:WORD_0
    v_add_u32_sdwa v45, v58, v78 dst_sel:DWORD dst_unused:UNUSED_PAD src0_sel:DWORD src1_sel:WORD_1
    v_add_u32_sdwa v46, v58, v79 dst_sel:DWORD dst_unused:UNUSED_PAD src0_sel:DWORD src1_sel:WORD_0
    v_add_u32_sdwa v47, v58, v79 dst_sel:DWORD dst_unused:UNUSED_PAD src0_sel:DWORD src1_sel:WORD_1
    v_add_u32_sdwa v48, v58, v80 dst_sel:DWORD dst_unused:UNUSED_PAD src0_sel:DWORD src1_sel:WORD_0
    v_add_u32_sdwa v49, v58, v80 dst_sel:DWORD dst_unused:UNUSED_PAD src0_sel:DWORD src1_sel:WORD_1
    v_add_u32_sdwa v50, v58, v81 dst_sel:DWORD dst_unused:UNUSED_PAD src0_sel:DWORD src1_sel:WORD_0
    v_add_u32_sdwa v51, v58, v81 dst_sel:DWORD dst_unused:UNUSED_PAD src0_sel:DWORD src1_sel:WORD_1
    v_add_u32_sdwa v52, v58, v82 dst_sel:DWORD dst_unused:UNUSED_PAD src0_sel:DWORD src1_sel:WORD_0
    v_add_u32_sdwa v53, v58, v82 dst_sel:DWORD dst_unused:UNUSED_PAD src0_sel:DWORD src1_sel:WORD_1
    v_add_u32_sdwa v54, v58, v83 dst_sel:DWORD dst_unused:UNUSED_PAD src0_sel:DWORD src1_sel:WORD_0
    v_add_u32_sdwa v55, v58, v83 dst_sel:DWORD dst_unused:UNUSED_PAD src0_sel:DWORD src1_sel:WORD_1
    ds_read_u16 v32, v32 offset:14464
    ds_read_u16_d16_hi v33, v33 offset:14464
    ds_read_u16 v34, v34 offset:14464
    ds_read_u16_d16_hi v35, v35 offset:14464
    ds_read_u16 v36, v36 offset:14464
    ds_read_u16_d16_hi v37, v37 offset:14464
    ds_read_u16 v38, v38 offset:14464
    ds_read_u16_d16_hi v39, v39 offset:14464
    ds_read_u16 v40, v40 offset:14464
    ds_read_u16_d16_hi v41, v41 offset:14464
    ds_read_u16 v42, v42 offset:14464
    ds_read_u16_d16_hi v43, v43 offset:14464
    ds_read_u16 v44, v44 offset:14464
    ds_read_u16_d16_hi v45, v45 offset:14464
    s_waitcnt lgkmcnt(8)
    ds_read_u16 v46, v46 offset:14464
    ds_read_u16_d16_hi v47, v47 offset:14464
    s_waitcnt lgkmcnt(7)
    ds_read_u16 v48, v48 offset:14464
    ds_read_u16_d16_hi v49, v49 offset:14464
    ds_read_u16 v50, v50 offset:14464
    ds_read_u16_d16_hi v51, v51 offset:14464
    ds_read_u16 v52, v52 offset:14464
    ds_read_u16_d16_hi v53, v53 offset:14464
    ds_read_u16 v54, v54 offset:14464
    ds_read_u16_d16_hi v55, v55 offset:14464
    s_waitcnt lgkmcnt(0)
    v_and_b32 v33, 0xffff0000, v33
    v_or_b32 v84, v32, v33
    v_and_b32 v35, 0xffff0000, v35
    v_or_b32 v85, v34, v35
    v_and_b32 v37, 0xffff0000, v37
    v_or_b32 v86, v36, v37
    v_and_b32 v39, 0xffff0000, v39
    v_or_b32 v87, v38, v39
    v_and_b32 v41, 0xffff0000, v41
    v_or_b32 v88, v40, v41
    v_and_b32 v43, 0xffff0000, v43
    v_or_b32 v89, v42, v43
    v_and_b32 v45, 0xffff0000, v45
    v_or_b32 v90, v44, v45
    v_and_b32 v47, 0xffff0000, v47
    v_or_b32 v91, v46, v47
    v_and_b32 v49, 0xffff0000, v49
    v_or_b32 v92, v48, v49
    v_and_b32 v51, 0xffff0000, v51
    v_or_b32 v93, v50, v51
    v_and_b32 v53, 0xffff0000, v53
    v_or_b32 v94, v52, v53
    v_and_b32 v55, 0xffff0000, v55
    v_or_b32 v95, v54, v55
    buffer_store_dwordx4 v[84:87], v6, s[52:55], s56 offen offset:0 sc1
    buffer_store_dwordx4 v[88:91], v6, s[52:55], s56 offen offset:1024 sc1
    v_lshlrev_b32 v60, 4, v182
    v_cmp_gt_u32 vcc, 4, v182
    s_and_saveexec_b64 s[58:59], vcc
    s_add_u32 s56, s56, 4096
    buffer_store_dwordx4 v[92:95], v60, s[52:55], s56 offen sc1
    s_mov_b64 exec, s[58:59]
    s_barrier
    s_mov_b32 s33, s36
    v_lshlrev_b32 v11, 2, v182
    v_add_u32 v11, s34, v11
    v_and_b32 v13, 31, v182
    v_mul_u32_u24 v13, 272, v13
    v_lshrrev_b32 v14, 5, v182
    v_lshlrev_b32 v14, 4, v14
    v_add_u32 v13, v13, v14
    v_add_u32 v13, s34, v13
    v_lshlrev_b32 v154, 16, v154
    v_lshlrev_b32 v15, 16, v150
    v_mul_f32 v10, 0x3fb8aa3b, v154
    v_mul_f32 v15, 0x3fb8aa3b, v15
    v_exp_f32 v10, v10
    v_exp_f32 v15, v15
    v_lshlrev_b32 v16, 16, v151
    v_cvt_pk_bf16_f32 v10, v10, v15
    v_and_b32 v15, 0xffff0000, v10
    v_lshlrev_b32 v10, 16, v10
    v_mul_f32 v16, v16, v10
    v_mul_f32 v15, v15, v10
    v_mul_f32 v16, 0x3e22f983, v16
    v_mul_f32 v15, 0xbfb8aa3b, v15
    v_lshlrev_b32 v30, 16, v152
    v_lshlrev_b32 v31, 16, v153
    v_add_f32 v58, v10, v10
    v_mul_f32 v30, v30, v58
    v_mul_f32 v31, v31, v58
    v_mul_f32 v32, 1.0, v15
    v_mul_f32 v38, 0x41000000, v15
    v_mul_f32 v44, 0x43800000, v15
    v_mul_f32 v33, 1.0, v16
    v_mul_f32 v39, 0x41000000, v16
    v_mul_f32 v45, 0x43800000, v16
    v_exp_f32 v32, v32
    v_exp_f32 v38, v38
    v_exp_f32 v44, v44
    v_fract_f32 v33, v33
    v_fract_f32 v39, v39
    v_fract_f32 v45, v45
    v_cos_f32 v18, v33
    v_cos_f32 v24, v39
    v_cos_f32 v26, v45
    v_sin_f32 v19, v33
    v_sin_f32 v25, v39
    v_sin_f32 v27, v45
    v_mul_f32 v18, v18, v32
    v_mul_f32 v24, v24, v38
    v_mul_f32 v26, v26, v44
    v_mul_f32 v19, v19, v32
    v_mul_f32 v25, v25, v38
    v_mul_f32 v27, v27, v44
    v_mul_f32 v40, v18, v18
    v_mul_f32 v46, v24, v24
    v_mul_f32 v41, v18, v19
    v_mul_f32 v47, v24, v25
    v_fma_f32 v20, -v19, v19, v40
    v_fma_f32 v28, -v25, v25, v46
    v_fma_f32 v21, v19, v18, v41
    v_fma_f32 v29, v25, v24, v47
    v_mul_f32 v40, v20, v20
    v_mul_f32 v41, v20, v21
    v_fma_f32 v22, -v21, v21, v40
    v_fma_f32 v23, v21, v20, v41
    v_cvt_pk_bf16_f32 v36, v30, -v31
    v_mul_f32 v40, v30, v26
    v_mov_b32 v44, 1.0
    v_cvt_pk_bf16_f32 v54, v24, v25
    ds_write_b32 v11, v36 offset:0
    v_mul_f32 v41, v30, v27
    v_mov_b32 v45, 0
    ds_write_b32 v11, v54 offset:6032
    v_mul_f32 v34, v30, v18
    v_fma_f32 v56, -v31, v27, v40
    v_cvt_pk_bf16_f32 v48, v44, v45
    v_mul_f32 v52, v24, v28
    v_mul_f32 v35, v30, v19
    v_fma_f32 v57, v31, v26, v41
    ds_write_b32 v11, v48 offset:5760
    v_mul_f32 v53, v24, v29
    v_fma_f32 v32, -v31, v19, v34
    v_cvt_pk_bf16_f32 v42, v56, -v57
    v_cvt_pk_bf16_f32 v48, v28, v29
    v_fma_f32 v50, -v25, v29, v52
    v_fma_f32 v33, v31, v18, v35
    ds_write_b32 v11, v42 offset:2176
    ds_write_b32 v11, v48 offset:6304
    v_fma_f32 v51, v25, v28, v53
    v_cvt_pk_bf16_f32 v36, v32, -v33
    v_mul_f32 v40, v56, v20
    v_mul_f32 v46, v28, v28
    v_cvt_pk_bf16_f32 v54, v50, v51
    ds_write_b32 v11, v36 offset:272
    v_mul_f32 v41, v56, v21
    v_mul_f32 v47, v28, v29
    ds_write_b32 v11, v54 offset:6576
    v_mul_f32 v34, v32, v18
    v_fma_f32 v38, -v57, v21, v40
    v_fma_f32 v44, -v29, v29, v46
    v_mul_f32 v52, v50, v28
    v_mul_f32 v35, v32, v19
    v_fma_f32 v39, v57, v20, v41
    v_fma_f32 v45, v29, v28, v47
    v_mul_f32 v53, v50, v29
    v_fma_f32 v32, -v33, v19, v34
    v_cvt_pk_bf16_f32 v42, v38, -v39
    v_cvt_pk_bf16_f32 v48, v44, v45
    v_fma_f32 v50, -v51, v29, v52
    v_fma_f32 v33, v33, v18, v35
    ds_write_b32 v11, v42 offset:2448
    ds_write_b32 v11, v48 offset:6848
    v_fma_f32 v51, v51, v28, v53
    v_cvt_pk_bf16_f32 v36, v32, -v33
    v_mul_f32 v40, v38, v20
    v_mul_f32 v46, v44, v28
    v_cvt_pk_bf16_f32 v54, v50, v51
    ds_write_b32 v11, v36 offset:544
    v_mul_f32 v41, v38, v21
    v_mul_f32 v47, v44, v29
    ds_write_b32 v11, v54 offset:7120
    v_mul_f32 v34, v32, v18
    v_fma_f32 v38, -v39, v21, v40
    v_fma_f32 v44, -v45, v29, v46
    v_mul_f32 v52, v50, v28
    v_mul_f32 v35, v32, v19
    v_fma_f32 v39, v39, v20, v41
    v_fma_f32 v45, v45, v28, v47
    v_mul_f32 v53, v50, v29
    v_fma_f32 v32, -v33, v19, v34
    v_cvt_pk_bf16_f32 v42, v38, -v39
    v_cvt_pk_bf16_f32 v48, v44, v45
    v_fma_f32 v50, -v51, v29, v52
    v_fma_f32 v33, v33, v18, v35
    ds_write_b32 v11, v42 offset:2720
    ds_write_b32 v11, v48 offset:7392
    v_fma_f32 v51, v51, v28, v53
    v_cvt_pk_bf16_f32 v36, v32, -v33
    v_mul_f32 v40, v38, v20
    v_mul_f32 v46, v44, v28
    v_cvt_pk_bf16_f32 v54, v50, v51
    ds_write_b32 v11, v36 offset:816
    v_mul_f32 v41, v38, v21
    v_mul_f32 v47, v44, v29
    ds_write_b32 v11, v54 offset:7664
    v_mul_f32 v34, v32, v18
    v_fma_f32 v38, -v39, v21, v40
    v_fma_f32 v44, -v45, v29, v46
    v_mul_f32 v52, v50, v28
    v_mul_f32 v35, v32, v19
    v_fma_f32 v39, v39, v20, v41
    v_fma_f32 v45, v45, v28, v47
    v_mul_f32 v53, v50, v29
    v_fma_f32 v32, -v33, v19, v34
    v_cvt_pk_bf16_f32 v42, v38, -v39
    v_cvt_pk_bf16_f32 v48, v44, v45
    v_fma_f32 v50, -v51, v29, v52
    v_fma_f32 v33, v33, v18, v35
    ds_write_b32 v11, v42 offset:2992
    ds_write_b32 v11, v48 offset:7936
    v_fma_f32 v51, v51, v28, v53
    v_cvt_pk_bf16_f32 v36, v32, -v33
    v_mul_f32 v40, v56, v26
    v_mul_f32 v46, v44, v28
    v_cvt_pk_bf16_f32 v54, v50, v51
    ds_write_b32 v11, v36 offset:1088
    v_mul_f32 v41, v56, v27
    v_mul_f32 v47, v44, v29
    ds_write_b32 v11, v54 offset:8208
    v_mul_f32 v34, v32, v18
    v_fma_f32 v56, -v57, v27, v40
    v_fma_f32 v44, -v45, v29, v46
    v_mul_f32 v52, v50, v28
    v_mul_f32 v35, v32, v19
    v_fma_f32 v57, v57, v26, v41
    v_fma_f32 v45, v45, v28, v47
    v_mul_f32 v53, v50, v29
    v_fma_f32 v32, -v33, v19, v34
    v_cvt_pk_bf16_f32 v42, v56, -v57
    v_cvt_pk_bf16_f32 v48, v44, v45
    v_fma_f32 v50, -v51, v29, v52
    v_fma_f32 v33, v33, v18, v35
    ds_write_b32 v11, v42 offset:3264
    ds_write_b32 v11, v48 offset:8480
    v_fma_f32 v51, v51, v28, v53
    v_cvt_pk_bf16_f32 v36, v32, -v33
    v_mul_f32 v40, v56, v22
    v_mul_f32 v46, v44, v28
    v_cvt_pk_bf16_f32 v54, v50, v51
    ds_write_b32 v11, v36 offset:1360
    v_mul_f32 v41, v56, v23
    v_mul_f32 v47, v44, v29
    ds_write_b32 v11, v54 offset:8752
    v_mul_f32 v34, v32, v18
    v_fma_f32 v38, -v57, v23, v40
    v_fma_f32 v44, -v45, v29, v46
    v_mul_f32 v52, v50, v28
    v_mul_f32 v35, v32, v19
    v_fma_f32 v39, v57, v22, v41
    v_fma_f32 v45, v45, v28, v47
    v_mul_f32 v53, v50, v29
    v_fma_f32 v32, -v33, v19, v34
    v_cvt_pk_bf16_f32 v42, v38, -v39
    v_cvt_pk_bf16_f32 v48, v44, v45
    v_fma_f32 v50, -v51, v29, v52
    v_fma_f32 v33, v33, v18, v35
    ds_write_b32 v11, v42 offset:3536
    ds_write_b32 v11, v48 offset:9024
    v_fma_f32 v51, v51, v28, v53
    v_cvt_pk_bf16_f32 v36, v32, -v33
    v_mul_f32 v40, v56, v26
    v_mul_f32 v46, v44, v28
    v_cvt_pk_bf16_f32 v54, v50, v51
    ds_write_b32 v11, v36 offset:1632
    v_mul_f32 v41, v56, v27
    v_mul_f32 v47, v44, v29
    ds_write_b32 v11, v54 offset:9296
    v_mul_f32 v34, v32, v18
    v_fma_f32 v56, -v57, v27, v40
    v_fma_f32 v44, -v45, v29, v46
    v_mul_f32 v52, v50, v28
    v_mul_f32 v35, v32, v19
    v_fma_f32 v57, v57, v26, v41
    v_fma_f32 v45, v45, v28, v47
    v_mul_f32 v53, v50, v29
    v_fma_f32 v32, -v33, v19, v34
    v_cvt_pk_bf16_f32 v42, v56, -v57
    v_cvt_pk_bf16_f32 v48, v44, v45
    v_fma_f32 v50, -v51, v29, v52
    v_fma_f32 v33, v33, v18, v35
    ds_write_b32 v11, v42 offset:3808
    ds_write_b32 v11, v48 offset:9568
    v_fma_f32 v51, v51, v28, v53
    v_cvt_pk_bf16_f32 v36, v32, -v33
    v_mul_f32 v40, v56, v22
    v_mul_f32 v46, v44, v28
    v_cvt_pk_bf16_f32 v54, v50, v51
    ds_write_b32 v11, v36 offset:1904
    v_mul_f32 v41, v56, v23
    v_mul_f32 v47, v44, v29
    ds_write_b32 v11, v54 offset:9840
    v_fma_f32 v38, -v57, v23, v40
    v_fma_f32 v44, -v45, v29, v46
    v_mul_f32 v52, v50, v28
    v_fma_f32 v39, v57, v22, v41
    v_fma_f32 v45, v45, v28, v47
    v_mul_f32 v53, v50, v29
    v_cvt_pk_bf16_f32 v42, v38, -v39
    v_cvt_pk_bf16_f32 v48, v44, v45
    v_fma_f32 v50, -v51, v29, v52
    ds_write_b32 v11, v42 offset:4080
    ds_write_b32 v11, v48 offset:10112
    v_fma_f32 v51, v51, v28, v53
    v_mul_f32 v40, v56, v26
    v_mul_f32 v46, v44, v28
    v_cvt_pk_bf16_f32 v54, v50, v51
    v_mul_f32 v41, v56, v27
    v_mul_f32 v47, v44, v29
    ds_write_b32 v11, v54 offset:10384
    v_fma_f32 v56, -v57, v27, v40
    v_fma_f32 v44, -v45, v29, v46
    v_mul_f32 v52, v50, v28
    v_fma_f32 v57, v57, v26, v41
    v_fma_f32 v45, v45, v28, v47
    v_mul_f32 v53, v50, v29
    v_cvt_pk_bf16_f32 v42, v56, -v57
    v_cvt_pk_bf16_f32 v48, v44, v45
    v_fma_f32 v50, -v51, v29, v52
    ds_write_b32 v11, v42 offset:4352
    ds_write_b32 v11, v48 offset:10656
    v_fma_f32 v51, v51, v28, v53
    v_mul_f32 v40, v56, v26
    v_mul_f32 v46, v44, v28
    v_cvt_pk_bf16_f32 v54, v50, v51
    v_mul_f32 v41, v56, v27
    v_mul_f32 v47, v44, v29
    ds_write_b32 v11, v54 offset:10928
    v_fma_f32 v56, -v57, v27, v40
    v_fma_f32 v44, -v45, v29, v46
    v_mul_f32 v52, v50, v28
    v_fma_f32 v57, v57, v26, v41
    v_fma_f32 v45, v45, v28, v47
    v_mul_f32 v53, v50, v29
    v_cvt_pk_bf16_f32 v42, v56, -v57
    v_cvt_pk_bf16_f32 v48, v44, v45
    v_fma_f32 v50, -v51, v29, v52
    ds_write_b32 v11, v42 offset:4624
    ds_write_b32 v11, v48 offset:11200
    v_fma_f32 v51, v51, v28, v53
    v_mul_f32 v40, v56, v26
    v_mul_f32 v46, v44, v28
    v_cvt_pk_bf16_f32 v54, v50, v51
    v_mul_f32 v41, v56, v27
    v_mul_f32 v47, v44, v29
    ds_write_b32 v11, v54 offset:11472
    v_fma_f32 v56, -v57, v27, v40
    v_fma_f32 v44, -v45, v29, v46
    v_mul_f32 v52, v50, v28
    v_fma_f32 v57, v57, v26, v41
    v_fma_f32 v45, v45, v28, v47
    v_mul_f32 v53, v50, v29
    v_cvt_pk_bf16_f32 v42, v56, -v57
    v_cvt_pk_bf16_f32 v48, v44, v45
    v_fma_f32 v50, -v51, v29, v52
    ds_write_b32 v11, v42 offset:4896
    ds_write_b32 v11, v48 offset:11744
    v_fma_f32 v51, v51, v28, v53
    v_mul_f32 v40, v56, v26
    v_mul_f32 v46, v44, v28
    v_cvt_pk_bf16_f32 v54, v50, v51
    v_mul_f32 v41, v56, v27
    v_mul_f32 v47, v44, v29
    ds_write_b32 v11, v54 offset:12016
    v_fma_f32 v56, -v57, v27, v40
    v_fma_f32 v44, -v45, v29, v46
    v_mul_f32 v52, v50, v28
    v_fma_f32 v57, v57, v26, v41
    v_fma_f32 v45, v45, v28, v47
    v_mul_f32 v53, v50, v29
    v_cvt_pk_bf16_f32 v42, v56, -v57
    v_cvt_pk_bf16_f32 v48, v44, v45
    v_fma_f32 v50, -v51, v29, v52
    ds_write_b32 v11, v42 offset:5168
    ds_write_b32 v11, v48 offset:12288
    v_fma_f32 v51, v51, v28, v53
    v_mul_f32 v40, v56, v26
    v_mul_f32 v46, v44, v28
    v_cvt_pk_bf16_f32 v54, v50, v51
    v_mul_f32 v41, v56, v27
    v_mul_f32 v47, v44, v29
    ds_write_b32 v11, v54 offset:12560
    v_fma_f32 v56, -v57, v27, v40
    v_fma_f32 v44, -v45, v29, v46
    v_mul_f32 v52, v50, v28
    v_fma_f32 v57, v57, v26, v41
    v_fma_f32 v45, v45, v28, v47
    v_mul_f32 v53, v50, v29
    v_cvt_pk_bf16_f32 v42, v56, -v57
    v_cvt_pk_bf16_f32 v48, v44, v45
    v_fma_f32 v50, -v51, v29, v52
    ds_write_b32 v11, v42 offset:5440
    ds_write_b32 v11, v48 offset:12832
    v_fma_f32 v51, v51, v28, v53
    v_mul_f32 v46, v44, v28
    v_cvt_pk_bf16_f32 v54, v50, v51
    v_mul_f32 v47, v44, v29
    ds_write_b32 v11, v54 offset:13104
    v_fma_f32 v44, -v45, v29, v46
    v_mul_f32 v52, v50, v28
    v_fma_f32 v45, v45, v28, v47
    v_mul_f32 v53, v50, v29
    v_cvt_pk_bf16_f32 v48, v44, v45
    v_fma_f32 v50, -v51, v29, v52
    ds_write_b32 v11, v48 offset:13376
    v_fma_f32 v51, v51, v28, v53
    v_mul_f32 v46, v44, v28
    v_cvt_pk_bf16_f32 v54, v50, v51
    v_mul_f32 v47, v44, v29
    ds_write_b32 v11, v54 offset:13648
    v_fma_f32 v44, -v45, v29, v46
    v_mul_f32 v52, v50, v28
    v_fma_f32 v45, v45, v28, v47
    v_mul_f32 v53, v50, v29
    v_cvt_pk_bf16_f32 v48, v44, v45
    v_fma_f32 v50, -v51, v29, v52
    ds_write_b32 v11, v48 offset:13920
    v_fma_f32 v51, v51, v28, v53
    v_cvt_pk_bf16_f32 v54, v50, v51
    ds_write_b32 v11, v54 offset:14192
    s_waitcnt lgkmcnt(0)
    ds_read_b128 v[112:115], v13 offset:0
    ds_read_b128 v[116:119], v13 offset:5760
    ds_read_b128 v[120:123], v13 offset:32
    ds_read_b128 v[124:127], v13 offset:5792
    ds_read_b128 v[128:131], v13 offset:64
    ds_read_b128 v[132:135], v13 offset:5824
    ds_read_b128 v[136:139], v13 offset:96
    ds_read_b128 v[140:143], v13 offset:5856
    s_waitcnt lgkmcnt(6)
    v_mfma_f32_32x32x16_bf16 v[96:111], v[112:115], v[116:119], 0
    s_nop 3
    ds_read_b128 v[112:115], v13 offset:128
    ds_read_b128 v[116:119], v13 offset:5888
    s_waitcnt lgkmcnt(6)
    v_mfma_f32_32x32x16_bf16 v[96:111], v[120:123], v[124:127], v[96:111]
    s_nop 3
    ds_read_b128 v[120:123], v13 offset:160
    ds_read_b128 v[124:127], v13 offset:5920
    s_waitcnt lgkmcnt(6)
    v_mfma_f32_32x32x16_bf16 v[96:111], v[128:131], v[132:135], v[96:111]
    s_nop 3
    ds_read_b128 v[128:131], v13 offset:192
    ds_read_b128 v[132:135], v13 offset:5952
    s_waitcnt lgkmcnt(6)
    v_mfma_f32_32x32x16_bf16 v[96:111], v[136:139], v[140:143], v[96:111]
    s_nop 3
    ds_read_b128 v[136:139], v13 offset:224
    ds_read_b128 v[140:143], v13 offset:5984
    s_waitcnt lgkmcnt(6)
    v_mfma_f32_32x32x16_bf16 v[96:111], v[112:115], v[116:119], v[96:111]
    s_waitcnt lgkmcnt(4)
    v_mfma_f32_32x32x16_bf16 v[96:111], v[120:123], v[124:127], v[96:111]
    s_waitcnt lgkmcnt(2)
    v_mfma_f32_32x32x16_bf16 v[96:111], v[128:131], v[132:135], v[96:111]
    s_waitcnt lgkmcnt(0)
    v_mfma_f32_32x32x16_bf16 v[96:111], v[136:139], v[140:143], v[96:111]
    v_lshlrev_b32 v60, 4, v182
    v_add_u32 v61, s35, v60
    v_add_u32 v60, s34, v60
    s_nop 7
    s_nop 3
    ds_write_b128 v60, v[96:99] offset:0
    ds_write_b128 v60, v[100:103] offset:1024
    ds_write_b128 v60, v[104:107] offset:2048
    s_waitcnt lgkmcnt(0)
    s_barrier
    ds_read_b128 v[112:115], v61 offset:0
    ds_read_b128 v[116:119], v61 offset:1024
    ds_read_b128 v[120:123], v61 offset:2048
    v_and_b32 v60, 31, v182
    v_lshlrev_b32 v60, 1, v60
    v_lshrrev_b32 v61, 5, v182
    v_lshlrev_b32 v61, 8, v61
    v_add_u32 v60, v60, v61
    v_add_u32 v60, s34, v60
    v_mov_b32 v58, s34
    s_add_u32 s52, s4, 37748736
    s_addc_u32 s53, s5, 0
    s_mov_b32 s54, 2396160
    s_mov_b32 s55, 0x20000
    s_mul_i32 s56, s33, 4160
    s_waitcnt lgkmcnt(0)
    v_add_f32 v96, v96, v112
    v_add_f32 v97, v97, v113
    v_add_f32 v98, v98, v114
    v_add_f32 v99, v99, v115
    v_add_f32 v100, v100, v116
    v_add_f32 v101, v101, v117
    v_add_f32 v102, v102, v118
    v_add_f32 v103, v103, v119
    v_add_f32 v104, v104, v120
    v_add_f32 v105, v105, v121
    v_add_f32 v106, v106, v122
    v_add_f32 v107, v107, v123
    v_cvt_pk_bf16_f32 v32, v96, v97
    ds_write_b16 v60, v32 offset:14464
    ds_write_b16_d16_hi v60, v32 offset:14528
    v_cvt_pk_bf16_f32 v38, v98, v99
    ds_write_b16 v60, v38 offset:14592
    ds_write_b16_d16_hi v60, v38 offset:14656
    v_cvt_pk_bf16_f32 v44, v100, v101
    ds_write_b16 v60, v44 offset:14976
    ds_write_b16_d16_hi v60, v44 offset:15040
    v_cvt_pk_bf16_f32 v50, v102, v103
    ds_write_b16 v60, v50 offset:15104
    ds_write_b16_d16_hi v60, v50 offset:15168
    v_cvt_pk_bf16_f32 v32, v104, v105
    ds_write_b16 v60, v32 offset:15488
    ds_write_b16_d16_hi v60, v32 offset:15552
    v_cvt_pk_bf16_f32 v38, v106, v107
    ds_write_b16 v60, v38 offset:15616
    ds_write_b16_d16_hi v60, v38 offset:15680
    v_mov_b32 v59, 0
    ds_write_b16 v58, v59 offset:15808
    s_waitcnt vmcnt(63) lgkmcnt(0)
    v_add_u32_sdwa v32, v58, v72 dst_sel:DWORD dst_unused:UNUSED_PAD src0_sel:DWORD src1_sel:WORD_0
    v_add_u32_sdwa v33, v58, v72 dst_sel:DWORD dst_unused:UNUSED_PAD src0_sel:DWORD src1_sel:WORD_1
    v_add_u32_sdwa v34, v58, v73 dst_sel:DWORD dst_unused:UNUSED_PAD src0_sel:DWORD src1_sel:WORD_0
    v_add_u32_sdwa v35, v58, v73 dst_sel:DWORD dst_unused:UNUSED_PAD src0_sel:DWORD src1_sel:WORD_1
    v_add_u32_sdwa v36, v58, v74 dst_sel:DWORD dst_unused:UNUSED_PAD src0_sel:DWORD src1_sel:WORD_0
    v_add_u32_sdwa v37, v58, v74 dst_sel:DWORD dst_unused:UNUSED_PAD src0_sel:DWORD src1_sel:WORD_1
    v_add_u32_sdwa v38, v58, v75 dst_sel:DWORD dst_unused:UNUSED_PAD src0_sel:DWORD src1_sel:WORD_0
    v_add_u32_sdwa v39, v58, v75 dst_sel:DWORD dst_unused:UNUSED_PAD src0_sel:DWORD src1_sel:WORD_1
    v_add_u32_sdwa v40, v58, v76 dst_sel:DWORD dst_unused:UNUSED_PAD src0_sel:DWORD src1_sel:WORD_0
    v_add_u32_sdwa v41, v58, v76 dst_sel:DWORD dst_unused:UNUSED_PAD src0_sel:DWORD src1_sel:WORD_1
    v_add_u32_sdwa v42, v58, v77 dst_sel:DWORD dst_unused:UNUSED_PAD src0_sel:DWORD src1_sel:WORD_0
    v_add_u32_sdwa v43, v58, v77 dst_sel:DWORD dst_unused:UNUSED_PAD src0_sel:DWORD src1_sel:WORD_1
    v_add_u32_sdwa v44, v58, v78 dst_sel:DWORD dst_unused:UNUSED_PAD src0_sel:DWORD src1_sel:WORD_0
    v_add_u32_sdwa v45, v58, v78 dst_sel:DWORD dst_unused:UNUSED_PAD src0_sel:DWORD src1_sel:WORD_1
    v_add_u32_sdwa v46, v58, v79 dst_sel:DWORD dst_unused:UNUSED_PAD src0_sel:DWORD src1_sel:WORD_0
    v_add_u32_sdwa v47, v58, v79 dst_sel:DWORD dst_unused:UNUSED_PAD src0_sel:DWORD src1_sel:WORD_1
    v_add_u32_sdwa v48, v58, v80 dst_sel:DWORD dst_unused:UNUSED_PAD src0_sel:DWORD src1_sel:WORD_0
    v_add_u32_sdwa v49, v58, v80 dst_sel:DWORD dst_unused:UNUSED_PAD src0_sel:DWORD src1_sel:WORD_1
    v_add_u32_sdwa v50, v58, v81 dst_sel:DWORD dst_unused:UNUSED_PAD src0_sel:DWORD src1_sel:WORD_0
    v_add_u32_sdwa v51, v58, v81 dst_sel:DWORD dst_unused:UNUSED_PAD src0_sel:DWORD src1_sel:WORD_1
    v_add_u32_sdwa v52, v58, v82 dst_sel:DWORD dst_unused:UNUSED_PAD src0_sel:DWORD src1_sel:WORD_0
    v_add_u32_sdwa v53, v58, v82 dst_sel:DWORD dst_unused:UNUSED_PAD src0_sel:DWORD src1_sel:WORD_1
    v_add_u32_sdwa v54, v58, v83 dst_sel:DWORD dst_unused:UNUSED_PAD src0_sel:DWORD src1_sel:WORD_0
    v_add_u32_sdwa v55, v58, v83 dst_sel:DWORD dst_unused:UNUSED_PAD src0_sel:DWORD src1_sel:WORD_1
    ds_read_u16 v32, v32 offset:14464
    ds_read_u16_d16_hi v33, v33 offset:14464
    ds_read_u16 v34, v34 offset:14464
    ds_read_u16_d16_hi v35, v35 offset:14464
    ds_read_u16 v36, v36 offset:14464
    ds_read_u16_d16_hi v37, v37 offset:14464
    ds_read_u16 v38, v38 offset:14464
    ds_read_u16_d16_hi v39, v39 offset:14464
    ds_read_u16 v40, v40 offset:14464
    ds_read_u16_d16_hi v41, v41 offset:14464
    ds_read_u16 v42, v42 offset:14464
    ds_read_u16_d16_hi v43, v43 offset:14464
    ds_read_u16 v44, v44 offset:14464
    ds_read_u16_d16_hi v45, v45 offset:14464
    s_waitcnt lgkmcnt(8)
    ds_read_u16 v46, v46 offset:14464
    ds_read_u16_d16_hi v47, v47 offset:14464
    s_waitcnt lgkmcnt(7)
    ds_read_u16 v48, v48 offset:14464
    ds_read_u16_d16_hi v49, v49 offset:14464
    ds_read_u16 v50, v50 offset:14464
    ds_read_u16_d16_hi v51, v51 offset:14464
    ds_read_u16 v52, v52 offset:14464
    ds_read_u16_d16_hi v53, v53 offset:14464
    ds_read_u16 v54, v54 offset:14464
    ds_read_u16_d16_hi v55, v55 offset:14464
    s_waitcnt lgkmcnt(0)
    v_and_b32 v33, 0xffff0000, v33
    v_or_b32 v84, v32, v33
    v_and_b32 v35, 0xffff0000, v35
    v_or_b32 v85, v34, v35
    v_and_b32 v37, 0xffff0000, v37
    v_or_b32 v86, v36, v37
    v_and_b32 v39, 0xffff0000, v39
    v_or_b32 v87, v38, v39
    v_and_b32 v41, 0xffff0000, v41
    v_or_b32 v88, v40, v41
    v_and_b32 v43, 0xffff0000, v43
    v_or_b32 v89, v42, v43
    v_and_b32 v45, 0xffff0000, v45
    v_or_b32 v90, v44, v45
    v_and_b32 v47, 0xffff0000, v47
    v_or_b32 v91, v46, v47
    v_and_b32 v49, 0xffff0000, v49
    v_or_b32 v92, v48, v49
    v_and_b32 v51, 0xffff0000, v51
    v_or_b32 v93, v50, v51
    v_and_b32 v53, 0xffff0000, v53
    v_or_b32 v94, v52, v53
    v_and_b32 v55, 0xffff0000, v55
    v_or_b32 v95, v54, v55
    buffer_store_dwordx4 v[84:87], v6, s[52:55], s56 offen offset:0 sc1
    buffer_store_dwordx4 v[88:91], v6, s[52:55], s56 offen offset:1024 sc1
    v_lshlrev_b32 v60, 4, v182
    v_cmp_gt_u32 vcc, 4, v182
    s_and_saveexec_b64 s[58:59], vcc
    s_add_u32 s56, s56, 4096
    buffer_store_dwordx4 v[92:95], v60, s[52:55], s56 offen sc1
    s_mov_b64 exec, s[58:59]
    s_waitcnt vmcnt(0) lgkmcnt(0)
    s_lshl_b32 s21, s60, 2
    s_add_u32 s21, s21, s20
    s_add_u32 s61, s21, 192
    s_add_u32 s21, s21, 512
    s_mov_b32 s28, 0
    s_mov_b32 s29, 1
    s_mov_b32 s26, 1
    s_barrier
    s_load_dwordx2 s[44:45], s[0:1], 0
    s_load_dwordx2 s[40:41], s[0:1], 88
    s_mov_b32 s31, s21
    s_mul_i32 s22, s20, 40960
    s_add_u32 s8, s4, 37748720
    s_addc_u32 s9, s5, 0
    s_mov_b32 s10, 2396176
    s_mov_b32 s11, 0x20000
    s_add_u32 s12, s4, 40894464
    s_addc_u32 s13, s5, 0
    s_mov_b32 s14, 2359296
    s_mov_b32 s15, 0x20000
    v_lshlrev_b32 v168, 4, v182
    v_xor_b32 v196, s65, v196
    v_xor_b32 v197, s65, v197
    v_xor_b32 v198, s65, v198
    v_xor_b32 v199, s65, v199
    v_or3_b32 v196, v196, v197, v198
    v_or_b32 v196, v196, v199
    v_cmp_ne_u32 vcc, 0, v196
    s_cbranch_vccz gated_mix__ssm_conv_s4d__geglu_ffn__prompt_kernel_sfok_44
    s_add_u32 s52, s4, 48234496
    s_addc_u32 s53, s5, 0
    s_mov_b32 s54, 16384
    s_mov_b32 s55, 0x20000
    s_movk_i32 s56, 5120
    s_mov_b32 s63, 0x40000
gated_mix__ssm_conv_s4d__geglu_ffn__prompt_kernel_poll_45:
    buffer_load_dwordx4 v[228:231], v168, s[52:55], s56 offen sc0 sc1
    s_waitcnt vmcnt(0)
    v_xor_b32 v228, s65, v228
    v_xor_b32 v229, s65, v229
    v_xor_b32 v230, s65, v230
    v_xor_b32 v231, s65, v231
    v_or3_b32 v228, v228, v229, v230
    v_or_b32 v228, v228, v231
    v_cmp_ne_u32 vcc, 0, v228
    s_cbranch_vccz gated_mix__ssm_conv_s4d__geglu_ffn__prompt_kernel_pd_46
    s_sleep 10
    s_sub_u32 s63, s63, 1
    s_cmp_lg_u32 s63, 0
    s_cbranch_scc1 gated_mix__ssm_conv_s4d__geglu_ffn__prompt_kernel_poll_45
gated_mix__ssm_conv_s4d__geglu_ffn__prompt_kernel_pd_46:
gated_mix__ssm_conv_s4d__geglu_ffn__prompt_kernel_sfok_44:
    s_mul_i32 s27, s21, 4160
    s_add_u32 s27, s27, 8
    s_lshl_b32 s30, s21, 12
    buffer_load_dwordx4 v[208:211], v168, s[12:15], s30 offen offset:0 sc1
    buffer_load_dwordx4 v[212:215], v168, s[12:15], s30 offen offset:1024 sc1
    buffer_load_dwordx4 v[216:219], v168, s[12:15], s30 offen offset:2048 sc1
    buffer_load_dwordx4 v[220:223], v168, s[12:15], s30 offen offset:3072 sc1
    buffer_load_dwordx4 v[226:229], v168, s[8:11], s27 offen offset:8 sc1
    buffer_load_dwordx2 v[224:225], v168, s[8:11], s27 offen offset:0 sc1
    buffer_load_dwordx4 v[232:235], v168, s[8:11], s27 offen offset:1032 sc1
    buffer_load_dwordx2 v[230:231], v168, s[8:11], s27 offen offset:1024 sc1
    buffer_load_dwordx4 v[238:241], v168, s[8:11], s27 offen offset:2056 sc1
    buffer_load_dwordx2 v[236:237], v168, s[8:11], s27 offen offset:2048 sc1
    buffer_load_dwordx4 v[244:247], v168, s[8:11], s27 offen offset:3080 sc1
    buffer_load_dwordx2 v[242:243], v168, s[8:11], s27 offen offset:3072 sc1
    s_add_u32 s24, s27, 4096
    buffer_load_dwordx4 v[250:253], v168, s[8:11], s24 offen offset:8 sc1
    buffer_load_dwordx2 v[248:249], v168, s[8:11], s24 offen offset:0 sc1
    s_add_u32 s36, s21, s28
    s_mul_i32 s27, s36, 4160
    s_add_u32 s27, s27, 8
    s_cmp_gt_u32 s26, 1
    s_cselect_b32 s10, s10, 0
    buffer_load_dwordx4 a[2:5], v168, s[8:11], s27 offen offset:8 sc1
    buffer_load_dwordx2 a[0:1], v168, s[8:11], s27 offen offset:0 sc1
    buffer_load_dwordx4 a[8:11], v168, s[8:11], s27 offen offset:1032 sc1
    buffer_load_dwordx2 a[6:7], v168, s[8:11], s27 offen offset:1024 sc1
    buffer_load_dwordx4 a[14:17], v168, s[8:11], s27 offen offset:2056 sc1
    buffer_load_dwordx2 a[12:13], v168, s[8:11], s27 offen offset:2048 sc1
    buffer_load_dwordx4 a[20:23], v168, s[8:11], s27 offen offset:3080 sc1
    buffer_load_dwordx2 a[18:19], v168, s[8:11], s27 offen offset:3072 sc1
    s_add_u32 s24, s27, 4096
    buffer_load_dwordx4 a[26:29], v168, s[8:11], s24 offen offset:8 sc1
    buffer_load_dwordx2 a[24:25], v168, s[8:11], s24 offen offset:0 sc1
    s_waitcnt vmcnt(0)
gated_mix__ssm_conv_s4d__geglu_ffn__prompt_kernel_conv:
    s_add_u32 s16, s4, 44040192
    s_addc_u32 s17, s5, 0
    s_mov_b32 s18, 2359296
    s_mov_b32 s19, 0x20000
    v_and_b32 v190, 3, v182
    v_mul_u32_u24 v160, 4160, v190
    v_lshrrev_b32 v190, 5, v182
    v_lshlrev_b32 v190, 5, v190
    v_sub_u32 v160, v160, v190
    v_bfe_u32 v191, v182, 4, 1
    v_lshlrev_b32 v191, 4, v191
    v_add_u32 v160, v160, v191
    v_and_b32 v192, 12, v182
    v_lshlrev_b32 v192, 1, v192
    v_sub_u32 v160, v160, v192
    v_add_u32 v160, 512, v160
    v_add_u32 v160, s22, v160
    v_and_b32 v192, 15, v182
    v_lshlrev_b32 v161, 5, v192
    v_sub_u32 v161, v161, v190
    v_add_u32 v161, v161, v191
    v_add_u32 v161, 33792, v161
    v_add_u32 v161, s22, v161
    v_add_u32 v162, 33792, v168
    v_add_u32 v162, s22, v162
    v_subrev_u32 v165, 512, v162
    v_mov_b32 v200, 0
    v_mov_b32 v201, 0
    v_mov_b32 v202, 0
    v_mov_b32 v203, 0
    s_mov_b32 exec_hi, 0
    ds_write_b128 v165, v[200:203]
    s_mov_b64 exec, -1
    v_lshlrev_b32 v163, 5, v192
    v_bfe_u32 v193, v182, 4, 1
    v_lshlrev_b32 v193, 9, v193
    v_add_u32 v163, v163, v193
    v_lshrrev_b32 v193, 5, v182
    v_lshlrev_b32 v193, 4, v193
    v_add_u32 v163, v163, v193
    s_mov_b32 s33, 0
    s_mov_b32 s34, 0
    v_add_u32 v169, s22, v168
    s_waitcnt vmcnt(10)
    ds_write_b128 v169, v[226:229] offset:0
    v_alignbit_b32 v170, v225, v224, 16
    v_alignbit_b32 v171, v226, v225, 16
    v_alignbit_b32 v172, v227, v226, 16
    v_alignbit_b32 v173, v228, v227, 16
    ds_write_b128 v169, v[170:173] offset:12480
    v_mov_b32 v174, v171
    v_mov_b32 v175, v172
    v_mov_b32 v176, v173
    v_alignbit_b32 v177, v229, v228, 16
    ds_write_b128 v169, v[174:177] offset:4160
    v_mov_b32 v178, v225
    v_mov_b32 v179, v226
    v_mov_b32 v180, v227
    v_mov_b32 v181, v228
    ds_write_b128 v169, v[178:181] offset:8320
    ds_write_b128 v169, v[232:235] offset:1024
    v_alignbit_b32 v170, v231, v230, 16
    v_alignbit_b32 v171, v232, v231, 16
    v_alignbit_b32 v172, v233, v232, 16
    v_alignbit_b32 v173, v234, v233, 16
    ds_write_b128 v169, v[170:173] offset:13504
    v_mov_b32 v174, v171
    v_mov_b32 v175, v172
    v_mov_b32 v176, v173
    v_alignbit_b32 v177, v235, v234, 16
    ds_write_b128 v169, v[174:177] offset:5184
    v_mov_b32 v178, v231
    v_mov_b32 v179, v232
    v_mov_b32 v180, v233
    v_mov_b32 v181, v234
    ds_write_b128 v169, v[178:181] offset:9344
    ds_write_b128 v169, v[238:241] offset:2048
    v_alignbit_b32 v170, v237, v236, 16
    v_alignbit_b32 v171, v238, v237, 16
    v_alignbit_b32 v172, v239, v238, 16
    v_alignbit_b32 v173, v240, v239, 16
    ds_write_b128 v169, v[170:173] offset:14528
    v_mov_b32 v174, v171
    v_mov_b32 v175, v172
    v_mov_b32 v176, v173
    v_alignbit_b32 v177, v241, v240, 16
    ds_write_b128 v169, v[174:177] offset:6208
    v_mov_b32 v178, v237
    v_mov_b32 v179, v238
    v_mov_b32 v180, v239
    v_mov_b32 v181, v240
    ds_write_b128 v169, v[178:181] offset:10368
    s_waitcnt lgkmcnt(4)
    ds_write_b128 v169, v[244:247] offset:3072
    v_alignbit_b32 v170, v243, v242, 16
    v_alignbit_b32 v171, v244, v243, 16
    v_alignbit_b32 v172, v245, v244, 16
    v_alignbit_b32 v173, v246, v245, 16
    ds_write_b128 v169, v[170:173] offset:15552
    v_mov_b32 v174, v171
    v_mov_b32 v175, v172
    v_mov_b32 v176, v173
    v_alignbit_b32 v177, v247, v246, 16
    ds_write_b128 v169, v[174:177] offset:7232
    v_mov_b32 v178, v243
    v_mov_b32 v179, v244
    v_mov_b32 v180, v245
    v_mov_b32 v181, v246
    ds_write_b128 v169, v[178:181] offset:11392
    s_mov_b64 exec, 15
    ds_write_b128 v169, v[250:253] offset:4096
    s_mov_b64 exec, -1
    v_alignbit_b32 v170, v249, v248, 16
    v_alignbit_b32 v171, v250, v249, 16
    v_alignbit_b32 v172, v251, v250, 16
    v_alignbit_b32 v173, v252, v251, 16
    s_mov_b64 exec, 15
    ds_write_b128 v169, v[170:173] offset:16576
    s_mov_b64 exec, -1
    v_mov_b32 v174, v171
    v_mov_b32 v175, v172
    v_mov_b32 v176, v173
    v_alignbit_b32 v177, v253, v252, 16
    s_mov_b64 exec, 15
    ds_write_b128 v169, v[174:177] offset:8256
    s_mov_b64 exec, -1
    v_mov_b32 v178, v249
    v_mov_b32 v179, v250
    v_mov_b32 v180, v251
    v_mov_b32 v181, v252
    s_mov_b64 exec, 15
    ds_write_b128 v169, v[178:181] offset:12416
    s_mov_b64 exec, -1
    s_waitcnt lgkmcnt(0)
    v_and_b32 v192, 7, v182
    v_lshlrev_b32 v192, 4, v192
    v_lshrrev_b32 v193, 3, v182
    v_mul_u32_u24 v194, 1152, v193
    v_add_u32 v194, v194, v192
    s_mul_i32 s48, s61, 9216
    s_waitcnt lgkmcnt(0)
    s_mov_b32 s46, 2359296
    s_mov_b32 s47, 0x20000
    s_mov_b32 s42, 1152
    s_mov_b32 s43, 0x20000
    s_branch gated_mix__ssm_conv_s4d__geglu_ffn__prompt_kernel_chentry
    .p2align 5
gated_mix__ssm_conv_s4d__geglu_ffn__prompt_kernel_chloop:
    s_waitcnt vmcnt(14)
gated_mix__ssm_conv_s4d__geglu_ffn__prompt_kernel_chentry:
    ds_write_b128 v162, v[208:211] offset:0
    ds_write_b128 v162, v[212:215] offset:1024
    ds_write_b128 v162, v[216:219] offset:2048
    ds_write_b128 v162, v[220:223] offset:3072
    s_lshl_b32 s25, s21, 12
    s_add_u32 s36, s21, s28
    s_lshl_b32 s30, s36, 12
    s_add_u32 s36, s33, 1
    s_cmp_gt_u32 s29, s36
    s_cselect_b32 s14, s14, 0
    v_add_u32 v190, s34, v160
    v_mov_b32 v191, v161
    s_sub_u32 s34, 16640, s34
    s_add_u32 s36, s22, s34
    v_add_u32 v169, s36, v168
    v_mov_b32 v0, 0
    v_mov_b32 v1, 0
    v_mov_b32 v2, 0
    v_mov_b32 v3, 0
    v_mov_b32 v4, 0
    v_mov_b32 v5, 0
    v_mov_b32 v6, 0
    v_mov_b32 v7, 0
    v_mov_b32 v8, 0
    v_mov_b32 v9, 0
    v_mov_b32 v10, 0
    v_mov_b32 v11, 0
    v_mov_b32 v12, 0
    v_mov_b32 v13, 0
    v_mov_b32 v14, 0
    v_mov_b32 v15, 0
    v_mov_b32 v16, 0
    v_mov_b32 v17, 0
    v_mov_b32 v18, 0
    v_mov_b32 v19, 0
    v_mov_b32 v20, 0
    v_mov_b32 v21, 0
    v_mov_b32 v22, 0
    v_mov_b32 v23, 0
    v_mov_b32 v24, 0
    v_mov_b32 v25, 0
    v_mov_b32 v26, 0
    v_mov_b32 v27, 0
    v_mov_b32 v28, 0
    v_mov_b32 v29, 0
    v_mov_b32 v30, 0
    v_mov_b32 v31, 0
    s_waitcnt lgkmcnt(0)
    ds_read_b64 v[32:33], v190 offset:3584
    ds_read_b64 v[34:35], v190 offset:3592
    ds_read_b128 v[96:99], v191 offset:0
    ds_read_b64 v[36:37], v190 offset:3072
    ds_read_b64 v[38:39], v190 offset:3080
    ds_read_b128 v[100:103], v191 offset:512
    ds_read_b64 v[40:41], v190 offset:2560
    ds_read_b64 v[42:43], v190 offset:2568
    ds_read_b128 v[104:107], v191 offset:1024
    ds_read_b64 v[44:45], v190 offset:2048
    ds_read_b64 v[46:47], v190 offset:2056
    ds_read_b128 v[108:111], v191 offset:1536
    s_waitcnt lgkmcnt(9)
    v_mfma_f32_16x16x32_bf16 v[0:3], v[32:35], v[96:99], v[0:3]
    ds_read_b64 v[48:49], v190 offset:1536
    s_waitcnt lgkmcnt(7)
    v_mfma_f32_16x16x32_bf16 v[4:7], v[32:35], v[100:103], v[4:7]
    ds_read_b64 v[50:51], v190 offset:1544
    v_mfma_f32_16x16x32_bf16 v[4:7], v[36:39], v[96:99], v[4:7]
    ds_read_b128 v[112:115], v191 offset:2048
    v_mfma_f32_16x16x32_bf16 v[8:11], v[36:39], v[100:103], v[8:11]
    ds_read_b64 v[52:53], v190 offset:1024
    s_waitcnt lgkmcnt(7)
    v_mfma_f32_16x16x32_bf16 v[8:11], v[32:35], v[104:107], v[8:11]
    ds_read_b64 v[54:55], v190 offset:1032
    v_mfma_f32_16x16x32_bf16 v[8:11], v[40:43], v[96:99], v[8:11]
    ds_read_b128 v[116:119], v191 offset:2560
    v_mfma_f32_16x16x32_bf16 v[12:15], v[36:39], v[104:107], v[12:15]
    ds_read_b64 v[56:57], v190 offset:512
    v_mfma_f32_16x16x32_bf16 v[12:15], v[40:43], v[100:103], v[12:15]
    ds_read_b64 v[58:59], v190 offset:520
    v_mfma_f32_16x16x32_bf16 v[16:19], v[40:43], v[104:107], v[16:19]
    buffer_load_dwordx4 v[208:211], v168, s[12:15], s30 offen offset:0 sc1
    ds_read_b128 v[120:123], v191 offset:3072
    s_waitcnt lgkmcnt(9)
    v_mfma_f32_16x16x32_bf16 v[12:15], v[32:35], v[108:111], v[12:15]
    ds_read_b64 v[60:61], v190 offset:0
    v_mfma_f32_16x16x32_bf16 v[12:15], v[44:47], v[96:99], v[12:15]
    ds_read_b64 v[62:63], v190 offset:8
    v_mfma_f32_16x16x32_bf16 v[16:19], v[36:39], v[108:111], v[16:19]
    ds_read_b128 v[124:127], v191 offset:3584
    v_mfma_f32_16x16x32_bf16 v[16:19], v[44:47], v[100:103], v[16:19]
    v_subrev_u32 v190, 64, v190
    v_subrev_u32 v191, 64, v191
    v_mfma_f32_16x16x32_bf16 v[20:23], v[40:43], v[108:111], v[20:23]
    ds_read_b64 v[64:65], v190 offset:3584
    v_mfma_f32_16x16x32_bf16 v[20:23], v[44:47], v[104:107], v[20:23]
    ds_read_b64 v[66:67], v190 offset:3592
    v_mfma_f32_16x16x32_bf16 v[24:27], v[44:47], v[108:111], v[24:27]
    ds_read_b128 v[128:131], v191 offset:0
    s_waitcnt lgkmcnt(12)
    v_mfma_f32_16x16x32_bf16 v[16:19], v[32:35], v[112:115], v[16:19]
    buffer_load_dwordx4 v[212:215], v168, s[12:15], s30 offen offset:1024 sc1
    ds_read_b64 v[68:69], v190 offset:3072
    v_mfma_f32_16x16x32_bf16 v[16:19], v[48:51], v[96:99], v[16:19]
    ds_read_b64 v[70:71], v190 offset:3080
    v_mfma_f32_16x16x32_bf16 v[20:23], v[36:39], v[112:115], v[20:23]
    ds_read_b128 v[132:135], v191 offset:512
    v_mfma_f32_16x16x32_bf16 v[20:23], v[48:51], v[100:103], v[20:23]
    v_mfma_f32_16x16x32_bf16 v[24:27], v[40:43], v[112:115], v[24:27]
    v_mfma_f32_16x16x32_bf16 v[24:27], v[48:51], v[104:107], v[24:27]
    v_mfma_f32_16x16x32_bf16 v[28:31], v[44:47], v[112:115], v[28:31]
    v_mfma_f32_16x16x32_bf16 v[28:31], v[48:51], v[108:111], v[28:31]
    s_waitcnt lgkmcnt(12)
    v_mfma_f32_16x16x32_bf16 v[20:23], v[32:35], v[116:119], v[20:23]
    buffer_load_dwordx4 v[216:219], v168, s[12:15], s30 offen offset:2048 sc1
    ds_read_b64 v[72:73], v190 offset:2560
    v_mfma_f32_16x16x32_bf16 v[20:23], v[52:55], v[96:99], v[20:23]
    ds_read_b64 v[74:75], v190 offset:2568
    v_mfma_f32_16x16x32_bf16 v[24:27], v[36:39], v[116:119], v[24:27]
    ds_read_b128 v[136:139], v191 offset:1024
    v_mfma_f32_16x16x32_bf16 v[24:27], v[52:55], v[100:103], v[24:27]
    v_mfma_f32_16x16x32_bf16 v[28:31], v[40:43], v[116:119], v[28:31]
    v_mfma_f32_16x16x32_bf16 v[28:31], v[52:55], v[104:107], v[28:31]
    s_waitcnt lgkmcnt(12)
    v_mfma_f32_16x16x32_bf16 v[24:27], v[32:35], v[120:123], v[24:27]
    ds_read_b64 v[76:77], v190 offset:2048
    v_mfma_f32_16x16x32_bf16 v[24:27], v[56:59], v[96:99], v[24:27]
    ds_read_b64 v[78:79], v190 offset:2056
    v_mfma_f32_16x16x32_bf16 v[28:31], v[36:39], v[120:123], v[28:31]
    buffer_load_dwordx4 v[220:223], v168, s[12:15], s30 offen offset:3072 sc1
    ds_read_b128 v[140:143], v191 offset:1536
    v_mfma_f32_16x16x32_bf16 v[28:31], v[56:59], v[100:103], v[28:31]
    s_waitcnt lgkmcnt(12)
    v_mfma_f32_16x16x32_bf16 v[28:31], v[32:35], v[124:127], v[28:31]
    v_mfma_f32_16x16x32_bf16 v[28:31], v[60:63], v[96:99], v[28:31]
    s_cmp_eq_u32 s33, 0
    s_cbranch_scc0 gated_mix__ssm_conv_s4d__geglu_ffn__prompt_kernel_f0_47
    s_waitcnt vmcnt(4)
gated_mix__ssm_conv_s4d__geglu_ffn__prompt_kernel_f0_47:
    s_waitcnt vmcnt(8)
    v_accvgpr_read_b32 v224, a0
    v_accvgpr_read_b32 v225, a1
    v_accvgpr_read_b32 v226, a2
    v_accvgpr_read_b32 v227, a3
    v_accvgpr_read_b32 v228, a4
    v_accvgpr_read_b32 v229, a5
    v_accvgpr_read_b32 v230, a6
    v_accvgpr_read_b32 v231, a7
    v_accvgpr_read_b32 v232, a8
    v_accvgpr_read_b32 v233, a9
    v_accvgpr_read_b32 v234, a10
    v_accvgpr_read_b32 v235, a11
    v_accvgpr_read_b32 v236, a12
    v_accvgpr_read_b32 v237, a13
    v_accvgpr_read_b32 v238, a14
    v_accvgpr_read_b32 v239, a15
    v_accvgpr_read_b32 v240, a16
    v_accvgpr_read_b32 v241, a17
    v_accvgpr_read_b32 v242, a18
    v_accvgpr_read_b32 v243, a19
    v_accvgpr_read_b32 v244, a20
    v_accvgpr_read_b32 v245, a21
    v_accvgpr_read_b32 v246, a22
    v_accvgpr_read_b32 v247, a23
    v_accvgpr_read_b32 v248, a24
    v_accvgpr_read_b32 v249, a25
    v_accvgpr_read_b32 v250, a26
    v_accvgpr_read_b32 v251, a27
    v_accvgpr_read_b32 v252, a28
    v_accvgpr_read_b32 v253, a29
    s_mul_i32 s36, s28, 2
    s_add_u32 s36, s36, s21
    s_mul_i32 s27, s36, 4160
    s_add_u32 s27, s27, 8
    s_add_u32 s36, s33, 2
    s_cmp_gt_u32 s29, s36
    s_cselect_b32 s10, s10, 0
    s_cmp_eq_u32 s33, 0
    s_cbranch_scc0 gated_mix__ssm_conv_s4d__geglu_ffn__prompt_kernel_ngl_48
    buffer_load_dwordx4 a[32:35], v194, s[44:47], s48 offen offset:0
    buffer_load_dwordx4 a[68:71], v192, s[40:43], 0 offen offset:0
    buffer_load_dwordx4 a[36:39], v194, s[44:47], s48 offen offset:128
    buffer_load_dwordx4 a[72:75], v192, s[40:43], 0 offen offset:128
    buffer_load_dwordx4 a[40:43], v194, s[44:47], s48 offen offset:256
    buffer_load_dwordx4 a[76:79], v192, s[40:43], 0 offen offset:256
    buffer_load_dwordx4 a[44:47], v194, s[44:47], s48 offen offset:384
    buffer_load_dwordx4 a[80:83], v192, s[40:43], 0 offen offset:384
    buffer_load_dwordx4 a[48:51], v194, s[44:47], s48 offen offset:512
    buffer_load_dwordx4 a[84:87], v192, s[40:43], 0 offen offset:512
    buffer_load_dwordx4 a[52:55], v194, s[44:47], s48 offen offset:640
    buffer_load_dwordx4 a[88:91], v192, s[40:43], 0 offen offset:640
    buffer_load_dwordx4 a[56:59], v194, s[44:47], s48 offen offset:768
    buffer_load_dwordx4 a[92:95], v192, s[40:43], 0 offen offset:768
    buffer_load_dwordx4 a[60:63], v194, s[44:47], s48 offen offset:896
    buffer_load_dwordx4 a[96:99], v192, s[40:43], 0 offen offset:896
    buffer_load_dwordx4 a[64:67], v194, s[44:47], s48 offen offset:1024
    buffer_load_dwordx4 a[100:103], v192, s[40:43], 0 offen offset:1024
gated_mix__ssm_conv_s4d__geglu_ffn__prompt_kernel_ngl_48:
    s_waitcnt lgkmcnt(9)
    v_mfma_f32_16x16x32_bf16 v[0:3], v[64:67], v[128:131], v[0:3]
    ds_read_b64 v[80:81], v190 offset:1536
    s_waitcnt lgkmcnt(7)
    v_mfma_f32_16x16x32_bf16 v[4:7], v[64:67], v[132:135], v[4:7]
    ds_read_b64 v[82:83], v190 offset:1544
    v_mfma_f32_16x16x32_bf16 v[4:7], v[68:71], v[128:131], v[4:7]
    ds_read_b128 v[144:147], v191 offset:2048
    v_mfma_f32_16x16x32_bf16 v[8:11], v[68:71], v[132:135], v[8:11]
    ds_read_b64 v[84:85], v190 offset:1024
    s_waitcnt lgkmcnt(7)
    v_mfma_f32_16x16x32_bf16 v[8:11], v[64:67], v[136:139], v[8:11]
    ds_read_b64 v[86:87], v190 offset:1032
    v_mfma_f32_16x16x32_bf16 v[8:11], v[72:75], v[128:131], v[8:11]
    ds_read_b128 v[148:151], v191 offset:2560
    v_mfma_f32_16x16x32_bf16 v[12:15], v[68:71], v[136:139], v[12:15]
    ds_read_b64 v[88:89], v190 offset:512
    v_mfma_f32_16x16x32_bf16 v[12:15], v[72:75], v[132:135], v[12:15]
    ds_read_b64 v[90:91], v190 offset:520
    v_mfma_f32_16x16x32_bf16 v[16:19], v[72:75], v[136:139], v[16:19]
    ds_read_b128 v[152:155], v191 offset:3072
    s_waitcnt lgkmcnt(9)
    v_mfma_f32_16x16x32_bf16 v[12:15], v[64:67], v[140:143], v[12:15]
    ds_read_b64 v[92:93], v190 offset:0
    v_mfma_f32_16x16x32_bf16 v[12:15], v[76:79], v[128:131], v[12:15]
    ds_read_b64 v[94:95], v190 offset:8
    v_mfma_f32_16x16x32_bf16 v[16:19], v[68:71], v[140:143], v[16:19]
    ds_read_b128 v[156:159], v191 offset:3584
    v_mfma_f32_16x16x32_bf16 v[16:19], v[76:79], v[132:135], v[16:19]
    v_subrev_u32 v190, 64, v190
    v_subrev_u32 v191, 64, v191
    v_mfma_f32_16x16x32_bf16 v[20:23], v[72:75], v[140:143], v[20:23]
    ds_read_b64 v[32:33], v190 offset:3584
    v_mfma_f32_16x16x32_bf16 v[20:23], v[76:79], v[136:139], v[20:23]
    buffer_load_dwordx4 a[2:5], v168, s[8:11], s27 offen offset:8 sc1
    ds_read_b64 v[34:35], v190 offset:3592
    v_mfma_f32_16x16x32_bf16 v[24:27], v[76:79], v[140:143], v[24:27]
    ds_read_b128 v[96:99], v191 offset:0
    s_waitcnt lgkmcnt(12)
    v_mfma_f32_16x16x32_bf16 v[16:19], v[64:67], v[144:147], v[16:19]
    ds_read_b64 v[36:37], v190 offset:3072
    v_mfma_f32_16x16x32_bf16 v[16:19], v[80:83], v[128:131], v[16:19]
    ds_read_b64 v[38:39], v190 offset:3080
    v_mfma_f32_16x16x32_bf16 v[20:23], v[68:71], v[144:147], v[20:23]
    ds_read_b128 v[100:103], v191 offset:512
    v_mfma_f32_16x16x32_bf16 v[20:23], v[80:83], v[132:135], v[20:23]
    v_mfma_f32_16x16x32_bf16 v[24:27], v[72:75], v[144:147], v[24:27]
    v_mfma_f32_16x16x32_bf16 v[24:27], v[80:83], v[136:139], v[24:27]
    v_mfma_f32_16x16x32_bf16 v[28:31], v[76:79], v[144:147], v[28:31]
    v_mfma_f32_16x16x32_bf16 v[28:31], v[80:83], v[140:143], v[28:31]
    s_waitcnt lgkmcnt(12)
    v_mfma_f32_16x16x32_bf16 v[20:23], v[64:67], v[148:151], v[20:23]
    ds_read_b64 v[40:41], v190 offset:2560
    v_mfma_f32_16x16x32_bf16 v[20:23], v[84:87], v[128:131], v[20:23]
    ds_read_b64 v[42:43], v190 offset:2568
    v_mfma_f32_16x16x32_bf16 v[24:27], v[68:71], v[148:151], v[24:27]
    ds_read_b128 v[104:107], v191 offset:1024
    v_mfma_f32_16x16x32_bf16 v[24:27], v[84:87], v[132:135], v[24:27]
    v_mfma_f32_16x16x32_bf16 v[28:31], v[72:75], v[148:151], v[28:31]
    v_mfma_f32_16x16x32_bf16 v[28:31], v[84:87], v[136:139], v[28:31]
    s_waitcnt lgkmcnt(12)
    v_mfma_f32_16x16x32_bf16 v[24:27], v[64:67], v[152:155], v[24:27]
    buffer_load_dwordx2 a[0:1], v168, s[8:11], s27 offen offset:0 sc1
    ds_read_b64 v[44:45], v190 offset:2048
    v_mfma_f32_16x16x32_bf16 v[24:27], v[88:91], v[128:131], v[24:27]
    ds_read_b64 v[46:47], v190 offset:2056
    v_mfma_f32_16x16x32_bf16 v[28:31], v[68:71], v[152:155], v[28:31]
    ds_read_b128 v[108:111], v191 offset:1536
    v_mfma_f32_16x16x32_bf16 v[28:31], v[88:91], v[132:135], v[28:31]
    s_waitcnt lgkmcnt(12)
    v_mfma_f32_16x16x32_bf16 v[28:31], v[64:67], v[156:159], v[28:31]
    v_mfma_f32_16x16x32_bf16 v[28:31], v[92:95], v[128:131], v[28:31]
    s_waitcnt lgkmcnt(9)
    v_mfma_f32_16x16x32_bf16 v[0:3], v[32:35], v[96:99], v[0:3]
    ds_read_b64 v[48:49], v190 offset:1536
    s_waitcnt lgkmcnt(7)
    v_mfma_f32_16x16x32_bf16 v[4:7], v[32:35], v[100:103], v[4:7]
    ds_read_b64 v[50:51], v190 offset:1544
    v_mfma_f32_16x16x32_bf16 v[4:7], v[36:39], v[96:99], v[4:7]
    ds_read_b128 v[112:115], v191 offset:2048
    v_mfma_f32_16x16x32_bf16 v[8:11], v[36:39], v[100:103], v[8:11]
    ds_read_b64 v[52:53], v190 offset:1024
    s_waitcnt lgkmcnt(7)
    v_mfma_f32_16x16x32_bf16 v[8:11], v[32:35], v[104:107], v[8:11]
    ds_read_b64 v[54:55], v190 offset:1032
    v_mfma_f32_16x16x32_bf16 v[8:11], v[40:43], v[96:99], v[8:11]
    ds_read_b128 v[116:119], v191 offset:2560
    v_mfma_f32_16x16x32_bf16 v[12:15], v[36:39], v[104:107], v[12:15]
    ds_read_b64 v[56:57], v190 offset:512
    v_mfma_f32_16x16x32_bf16 v[12:15], v[40:43], v[100:103], v[12:15]
    ds_read_b64 v[58:59], v190 offset:520
    v_mfma_f32_16x16x32_bf16 v[16:19], v[40:43], v[104:107], v[16:19]
    ds_read_b128 v[120:123], v191 offset:3072
    s_waitcnt lgkmcnt(9)
    v_mfma_f32_16x16x32_bf16 v[12:15], v[32:35], v[108:111], v[12:15]
    ds_read_b64 v[60:61], v190 offset:0
    v_mfma_f32_16x16x32_bf16 v[12:15], v[44:47], v[96:99], v[12:15]
    ds_read_b64 v[62:63], v190 offset:8
    v_mfma_f32_16x16x32_bf16 v[16:19], v[36:39], v[108:111], v[16:19]
    ds_read_b128 v[124:127], v191 offset:3584
    v_mfma_f32_16x16x32_bf16 v[16:19], v[44:47], v[100:103], v[16:19]
    v_subrev_u32 v190, 64, v190
    v_subrev_u32 v191, 64, v191
    v_mfma_f32_16x16x32_bf16 v[20:23], v[40:43], v[108:111], v[20:23]
    ds_read_b64 v[64:65], v190 offset:3584
    v_mfma_f32_16x16x32_bf16 v[20:23], v[44:47], v[104:107], v[20:23]
    buffer_load_dwordx4 a[8:11], v168, s[8:11], s27 offen offset:1032 sc1
    ds_read_b64 v[66:67], v190 offset:3592
    v_mfma_f32_16x16x32_bf16 v[24:27], v[44:47], v[108:111], v[24:27]
    ds_read_b128 v[128:131], v191 offset:0
    s_waitcnt lgkmcnt(12)
    v_mfma_f32_16x16x32_bf16 v[16:19], v[32:35], v[112:115], v[16:19]
    ds_read_b64 v[68:69], v190 offset:3072
    v_mfma_f32_16x16x32_bf16 v[16:19], v[48:51], v[96:99], v[16:19]
    ds_read_b64 v[70:71], v190 offset:3080
    v_mfma_f32_16x16x32_bf16 v[20:23], v[36:39], v[112:115], v[20:23]
    ds_read_b128 v[132:135], v191 offset:512
    v_mfma_f32_16x16x32_bf16 v[20:23], v[48:51], v[100:103], v[20:23]
    s_waitcnt lgkmcnt(13)
    ds_write_b128 v169, v[226:229] offset:0
    v_mfma_f32_16x16x32_bf16 v[24:27], v[40:43], v[112:115], v[24:27]
    ds_read_b64 v[72:73], v190 offset:2560
    v_mfma_f32_16x16x32_bf16 v[24:27], v[48:51], v[104:107], v[24:27]
    v_alignbit_b32 v170, v225, v224, 16
    v_alignbit_b32 v171, v226, v225, 16
    v_mfma_f32_16x16x32_bf16 v[28:31], v[44:47], v[112:115], v[28:31]
    v_alignbit_b32 v172, v227, v226, 16
    v_alignbit_b32 v173, v228, v227, 16
    v_mfma_f32_16x16x32_bf16 v[28:31], v[48:51], v[108:111], v[28:31]
    s_waitcnt lgkmcnt(14)
    ds_write_b128 v169, v[170:173] offset:12480
    v_mfma_f32_16x16x32_bf16 v[20:23], v[32:35], v[116:119], v[20:23]
    v_mov_b32 v174, v171
    v_mov_b32 v175, v172
    v_mfma_f32_16x16x32_bf16 v[20:23], v[52:55], v[96:99], v[20:23]
    v_mov_b32 v176, v173
    v_alignbit_b32 v177, v229, v228, 16
    v_mfma_f32_16x16x32_bf16 v[24:27], v[36:39], v[116:119], v[24:27]
    s_waitcnt lgkmcnt(13)
    ds_write_b128 v169, v[174:177] offset:4160
    v_mfma_f32_16x16x32_bf16 v[24:27], v[52:55], v[100:103], v[24:27]
    ds_read_b64 v[74:75], v190 offset:2568
    v_mfma_f32_16x16x32_bf16 v[28:31], v[40:43], v[116:119], v[28:31]
    v_mov_b32 v178, v225
    v_mov_b32 v179, v226
    v_mfma_f32_16x16x32_bf16 v[28:31], v[52:55], v[104:107], v[28:31]
    v_mov_b32 v180, v227
    v_mov_b32 v181, v228
    s_waitcnt lgkmcnt(14)
    v_mfma_f32_16x16x32_bf16 v[24:27], v[32:35], v[120:123], v[24:27]
    buffer_load_dwordx2 a[6:7], v168, s[8:11], s27 offen offset:1024 sc1
    ds_read_b128 v[136:139], v191 offset:1024
    v_mfma_f32_16x16x32_bf16 v[24:27], v[56:59], v[96:99], v[24:27]
    s_waitcnt lgkmcnt(13)
    ds_write_b128 v169, v[178:181] offset:8320
    v_mfma_f32_16x16x32_bf16 v[28:31], v[36:39], v[120:123], v[28:31]
    ds_read_b64 v[76:77], v190 offset:2048
    v_mfma_f32_16x16x32_bf16 v[28:31], v[56:59], v[100:103], v[28:31]
    s_waitcnt lgkmcnt(14)
    ds_write_b128 v169, v[232:235] offset:1024
    v_mfma_f32_16x16x32_bf16 v[28:31], v[32:35], v[124:127], v[28:31]
    v_alignbit_b32 v170, v231, v230, 16
    v_alignbit_b32 v171, v232, v231, 16
    v_mfma_f32_16x16x32_bf16 v[28:31], v[60:63], v[96:99], v[28:31]
    v_alignbit_b32 v172, v233, v232, 16
    v_alignbit_b32 v173, v234, v233, 16
    s_waitcnt lgkmcnt(13)
    ds_read_b64 v[78:79], v190 offset:2056
    ds_read_b128 v[140:143], v191 offset:1536
    s_waitcnt lgkmcnt(14)
    v_mfma_f32_16x16x32_bf16 v[0:3], v[64:67], v[128:131], v[0:3]
    ds_read_b64 v[80:81], v190 offset:1536
    s_waitcnt lgkmcnt(12)
    v_mfma_f32_16x16x32_bf16 v[4:7], v[64:67], v[132:135], v[4:7]
    ds_read_b64 v[82:83], v190 offset:1544
    v_mfma_f32_16x16x32_bf16 v[4:7], v[68:71], v[128:131], v[4:7]
    ds_read_b128 v[144:147], v191 offset:2048
    v_mfma_f32_16x16x32_bf16 v[8:11], v[68:71], v[132:135], v[8:11]
    ds_read_b64 v[84:85], v190 offset:1024
    s_waitcnt lgkmcnt(9)
    v_mfma_f32_16x16x32_bf16 v[8:11], v[64:67], v[136:139], v[8:11]
    ds_read_b64 v[86:87], v190 offset:1032
    v_mfma_f32_16x16x32_bf16 v[8:11], v[72:75], v[128:131], v[8:11]
    ds_read_b128 v[148:151], v191 offset:2560
    v_mfma_f32_16x16x32_bf16 v[12:15], v[68:71], v[136:139], v[12:15]
    ds_read_b64 v[88:89], v190 offset:512
    v_mfma_f32_16x16x32_bf16 v[12:15], v[72:75], v[132:135], v[12:15]
    ds_read_b64 v[90:91], v190 offset:520
    v_mfma_f32_16x16x32_bf16 v[16:19], v[72:75], v[136:139], v[16:19]
    ds_read_b128 v[152:155], v191 offset:3072
    s_waitcnt lgkmcnt(9)
    v_mfma_f32_16x16x32_bf16 v[12:15], v[64:67], v[140:143], v[12:15]
    ds_read_b64 v[92:93], v190 offset:0
    v_mfma_f32_16x16x32_bf16 v[12:15], v[76:79], v[128:131], v[12:15]
    ds_read_b64 v[94:95], v190 offset:8
    v_mfma_f32_16x16x32_bf16 v[16:19], v[68:71], v[140:143], v[16:19]
    ds_read_b128 v[156:159], v191 offset:3584
    v_mfma_f32_16x16x32_bf16 v[16:19], v[76:79], v[132:135], v[16:19]
    v_subrev_u32 v190, 64, v190
    v_subrev_u32 v191, 64, v191
    v_mfma_f32_16x16x32_bf16 v[20:23], v[72:75], v[140:143], v[20:23]
    ds_read_b64 v[32:33], v190 offset:3584
    v_mfma_f32_16x16x32_bf16 v[20:23], v[76:79], v[136:139], v[20:23]
    buffer_load_dwordx4 a[14:17], v168, s[8:11], s27 offen offset:2056 sc1
    ds_read_b64 v[34:35], v190 offset:3592
    v_mfma_f32_16x16x32_bf16 v[24:27], v[76:79], v[140:143], v[24:27]
    ds_read_b128 v[96:99], v191 offset:0
    s_waitcnt lgkmcnt(12)
    v_mfma_f32_16x16x32_bf16 v[16:19], v[64:67], v[144:147], v[16:19]
    ds_read_b64 v[36:37], v190 offset:3072
    v_mfma_f32_16x16x32_bf16 v[16:19], v[80:83], v[128:131], v[16:19]
    ds_read_b64 v[38:39], v190 offset:3080
    v_mfma_f32_16x16x32_bf16 v[20:23], v[68:71], v[144:147], v[20:23]
    ds_read_b128 v[100:103], v191 offset:512
    v_mfma_f32_16x16x32_bf16 v[20:23], v[80:83], v[132:135], v[20:23]
    s_waitcnt lgkmcnt(13)
    ds_write_b128 v169, v[170:173] offset:13504
    v_mfma_f32_16x16x32_bf16 v[24:27], v[72:75], v[144:147], v[24:27]
    ds_read_b64 v[40:41], v190 offset:2560
    v_mfma_f32_16x16x32_bf16 v[24:27], v[80:83], v[136:139], v[24:27]
    v_mov_b32 v174, v171
    v_mov_b32 v175, v172
    v_mfma_f32_16x16x32_bf16 v[28:31], v[76:79], v[144:147], v[28:31]
    v_mov_b32 v176, v173
    v_alignbit_b32 v177, v235, v234, 16
    v_mfma_f32_16x16x32_bf16 v[28:31], v[80:83], v[140:143], v[28:31]
    s_waitcnt lgkmcnt(14)
    ds_write_b128 v169, v[174:177] offset:5184
    v_mfma_f32_16x16x32_bf16 v[20:23], v[64:67], v[148:151], v[20:23]
    v_mov_b32 v178, v231
    v_mov_b32 v179, v232
    v_mfma_f32_16x16x32_bf16 v[20:23], v[84:87], v[128:131], v[20:23]
    v_mov_b32 v180, v233
    v_mov_b32 v181, v234
    v_mfma_f32_16x16x32_bf16 v[24:27], v[68:71], v[148:151], v[24:27]
    s_waitcnt lgkmcnt(13)
    ds_write_b128 v169, v[178:181] offset:9344
    v_mfma_f32_16x16x32_bf16 v[24:27], v[84:87], v[132:135], v[24:27]
    ds_read_b64 v[42:43], v190 offset:2568
    v_mfma_f32_16x16x32_bf16 v[28:31], v[72:75], v[148:151], v[28:31]
    s_waitcnt lgkmcnt(14)
    ds_write_b128 v169, v[238:241] offset:2048
    v_mfma_f32_16x16x32_bf16 v[28:31], v[84:87], v[136:139], v[28:31]
    v_alignbit_b32 v170, v237, v236, 16
    v_alignbit_b32 v171, v238, v237, 16
    v_mfma_f32_16x16x32_bf16 v[24:27], v[64:67], v[152:155], v[24:27]
    buffer_load_dwordx2 a[12:13], v168, s[8:11], s27 offen offset:2048 sc1
    v_alignbit_b32 v172, v239, v238, 16
    v_alignbit_b32 v173, v240, v239, 16
    v_mfma_f32_16x16x32_bf16 v[24:27], v[88:91], v[128:131], v[24:27]
    s_waitcnt lgkmcnt(13)
    ds_write_b128 v169, v[170:173] offset:14528
    v_mfma_f32_16x16x32_bf16 v[28:31], v[68:71], v[152:155], v[28:31]
    ds_read_b128 v[104:107], v191 offset:1024
    v_mfma_f32_16x16x32_bf16 v[28:31], v[88:91], v[132:135], v[28:31]
    v_mov_b32 v174, v171
    v_mov_b32 v175, v172
    s_waitcnt lgkmcnt(14)
    v_mfma_f32_16x16x32_bf16 v[28:31], v[64:67], v[156:159], v[28:31]
    ds_read_b64 v[44:45], v190 offset:2048
    v_mfma_f32_16x16x32_bf16 v[28:31], v[92:95], v[128:131], v[28:31]
    v_mov_b32 v176, v173
    v_alignbit_b32 v177, v241, v240, 16
    s_waitcnt lgkmcnt(13)
    ds_read_b64 v[46:47], v190 offset:2056
    ds_read_b128 v[108:111], v191 offset:1536
    s_waitcnt lgkmcnt(14)
    v_mfma_f32_16x16x32_bf16 v[0:3], v[32:35], v[96:99], v[0:3]
    ds_read_b64 v[48:49], v190 offset:1536
    s_waitcnt lgkmcnt(12)
    v_mfma_f32_16x16x32_bf16 v[4:7], v[32:35], v[100:103], v[4:7]
    ds_read_b64 v[50:51], v190 offset:1544
    v_mfma_f32_16x16x32_bf16 v[4:7], v[36:39], v[96:99], v[4:7]
    ds_read_b128 v[112:115], v191 offset:2048
    v_mfma_f32_16x16x32_bf16 v[8:11], v[36:39], v[100:103], v[8:11]
    ds_read_b64 v[52:53], v190 offset:1024
    s_waitcnt lgkmcnt(7)
    v_mfma_f32_16x16x32_bf16 v[8:11], v[32:35], v[104:107], v[8:11]
    ds_read_b64 v[54:55], v190 offset:1032
    v_mfma_f32_16x16x32_bf16 v[8:11], v[40:43], v[96:99], v[8:11]
    ds_read_b128 v[116:119], v191 offset:2560
    v_mfma_f32_16x16x32_bf16 v[12:15], v[36:39], v[104:107], v[12:15]
    ds_read_b64 v[56:57], v190 offset:512
    v_mfma_f32_16x16x32_bf16 v[12:15], v[40:43], v[100:103], v[12:15]
    ds_read_b64 v[58:59], v190 offset:520
    v_mfma_f32_16x16x32_bf16 v[16:19], v[40:43], v[104:107], v[16:19]
    ds_read_b128 v[120:123], v191 offset:3072
    s_waitcnt lgkmcnt(9)
    v_mfma_f32_16x16x32_bf16 v[12:15], v[32:35], v[108:111], v[12:15]
    ds_read_b64 v[60:61], v190 offset:0
    v_mfma_f32_16x16x32_bf16 v[12:15], v[44:47], v[96:99], v[12:15]
    ds_read_b64 v[62:63], v190 offset:8
    v_mfma_f32_16x16x32_bf16 v[16:19], v[36:39], v[108:111], v[16:19]
    ds_read_b128 v[124:127], v191 offset:3584
    v_mfma_f32_16x16x32_bf16 v[16:19], v[44:47], v[100:103], v[16:19]
    v_subrev_u32 v190, 64, v190
    v_subrev_u32 v191, 64, v191
    v_mfma_f32_16x16x32_bf16 v[20:23], v[40:43], v[108:111], v[20:23]
    ds_read_b64 v[64:65], v190 offset:3584
    v_mfma_f32_16x16x32_bf16 v[20:23], v[44:47], v[104:107], v[20:23]
    buffer_load_dwordx4 a[20:23], v168, s[8:11], s27 offen offset:3080 sc1
    ds_read_b64 v[66:67], v190 offset:3592
    v_mfma_f32_16x16x32_bf16 v[24:27], v[44:47], v[108:111], v[24:27]
    ds_read_b128 v[128:131], v191 offset:0
    s_waitcnt lgkmcnt(12)
    v_mfma_f32_16x16x32_bf16 v[16:19], v[32:35], v[112:115], v[16:19]
    ds_read_b64 v[68:69], v190 offset:3072
    v_mfma_f32_16x16x32_bf16 v[16:19], v[48:51], v[96:99], v[16:19]
    ds_read_b64 v[70:71], v190 offset:3080
    v_mfma_f32_16x16x32_bf16 v[20:23], v[36:39], v[112:115], v[20:23]
    ds_read_b128 v[132:135], v191 offset:512
    v_mfma_f32_16x16x32_bf16 v[20:23], v[48:51], v[100:103], v[20:23]
    s_waitcnt lgkmcnt(13)
    ds_write_b128 v169, v[174:177] offset:6208
    v_mfma_f32_16x16x32_bf16 v[24:27], v[40:43], v[112:115], v[24:27]
    ds_read_b64 v[72:73], v190 offset:2560
    v_mfma_f32_16x16x32_bf16 v[24:27], v[48:51], v[104:107], v[24:27]
    v_mov_b32 v178, v237
    v_mov_b32 v179, v238
    v_mfma_f32_16x16x32_bf16 v[28:31], v[44:47], v[112:115], v[28:31]
    v_mov_b32 v180, v239
    v_mov_b32 v181, v240
    v_mfma_f32_16x16x32_bf16 v[28:31], v[48:51], v[108:111], v[28:31]
    s_waitcnt lgkmcnt(14)
    ds_write_b128 v169, v[178:181] offset:10368
    v_mfma_f32_16x16x32_bf16 v[20:23], v[32:35], v[116:119], v[20:23]
    s_waitcnt lgkmcnt(13)
    ds_write_b128 v169, v[244:247] offset:3072
    v_mfma_f32_16x16x32_bf16 v[20:23], v[52:55], v[96:99], v[20:23]
    ds_read_b64 v[74:75], v190 offset:2568
    v_mfma_f32_16x16x32_bf16 v[24:27], v[36:39], v[116:119], v[24:27]
    v_alignbit_b32 v170, v243, v242, 16
    v_alignbit_b32 v171, v244, v243, 16
    v_mfma_f32_16x16x32_bf16 v[24:27], v[52:55], v[100:103], v[24:27]
    v_alignbit_b32 v172, v245, v244, 16
    v_alignbit_b32 v173, v246, v245, 16
    v_mfma_f32_16x16x32_bf16 v[28:31], v[40:43], v[116:119], v[28:31]
    s_waitcnt lgkmcnt(14)
    ds_write_b128 v169, v[170:173] offset:15552
    v_mfma_f32_16x16x32_bf16 v[28:31], v[52:55], v[104:107], v[28:31]
    v_mov_b32 v174, v171
    v_mov_b32 v175, v172
    v_mfma_f32_16x16x32_bf16 v[24:27], v[32:35], v[120:123], v[24:27]
    buffer_load_dwordx2 a[18:19], v168, s[8:11], s27 offen offset:3072 sc1
    v_mov_b32 v176, v173
    v_alignbit_b32 v177, v247, v246, 16
    v_mfma_f32_16x16x32_bf16 v[24:27], v[56:59], v[96:99], v[24:27]
    s_waitcnt lgkmcnt(13)
    ds_write_b128 v169, v[174:177] offset:7232
    v_mfma_f32_16x16x32_bf16 v[28:31], v[36:39], v[120:123], v[28:31]
    ds_read_b128 v[136:139], v191 offset:1024
    v_mfma_f32_16x16x32_bf16 v[28:31], v[56:59], v[100:103], v[28:31]
    v_mov_b32 v178, v243
    v_mov_b32 v179, v244
    s_waitcnt lgkmcnt(14)
    v_mfma_f32_16x16x32_bf16 v[28:31], v[32:35], v[124:127], v[28:31]
    ds_read_b64 v[76:77], v190 offset:2048
    v_mfma_f32_16x16x32_bf16 v[28:31], v[60:63], v[96:99], v[28:31]
    v_mov_b32 v180, v245
    v_mov_b32 v181, v246
    s_waitcnt lgkmcnt(13)
    ds_read_b64 v[78:79], v190 offset:2056
    ds_read_b128 v[140:143], v191 offset:1536
    s_waitcnt lgkmcnt(14)
    v_mfma_f32_16x16x32_bf16 v[0:3], v[64:67], v[128:131], v[0:3]
    ds_read_b64 v[80:81], v190 offset:1536
    s_waitcnt lgkmcnt(12)
    v_mfma_f32_16x16x32_bf16 v[4:7], v[64:67], v[132:135], v[4:7]
    ds_read_b64 v[82:83], v190 offset:1544
    v_mfma_f32_16x16x32_bf16 v[4:7], v[68:71], v[128:131], v[4:7]
    ds_read_b128 v[144:147], v191 offset:2048
    v_mfma_f32_16x16x32_bf16 v[8:11], v[68:71], v[132:135], v[8:11]
    ds_read_b64 v[84:85], v190 offset:1024
    s_waitcnt lgkmcnt(7)
    v_mfma_f32_16x16x32_bf16 v[8:11], v[64:67], v[136:139], v[8:11]
    ds_read_b64 v[86:87], v190 offset:1032
    v_mfma_f32_16x16x32_bf16 v[8:11], v[72:75], v[128:131], v[8:11]
    ds_read_b128 v[148:151], v191 offset:2560
    v_mfma_f32_16x16x32_bf16 v[12:15], v[68:71], v[136:139], v[12:15]
    ds_read_b64 v[88:89], v190 offset:512
    v_mfma_f32_16x16x32_bf16 v[12:15], v[72:75], v[132:135], v[12:15]
    ds_read_b64 v[90:91], v190 offset:520
    v_mfma_f32_16x16x32_bf16 v[16:19], v[72:75], v[136:139], v[16:19]
    ds_read_b128 v[152:155], v191 offset:3072
    s_waitcnt lgkmcnt(9)
    v_mfma_f32_16x16x32_bf16 v[12:15], v[64:67], v[140:143], v[12:15]
    ds_read_b64 v[92:93], v190 offset:0
    v_mfma_f32_16x16x32_bf16 v[12:15], v[76:79], v[128:131], v[12:15]
    ds_read_b64 v[94:95], v190 offset:8
    v_mfma_f32_16x16x32_bf16 v[16:19], v[68:71], v[140:143], v[16:19]
    ds_read_b128 v[156:159], v191 offset:3584
    v_mfma_f32_16x16x32_bf16 v[16:19], v[76:79], v[132:135], v[16:19]
    v_subrev_u32 v190, 64, v190
    v_subrev_u32 v191, 64, v191
    v_mfma_f32_16x16x32_bf16 v[20:23], v[72:75], v[140:143], v[20:23]
    ds_read_b64 v[32:33], v190 offset:3584
    v_mfma_f32_16x16x32_bf16 v[20:23], v[76:79], v[136:139], v[20:23]
    s_add_u32 s24, s27, 4096
    buffer_load_dwordx4 a[26:29], v168, s[8:11], s24 offen offset:8 sc1
    ds_read_b64 v[34:35], v190 offset:3592
    v_mfma_f32_16x16x32_bf16 v[24:27], v[76:79], v[140:143], v[24:27]
    ds_read_b128 v[96:99], v191 offset:0
    s_waitcnt lgkmcnt(12)
    v_mfma_f32_16x16x32_bf16 v[16:19], v[64:67], v[144:147], v[16:19]
    ds_read_b64 v[36:37], v190 offset:3072
    v_mfma_f32_16x16x32_bf16 v[16:19], v[80:83], v[128:131], v[16:19]
    ds_read_b64 v[38:39], v190 offset:3080
    v_mfma_f32_16x16x32_bf16 v[20:23], v[68:71], v[144:147], v[20:23]
    ds_read_b128 v[100:103], v191 offset:512
    v_mfma_f32_16x16x32_bf16 v[20:23], v[80:83], v[132:135], v[20:23]
    s_waitcnt lgkmcnt(13)
    ds_write_b128 v169, v[178:181] offset:11392
    v_mfma_f32_16x16x32_bf16 v[24:27], v[72:75], v[144:147], v[24:27]
    ds_read_b64 v[40:41], v190 offset:2560
    v_mfma_f32_16x16x32_bf16 v[24:27], v[80:83], v[136:139], v[24:27]
    s_waitcnt lgkmcnt(14)
    s_mov_b64 exec, 15
    ds_write_b128 v169, v[250:253] offset:4096
    s_mov_b64 exec, -1
    v_mfma_f32_16x16x32_bf16 v[28:31], v[76:79], v[144:147], v[28:31]
    v_alignbit_b32 v170, v249, v248, 16
    v_alignbit_b32 v171, v250, v249, 16
    v_mfma_f32_16x16x32_bf16 v[28:31], v[80:83], v[140:143], v[28:31]
    v_alignbit_b32 v172, v251, v250, 16
    v_alignbit_b32 v173, v252, v251, 16
    v_mfma_f32_16x16x32_bf16 v[20:23], v[64:67], v[148:151], v[20:23]
    s_waitcnt lgkmcnt(13)
    s_mov_b64 exec, 15
    ds_write_b128 v169, v[170:173] offset:16576
    s_mov_b64 exec, -1
    v_mfma_f32_16x16x32_bf16 v[20:23], v[84:87], v[128:131], v[20:23]
    ds_read_b64 v[42:43], v190 offset:2568
    v_mfma_f32_16x16x32_bf16 v[24:27], v[68:71], v[148:151], v[24:27]
    v_mov_b32 v174, v171
    v_mov_b32 v175, v172
    v_mfma_f32_16x16x32_bf16 v[24:27], v[84:87], v[132:135], v[24:27]
    v_mov_b32 v176, v173
    v_alignbit_b32 v177, v253, v252, 16
    v_mfma_f32_16x16x32_bf16 v[28:31], v[72:75], v[148:151], v[28:31]
    s_waitcnt lgkmcnt(14)
    s_mov_b64 exec, 15
    ds_write_b128 v169, v[174:177] offset:8256
    s_mov_b64 exec, -1
    v_mfma_f32_16x16x32_bf16 v[28:31], v[84:87], v[136:139], v[28:31]
    v_mov_b32 v178, v249
    v_mov_b32 v179, v250
    v_mfma_f32_16x16x32_bf16 v[24:27], v[64:67], v[152:155], v[24:27]
    buffer_load_dwordx2 a[24:25], v168, s[8:11], s24 offen offset:0 sc1
    v_mov_b32 v180, v251
    v_mov_b32 v181, v252
    v_mfma_f32_16x16x32_bf16 v[24:27], v[88:91], v[128:131], v[24:27]
    s_waitcnt lgkmcnt(13)
    s_mov_b64 exec, 15
    ds_write_b128 v169, v[178:181] offset:12416
    s_mov_b64 exec, -1
    v_mfma_f32_16x16x32_bf16 v[28:31], v[68:71], v[152:155], v[28:31]
    ds_read_b128 v[104:107], v191 offset:1024
    v_mfma_f32_16x16x32_bf16 v[28:31], v[88:91], v[132:135], v[28:31]
    s_waitcnt lgkmcnt(14)
    v_mfma_f32_16x16x32_bf16 v[28:31], v[64:67], v[156:159], v[28:31]
    ds_read_b64 v[44:45], v190 offset:2048
    v_mfma_f32_16x16x32_bf16 v[28:31], v[92:95], v[128:131], v[28:31]
    s_waitcnt lgkmcnt(13)
    ds_read_b64 v[46:47], v190 offset:2056
    ds_read_b128 v[108:111], v191 offset:1536
    s_waitcnt lgkmcnt(14)
    v_mfma_f32_16x16x32_bf16 v[0:3], v[32:35], v[96:99], v[0:3]
    ds_read_b64 v[48:49], v190 offset:1536
    s_waitcnt lgkmcnt(12)
    v_mfma_f32_16x16x32_bf16 v[4:7], v[32:35], v[100:103], v[4:7]
    ds_read_b64 v[50:51], v190 offset:1544
    v_mfma_f32_16x16x32_bf16 v[4:7], v[36:39], v[96:99], v[4:7]
    ds_read_b128 v[112:115], v191 offset:2048
    v_mfma_f32_16x16x32_bf16 v[8:11], v[36:39], v[100:103], v[8:11]
    ds_read_b64 v[52:53], v190 offset:1024
    s_waitcnt lgkmcnt(7)
    v_mfma_f32_16x16x32_bf16 v[8:11], v[32:35], v[104:107], v[8:11]
    ds_read_b64 v[54:55], v190 offset:1032
    v_mfma_f32_16x16x32_bf16 v[8:11], v[40:43], v[96:99], v[8:11]
    ds_read_b128 v[116:119], v191 offset:2560
    v_mfma_f32_16x16x32_bf16 v[12:15], v[36:39], v[104:107], v[12:15]
    ds_read_b64 v[56:57], v190 offset:512
    v_mfma_f32_16x16x32_bf16 v[12:15], v[40:43], v[100:103], v[12:15]
    ds_read_b64 v[58:59], v190 offset:520
    v_mfma_f32_16x16x32_bf16 v[16:19], v[40:43], v[104:107], v[16:19]
    ds_read_b128 v[120:123], v191 offset:3072
    s_waitcnt lgkmcnt(9)
    v_mfma_f32_16x16x32_bf16 v[12:15], v[32:35], v[108:111], v[12:15]
    ds_read_b64 v[60:61], v190 offset:0
    v_mfma_f32_16x16x32_bf16 v[12:15], v[44:47], v[96:99], v[12:15]
    ds_read_b64 v[62:63], v190 offset:8
    v_mfma_f32_16x16x32_bf16 v[16:19], v[36:39], v[108:111], v[16:19]
    ds_read_b128 v[124:127], v191 offset:3584
    v_mfma_f32_16x16x32_bf16 v[16:19], v[44:47], v[100:103], v[16:19]
    v_subrev_u32 v190, 64, v190
    v_subrev_u32 v191, 64, v191
    v_mfma_f32_16x16x32_bf16 v[20:23], v[40:43], v[108:111], v[20:23]
    ds_read_b64 v[64:65], v190 offset:3584
    v_mfma_f32_16x16x32_bf16 v[20:23], v[44:47], v[104:107], v[20:23]
    ds_read_b64 v[66:67], v190 offset:3592
    v_mfma_f32_16x16x32_bf16 v[24:27], v[44:47], v[108:111], v[24:27]
    ds_read_b128 v[128:131], v191 offset:0
    s_waitcnt lgkmcnt(12)
    v_mfma_f32_16x16x32_bf16 v[16:19], v[32:35], v[112:115], v[16:19]
    ds_read_b64 v[68:69], v190 offset:3072
    v_mfma_f32_16x16x32_bf16 v[16:19], v[48:51], v[96:99], v[16:19]
    ds_read_b64 v[70:71], v190 offset:3080
    v_mfma_f32_16x16x32_bf16 v[20:23], v[36:39], v[112:115], v[20:23]
    ds_read_b128 v[132:135], v191 offset:512
    v_mfma_f32_16x16x32_bf16 v[20:23], v[48:51], v[100:103], v[20:23]
    v_mfma_f32_16x16x32_bf16 v[24:27], v[40:43], v[112:115], v[24:27]
    v_mfma_f32_16x16x32_bf16 v[24:27], v[48:51], v[104:107], v[24:27]
    v_mfma_f32_16x16x32_bf16 v[28:31], v[44:47], v[112:115], v[28:31]
    v_mfma_f32_16x16x32_bf16 v[28:31], v[48:51], v[108:111], v[28:31]
    s_waitcnt lgkmcnt(12)
    v_mfma_f32_16x16x32_bf16 v[20:23], v[32:35], v[116:119], v[20:23]
    ds_read_b64 v[72:73], v190 offset:2560
    v_mfma_f32_16x16x32_bf16 v[20:23], v[52:55], v[96:99], v[20:23]
    ds_read_b64 v[74:75], v190 offset:2568
    v_mfma_f32_16x16x32_bf16 v[24:27], v[36:39], v[116:119], v[24:27]
    ds_read_b128 v[136:139], v191 offset:1024
    v_mfma_f32_16x16x32_bf16 v[24:27], v[52:55], v[100:103], v[24:27]
    v_mfma_f32_16x16x32_bf16 v[28:31], v[40:43], v[116:119], v[28:31]
    v_mfma_f32_16x16x32_bf16 v[28:31], v[52:55], v[104:107], v[28:31]
    s_waitcnt lgkmcnt(12)
    v_mfma_f32_16x16x32_bf16 v[24:27], v[32:35], v[120:123], v[24:27]
    ds_read_b64 v[76:77], v190 offset:2048
    v_mfma_f32_16x16x32_bf16 v[24:27], v[56:59], v[96:99], v[24:27]
    ds_read_b64 v[78:79], v190 offset:2056
    v_mfma_f32_16x16x32_bf16 v[28:31], v[36:39], v[120:123], v[28:31]
    ds_read_b128 v[140:143], v191 offset:1536
    v_mfma_f32_16x16x32_bf16 v[28:31], v[56:59], v[100:103], v[28:31]
    s_waitcnt lgkmcnt(12)
    v_mfma_f32_16x16x32_bf16 v[28:31], v[32:35], v[124:127], v[28:31]
    v_mfma_f32_16x16x32_bf16 v[28:31], v[60:63], v[96:99], v[28:31]
    s_waitcnt lgkmcnt(9)
    v_mfma_f32_16x16x32_bf16 v[0:3], v[64:67], v[128:131], v[0:3]
    ds_read_b64 v[80:81], v190 offset:1536
    s_waitcnt lgkmcnt(7)
    v_mfma_f32_16x16x32_bf16 v[4:7], v[64:67], v[132:135], v[4:7]
    ds_read_b64 v[82:83], v190 offset:1544
    v_mfma_f32_16x16x32_bf16 v[4:7], v[68:71], v[128:131], v[4:7]
    ds_read_b128 v[144:147], v191 offset:2048
    v_mfma_f32_16x16x32_bf16 v[8:11], v[68:71], v[132:135], v[8:11]
    ds_read_b64 v[84:85], v190 offset:1024
    s_waitcnt lgkmcnt(7)
    v_mfma_f32_16x16x32_bf16 v[8:11], v[64:67], v[136:139], v[8:11]
    ds_read_b64 v[86:87], v190 offset:1032
    v_mfma_f32_16x16x32_bf16 v[8:11], v[72:75], v[128:131], v[8:11]
    ds_read_b128 v[148:151], v191 offset:2560
    v_mfma_f32_16x16x32_bf16 v[12:15], v[68:71], v[136:139], v[12:15]
    ds_read_b64 v[88:89], v190 offset:512
    v_mfma_f32_16x16x32_bf16 v[12:15], v[72:75], v[132:135], v[12:15]
    ds_read_b64 v[90:91], v190 offset:520
    v_mfma_f32_16x16x32_bf16 v[16:19], v[72:75], v[136:139], v[16:19]
    ds_read_b128 v[152:155], v191 offset:3072
    s_waitcnt lgkmcnt(9)
    v_mfma_f32_16x16x32_bf16 v[12:15], v[64:67], v[140:143], v[12:15]
    ds_read_b64 v[92:93], v190 offset:0
    v_mfma_f32_16x16x32_bf16 v[12:15], v[76:79], v[128:131], v[12:15]
    ds_read_b64 v[94:95], v190 offset:8
    v_mfma_f32_16x16x32_bf16 v[16:19], v[68:71], v[140:143], v[16:19]
    ds_read_b128 v[156:159], v191 offset:3584
    v_mfma_f32_16x16x32_bf16 v[16:19], v[76:79], v[132:135], v[16:19]
    v_mfma_f32_16x16x32_bf16 v[20:23], v[72:75], v[140:143], v[20:23]
    v_mfma_f32_16x16x32_bf16 v[20:23], v[76:79], v[136:139], v[20:23]
    v_mfma_f32_16x16x32_bf16 v[24:27], v[76:79], v[140:143], v[24:27]
    s_waitcnt lgkmcnt(9)
    v_mfma_f32_16x16x32_bf16 v[16:19], v[64:67], v[144:147], v[16:19]
    v_mfma_f32_16x16x32_bf16 v[16:19], v[80:83], v[128:131], v[16:19]
    v_mfma_f32_16x16x32_bf16 v[20:23], v[68:71], v[144:147], v[20:23]
    v_mfma_f32_16x16x32_bf16 v[20:23], v[80:83], v[132:135], v[20:23]
    v_mfma_f32_16x16x32_bf16 v[24:27], v[72:75], v[144:147], v[24:27]
    v_mfma_f32_16x16x32_bf16 v[24:27], v[80:83], v[136:139], v[24:27]
    v_mfma_f32_16x16x32_bf16 v[28:31], v[76:79], v[144:147], v[28:31]
    v_mfma_f32_16x16x32_bf16 v[28:31], v[80:83], v[140:143], v[28:31]
    s_waitcnt lgkmcnt(6)
    v_mfma_f32_16x16x32_bf16 v[20:23], v[64:67], v[148:151], v[20:23]
    v_mfma_f32_16x16x32_bf16 v[20:23], v[84:87], v[128:131], v[20:23]
    v_mfma_f32_16x16x32_bf16 v[24:27], v[68:71], v[148:151], v[24:27]
    v_mfma_f32_16x16x32_bf16 v[24:27], v[84:87], v[132:135], v[24:27]
    v_mfma_f32_16x16x32_bf16 v[28:31], v[72:75], v[148:151], v[28:31]
    v_mfma_f32_16x16x32_bf16 v[28:31], v[84:87], v[136:139], v[28:31]
    s_waitcnt lgkmcnt(3)
    v_mfma_f32_16x16x32_bf16 v[24:27], v[64:67], v[152:155], v[24:27]
    v_mfma_f32_16x16x32_bf16 v[24:27], v[88:91], v[128:131], v[24:27]
    v_mfma_f32_16x16x32_bf16 v[28:31], v[68:71], v[152:155], v[28:31]
    v_mfma_f32_16x16x32_bf16 v[28:31], v[88:91], v[132:135], v[28:31]
    s_waitcnt lgkmcnt(0)
    v_mfma_f32_16x16x32_bf16 v[28:31], v[64:67], v[156:159], v[28:31]
    v_mfma_f32_16x16x32_bf16 v[28:31], v[92:95], v[128:131], v[28:31]
    s_waitcnt lgkmcnt(0)
    s_nop 7
    v_cvt_pk_bf16_f32 v200, v0, v1
    v_cvt_pk_bf16_f32 v201, v2, v3
    v_cvt_pk_bf16_f32 v202, v4, v5
    v_cvt_pk_bf16_f32 v203, v6, v7
    s_nop 1
    v_permlane16_swap_b32 v200, v202
    v_permlane16_swap_b32 v201, v203
    buffer_store_dwordx4 v[200:203], v163, s[16:19], s25 offen offset:0 sc1
    s_nop 1
    v_cvt_pk_bf16_f32 v204, v8, v9
    v_cvt_pk_bf16_f32 v205, v10, v11
    v_cvt_pk_bf16_f32 v206, v12, v13
    v_cvt_pk_bf16_f32 v207, v14, v15
    s_nop 1
    v_permlane16_swap_b32 v204, v206
    v_permlane16_swap_b32 v205, v207
    buffer_store_dwordx4 v[204:207], v163, s[16:19], s25 offen offset:1024 sc1
    s_nop 1
    v_cvt_pk_bf16_f32 v200, v16, v17
    v_cvt_pk_bf16_f32 v201, v18, v19
    v_cvt_pk_bf16_f32 v202, v20, v21
    v_cvt_pk_bf16_f32 v203, v22, v23
    s_nop 1
    v_permlane16_swap_b32 v200, v202
    v_permlane16_swap_b32 v201, v203
    buffer_store_dwordx4 v[200:203], v163, s[16:19], s25 offen offset:2048 sc1
    s_nop 1
    v_cvt_pk_bf16_f32 v204, v24, v25
    v_cvt_pk_bf16_f32 v205, v26, v27
    v_cvt_pk_bf16_f32 v206, v28, v29
    v_cvt_pk_bf16_f32 v207, v30, v31
    s_nop 1
    v_permlane16_swap_b32 v204, v206
    v_permlane16_swap_b32 v205, v207
    buffer_store_dwordx4 v[204:207], v163, s[16:19], s25 offen offset:3072 sc1
    s_nop 1
    s_cmp_eq_u32 s33, 0
    s_cbranch_scc0 gated_mix__ssm_conv_s4d__geglu_ffn__prompt_kernel_ng_49
    s_waitcnt vmcnt(4)
    v_accvgpr_read_b32 v32, a32
    v_accvgpr_read_b32 v33, a33
    v_accvgpr_read_b32 v34, a34
    v_accvgpr_read_b32 v35, a35
    v_accvgpr_read_b32 v36, a36
    v_accvgpr_read_b32 v37, a37
    v_accvgpr_read_b32 v38, a38
    v_accvgpr_read_b32 v39, a39
    v_accvgpr_read_b32 v40, a40
    v_accvgpr_read_b32 v41, a41
    v_accvgpr_read_b32 v42, a42
    v_accvgpr_read_b32 v43, a43
    v_accvgpr_read_b32 v44, a44
    v_accvgpr_read_b32 v45, a45
    v_accvgpr_read_b32 v46, a46
    v_accvgpr_read_b32 v47, a47
    v_accvgpr_read_b32 v48, a48
    v_accvgpr_read_b32 v49, a49
    v_accvgpr_read_b32 v50, a50
    v_accvgpr_read_b32 v51, a51
    v_accvgpr_read_b32 v52, a52
    v_accvgpr_read_b32 v53, a53
    v_accvgpr_read_b32 v54, a54
    v_accvgpr_read_b32 v55, a55
    v_accvgpr_read_b32 v56, a56
    v_accvgpr_read_b32 v57, a57
    v_accvgpr_read_b32 v58, a58
    v_accvgpr_read_b32 v59, a59
    v_accvgpr_read_b32 v60, a60
    v_accvgpr_read_b32 v61, a61
    v_accvgpr_read_b32 v62, a62
    v_accvgpr_read_b32 v63, a63
    v_accvgpr_read_b32 v64, a64
    v_accvgpr_read_b32 v65, a65
    v_accvgpr_read_b32 v66, a66
    v_accvgpr_read_b32 v67, a67
    v_accvgpr_read_b32 v68, a68
    v_accvgpr_read_b32 v69, a69
    v_accvgpr_read_b32 v70, a70
    v_accvgpr_read_b32 v71, a71
    v_accvgpr_read_b32 v72, a72
    v_accvgpr_read_b32 v73, a73
    v_accvgpr_read_b32 v74, a74
    v_accvgpr_read_b32 v75, a75
    v_accvgpr_read_b32 v76, a76
    v_accvgpr_read_b32 v77, a77
    v_accvgpr_read_b32 v78, a78
    v_accvgpr_read_b32 v79, a79
    v_accvgpr_read_b32 v80, a80
    v_accvgpr_read_b32 v81, a81
    v_accvgpr_read_b32 v82, a82
    v_accvgpr_read_b32 v83, a83
    v_accvgpr_read_b32 v84, a84
    v_accvgpr_read_b32 v85, a85
    v_accvgpr_read_b32 v86, a86
    v_accvgpr_read_b32 v87, a87
    v_accvgpr_read_b32 v88, a88
    v_accvgpr_read_b32 v89, a89
    v_accvgpr_read_b32 v90, a90
    v_accvgpr_read_b32 v91, a91
    v_accvgpr_read_b32 v92, a92
    v_accvgpr_read_b32 v93, a93
    v_accvgpr_read_b32 v94, a94
    v_accvgpr_read_b32 v95, a95
    v_accvgpr_read_b32 v96, a96
    v_accvgpr_read_b32 v97, a97
    v_accvgpr_read_b32 v98, a98
    v_accvgpr_read_b32 v99, a99
    v_accvgpr_read_b32 v100, a100
    v_accvgpr_read_b32 v101, a101
    v_accvgpr_read_b32 v102, a102
    v_accvgpr_read_b32 v103, a103
    v_mov_b32 v195, 0
    v_mov_b32 v196, 0
    v_mov_b32 v197, 0
    v_mov_b32 v198, 0
    v_dot2c_f32_bf16 v195, v32, v68
    v_dot2c_f32_bf16 v196, v33, v69
    v_dot2c_f32_bf16 v197, v34, v70
    v_dot2c_f32_bf16 v198, v35, v71
    v_dot2c_f32_bf16 v195, v36, v72
    v_dot2c_f32_bf16 v196, v37, v73
    v_dot2c_f32_bf16 v197, v38, v74
    v_dot2c_f32_bf16 v198, v39, v75
    v_dot2c_f32_bf16 v195, v40, v76
    v_dot2c_f32_bf16 v196, v41, v77
    v_dot2c_f32_bf16 v197, v42, v78
    v_dot2c_f32_bf16 v198, v43, v79
    v_dot2c_f32_bf16 v195, v44, v80
    v_dot2c_f32_bf16 v196, v45, v81
    v_dot2c_f32_bf16 v197, v46, v82
    v_dot2c_f32_bf16 v198, v47, v83
    v_dot2c_f32_bf16 v195, v48, v84
    v_dot2c_f32_bf16 v196, v49, v85
    v_dot2c_f32_bf16 v197, v50, v86
    v_dot2c_f32_bf16 v198, v51, v87
    v_dot2c_f32_bf16 v195, v52, v88
    v_dot2c_f32_bf16 v196, v53, v89
    v_dot2c_f32_bf16 v197, v54, v90
    v_dot2c_f32_bf16 v198, v55, v91
    v_dot2c_f32_bf16 v195, v56, v92
    v_dot2c_f32_bf16 v196, v57, v93
    v_dot2c_f32_bf16 v197, v58, v94
    v_dot2c_f32_bf16 v198, v59, v95
    v_dot2c_f32_bf16 v195, v60, v96
    v_dot2c_f32_bf16 v196, v61, v97
    v_dot2c_f32_bf16 v197, v62, v98
    v_dot2c_f32_bf16 v198, v63, v99
    v_dot2c_f32_bf16 v195, v64, v100
    v_dot2c_f32_bf16 v196, v65, v101
    v_dot2c_f32_bf16 v197, v66, v102
    v_dot2c_f32_bf16 v198, v67, v103
    s_nop 3
    v_add_f32 v195, v195, v196
    v_add_f32 v197, v197, v198
    v_add_f32 v195, v195, v197
    s_nop 1
    v_add_f32_dpp v195, v195, v195 quad_perm:[1,0,3,2] row_mask:0xf bank_mask:0xf
    s_nop 1
    v_add_f32_dpp v195, v195, v195 quad_perm:[2,3,0,1] row_mask:0xf bank_mask:0xf
    s_nop 1
    v_add_f32_dpp v195, v195, v195 row_half_mirror row_mask:0xf bank_mask:0xf
    v_cvt_pk_bf16_f32 v195, v195, v195
    v_and_b32 v195, 0xffff0000, v195
    v_mul_f32 v195, 0xbfb8aa3b, v195
    v_exp_f32 v195, v195
    s_nop 0
    v_add_f32 v195, 1.0, v195
    v_rcp_f32 v195, v195
    s_nop 0
    v_cvt_pk_bf16_f32 v195, v195, v195
    v_and_b32 v195, 0xffff0000, v195
    v_lshlrev_b32 v196, 2, v193
    s_add_u32 s44, s4, 47185920
    s_addc_u32 s45, s5, 0
    s_mov_b32 s46, 8192
    s_mov_b32 s47, 0x20000
    s_lshl_b32 s48, s61, 5
    v_cmp_eq_u32 vcc, 0, v192
    s_and_saveexec_b64 s[50:51], vcc
    buffer_store_dword v195, v196, s[44:47], s48 offen sc1
    s_mov_b64 exec, s[50:51]
gated_mix__ssm_conv_s4d__geglu_ffn__prompt_kernel_ng_49:
    s_add_u32 s21, s21, s28
    s_add_u32 s33, s33, 1
    s_cmp_gt_u32 s29, s33
    s_cbranch_scc1 gated_mix__ssm_conv_s4d__geglu_ffn__prompt_kernel_chloop
gated_mix__ssm_conv_s4d__geglu_ffn__prompt_kernel_convdone:
    s_waitcnt vmcnt(0)
    s_add_u32 s52, s4, 48234496
    s_addc_u32 s53, s5, 0
    s_mov_b32 s54, 16384
    s_mov_b32 s55, 0x20000
    v_mul_u32_u24 v190, s28, v182
    v_add_u32 v190, s31, v190
    v_lshlrev_b32 v190, 2, v190
    v_add_u32 v190, 1792, v190
    v_mov_b32 v191, s65
    v_cmp_gt_u32 vcc, s29, v182
    s_and_saveexec_b64 s[56:57], vcc
    buffer_store_dword v191, v190, s[52:55], 0 offen sc0 sc1
    s_mov_b64 exec, s[56:57]
    s_lshl_b32 s50, s61, 2
    s_add_u32 s50, s50, 4096
    v_mov_b32 v190, 0
    s_mov_b64 exec, 1
    buffer_store_dword v191, v190, s[52:55], s50 offen sc0 sc1
    s_mov_b64 exec, -1
gated_mix__ssm_conv_s4d__geglu_ffn__prompt_kernel_fin:
    s_waitcnt vmcnt(0)
gated_mix__ssm_conv_s4d__geglu_ffn__prompt_kernel_end:
    s_endpgm
    .p2align 4
kmap_table:
    .short 1344, 1280, 1280, 1280, 1280, 1278, 1278, 1278
    .short 1278, 1278, 1278, 1278, 1276, 1276, 1276, 1276
    .short 1276, 1276, 1276, 1276, 1276, 1274, 1274, 1274
    .short 1274, 1274, 1274, 1274, 1272, 1272, 1272, 1272
    .short 1272, 1272, 1272, 1272, 1272, 1270, 1270, 1270
    .short 1270, 1270, 1270, 1270, 1268, 1268, 1268, 1268
    .short 1268, 1268, 1268, 1268, 1268, 1266, 1266, 1266
    .short 1266, 1266, 1266, 1266, 1264, 1264, 1264, 1264
    .short 1264, 1264, 1264, 1264, 1264, 1262, 1262, 1262
    .short 1262, 1262, 1262, 1262, 1260, 1260, 1260, 1260
    .short 1260, 1260, 1260, 1260, 1260, 1258, 1258, 1258
    .short 1258, 1258, 1258, 1258, 1256, 1256, 1256, 1256
    .short 1256, 1256, 1256, 1256, 1256, 1254, 1254, 1254
    .short 1254, 1254, 1254, 1254, 1252, 1252, 1252, 1252
    .short 1252, 1252, 1252, 1252, 1252, 1250, 1250, 1250
    .short 1250, 1250, 1250, 1250, 1248, 1248, 1248, 1248
    .short 1248, 1248, 1248, 1248, 1248, 1246, 1246, 1246
    .short 1246, 1246, 1246, 1246, 1244, 1244, 1244, 1244
    .short 1244, 1244, 1244, 1244, 1244, 1242, 1242, 1242
    .short 1242, 1242, 1242, 1242, 1240, 1240, 1240, 1240
    .short 1240, 1240, 1240, 1240, 1240, 1238, 1238, 1238
    .short 1238, 1238, 1238, 1238, 1236, 1236, 1236, 1236
    .short 1236, 1236, 1236, 1236, 1236, 1234, 1234, 1234
    .short 1234, 1234, 1234, 1234, 1232, 1232, 1232, 1232
    .short 1232, 1232, 1232, 1232, 1232, 1230, 1230, 1230
    .short 1230, 1230, 1230, 1230, 1228, 1228, 1228, 1228
    .short 1228, 1228, 1228, 1228, 1228, 1226, 1226, 1226
    .short 1226, 1226, 1226, 1226, 1224, 1224, 1224, 1224
    .short 1224, 1224, 1224, 1224, 1224, 1222, 1222, 1222
    .short 1222, 1222, 1222, 1222, 1220, 1220, 1220, 1220
    .short 1220, 1220, 1220, 1220, 1220, 1218, 1218, 1218
    .short 1218, 1218, 1218, 1218, 1216, 1216, 1216, 1216
    .short 1216, 1216, 1216, 1216, 1216, 1214, 1214, 1214
    .short 1214, 1214, 1214, 1214, 1212, 1212, 1212, 1212
    .short 1212, 1212, 1212, 1212, 1212, 1210, 1210, 1210
    .short 1210, 1210, 1210, 1210, 1208, 1208, 1208, 1208
    .short 1208, 1208, 1208, 1208, 1208, 1206, 1206, 1206
    .short 1206, 1206, 1206, 1206, 1204, 1204, 1204, 1204
    .short 1204, 1204, 1204, 1204, 1204, 1202, 1202, 1202
    .short 1202, 1202, 1202, 1202, 1200, 1200, 1200, 1200
    .short 1200, 1200, 1200, 1200, 1200, 1198, 1198, 1198
    .short 1198, 1198, 1198, 1198, 1196, 1196, 1196, 1196
    .short 1196, 1196, 1196, 1196, 1196, 1194, 1194, 1194
    .short 1194, 1194, 1194, 1194, 1192, 1192, 1192, 1192
    .short 1192, 1192, 1192, 1192, 1192, 1190, 1190, 1190
    .short 1190, 1190, 1190, 1190, 1188, 1188, 1188, 1188
    .short 1188, 1188, 1188, 1188, 1188, 1186, 1186, 1186
    .short 1186, 1186, 1186, 1186, 1184, 1184, 1184, 1184
    .short 1184, 1184, 1184, 1184, 1184, 1182, 1182, 1182
    .short 1182, 1182, 1182, 1182, 1180, 1180, 1180, 1180
    .short 1180, 1180, 1180, 1180, 1180, 1178, 1178, 1178
    .short 1178, 1178, 1178, 1178, 1176, 1176, 1176, 1176
    .short 1176, 1176, 1176, 1176, 1176, 1174, 1174, 1174
    .short 1174, 1174, 1174, 1174, 1172, 1172, 1172, 1172
    .short 1172, 1172, 1172, 1172, 1172, 1170, 1170, 1170
    .short 1170, 1170, 1170, 1170, 1168, 1168, 1168, 1168
    .short 1168, 1168, 1168, 1168, 1168, 1166, 1166, 1166
    .short 1166, 1166, 1166, 1166, 1164, 1164, 1164, 1164
    .short 1164, 1164, 1164, 1164, 1164, 1162, 1162, 1162
    .short 1162, 1162, 1162, 1162, 1160, 1160, 1160, 1160
    .short 1160, 1160, 1160, 1160, 1160, 1158, 1158, 1158
    .short 1158, 1158, 1158, 1158, 1156, 1156, 1156, 1156
    .short 1156, 1156, 1156, 1156, 1156, 1154, 1154, 1154
    .short 1154, 1154, 1154, 1154, 1152, 1152, 1152, 1152
    .short 1152, 1152, 1152, 1152, 1152, 1150, 1150, 1150
    .short 1150, 1150, 1150, 1150, 1148, 1148, 1148, 1148
    .short 1148, 1148, 1148, 1148, 1148, 1146, 1146, 1146
    .short 1146, 1146, 1146, 1146, 1144, 1144, 1144, 1144
    .short 1144, 1144, 1144, 1144, 1144, 1142, 1142, 1142
    .short 1142, 1142, 1142, 1142, 1140, 1140, 1140, 1140
    .short 1140, 1140, 1140, 1140, 1140, 1138, 1138, 1138
    .short 1138, 1138, 1138, 1138, 1136, 1136, 1136, 1136
    .short 1136, 1136, 1136, 1136, 1136, 1134, 1134, 1134
    .short 1134, 1134, 1134, 1134, 1132, 1132, 1132, 1132
    .short 1132, 1132, 1132, 1132, 1132, 1130, 1130, 1130
    .short 1130, 1130, 1130, 1130, 1128, 1128, 1128, 1128
    .short 1128, 1128, 1128, 1128, 1128, 1126, 1126, 1126
    .short 1126, 1126, 1126, 1126, 1124, 1124, 1124, 1124
    .short 1124, 1124, 1124, 1124, 1124, 1122, 1122, 1122
    .short 1122, 1122, 1122, 1122, 1120, 1120, 1120, 1120
    .short 1120, 1120, 1120, 1120, 1120, 1118, 1118, 1118
    .short 1118, 1118, 1118, 1118, 1116, 1116, 1116, 1116
    .short 1116, 1116, 1116, 1116, 1116, 1114, 1114, 1114
    .short 1114, 1114, 1114, 1114, 1112, 1112, 1112, 1112
    .short 1112, 1112, 1112, 1112, 1112, 1110, 1110, 1110
    .short 1110, 1110, 1110, 1110, 1108, 1108, 1108, 1108
    .short 1108, 1108, 1108, 1108, 1108, 1106, 1106, 1106
    .short 1106, 1106, 1106, 1106, 1104, 1104, 1104, 1104
    .short 1104, 1104, 1104, 1104, 1104, 1102, 1102, 1102
    .short 1102, 1102, 1102, 1102, 1100, 1100, 1100, 1100
    .short 1100, 1100, 1100, 1100, 1100, 1098, 1098, 1098
    .short 1098, 1098, 1098, 1098, 1096, 1096, 1096, 1096
    .short 1096, 1096, 1096, 1096, 1096, 1094, 1094, 1094
    .short 1094, 1094, 1094, 1094, 1092, 1092, 1092, 1092
    .short 1092, 1092, 1092, 1092, 1092, 1090, 1090, 1090
    .short 1090, 1090, 1090, 1090, 1088, 1088, 1088, 1088
    .short 1088, 1088, 1088, 1088, 1088, 1086, 1086, 1086
    .short 1086, 1086, 1086, 1086, 1084, 1084, 1084, 1084
    .short 1084, 1084, 1084, 1084, 1084, 1082, 1082, 1082
    .short 1082, 1082, 1082, 1082, 1080, 1080, 1080, 1080
    .short 1080, 1080, 1080, 1080, 1080, 1078, 1078, 1078
    .short 1078, 1078, 1078, 1078, 1076, 1076, 1076, 1076
    .short 1076, 1076, 1076, 1076, 1076, 1074, 1074, 1074
    .short 1074, 1074, 1074, 1074, 1072, 1072, 1072, 1072
    .short 1072, 1072, 1072, 1072, 1072, 1070, 1070, 1070
    .short 1070, 1070, 1070, 1070, 1068, 1068, 1068, 1068
    .short 1068, 1068, 1068, 1068, 1068, 1066, 1066, 1066
    .short 1066, 1066, 1066, 1066, 1064, 1064, 1064, 1064
    .short 1064, 1064, 1064, 1064, 1064, 1062, 1062, 1062
    .short 1062, 1062, 1062, 1062, 1060, 1060, 1060, 1060
    .short 1060, 1060, 1060, 1060, 1060, 1058, 1058, 1058
    .short 1058, 1058, 1058, 1058, 1056, 1056, 1056, 1056
    .short 1056, 1056, 1056, 1056, 1056, 1054, 1054, 1054
    .short 1054, 1054, 1054, 1054, 1052, 1052, 1052, 1052
    .short 1052, 1052, 1052, 1052, 1052, 1050, 1050, 1050
    .short 1050, 1050, 1050, 1050, 1048, 1048, 1048, 1048
    .short 1048, 1048, 1048, 1048, 1048, 1046, 1046, 1046
    .short 1046, 1046, 1046, 1046, 1044, 1044, 1044, 1044
    .short 1044, 1044, 1044, 1044, 1044, 1042, 1042, 1042
    .short 1042, 1042, 1042, 1042, 1040, 1040, 1040, 1040
    .short 1040, 1040, 1040, 1040, 1040, 1038, 1038, 1038
    .short 1038, 1038, 1038, 1038, 1036, 1036, 1036, 1036
    .short 1036, 1036, 1036, 1036, 1036, 1034, 1034, 1034
    .short 1034, 1034, 1034, 1034, 1032, 1032, 1032, 1032
    .short 1032, 1032, 1032, 1032, 1032, 1030, 1030, 1030
    .short 1030, 1030, 1030, 1030, 1028, 1028, 1028, 1028
    .short 1028, 1028, 1028, 1028, 1028, 1026, 1026, 1026
    .short 1026, 1026, 1026, 1026, 1024, 1024, 1024, 1024
    .short 1024, 1024, 1024, 1022, 1022, 1022, 958, 958
    .short 958, 958, 958, 1020, 1020, 1020, 956, 956
    .short 956, 956, 956, 1018, 1018, 1018, 954, 954
    .short 954, 954, 954, 1016, 1016, 1016, 952, 952
    .short 952, 952, 952, 1014, 1014, 1014, 950, 950
    .short 950, 950, 950, 1012, 1012, 1012, 948, 948
    .short 948, 948, 948, 1010, 1010, 1010, 946, 946
    .short 946, 946, 946, 1008, 1008, 1008, 944, 944
    .short 944, 944, 944, 1006, 1006, 1006, 942, 942
    .short 942, 942, 942, 1004, 1004, 1004, 940, 940
    .short 940, 940, 940, 1002, 1002, 1002, 938, 938
    .short 938, 938, 938, 1000, 1000, 1000, 936, 936
    .short 936, 936, 936, 998, 998, 998, 934, 934
    .short 934, 934, 934, 996, 996, 996, 932, 932
    .short 932, 932, 932, 994, 994, 994, 930, 930
    .short 930, 930, 930, 992, 992, 992, 928, 928
    .short 928, 928, 928, 990, 990, 990, 926, 926
    .short 926, 926, 926, 988, 988, 988, 924, 924
    .short 924, 924, 924, 986, 986, 986, 922, 922
    .short 922, 922, 922, 984, 984, 984, 920, 920
    .short 920, 920, 920, 982, 982, 982, 918, 918
    .short 918, 918, 918, 980, 980, 980, 916, 916
    .short 916, 916, 916, 978, 978, 978, 914, 914
    .short 914, 914, 914, 976, 976, 976, 912, 912
    .short 912, 912, 912, 974, 974, 974, 910, 910
    .short 910, 910, 910, 972, 972, 972, 908, 908
    .short 908, 908, 908, 970, 970, 970, 906, 906
    .short 906, 906, 906, 968, 968, 968, 904, 904
    .short 904, 904, 904, 966, 966, 966, 902, 902
    .short 902, 902, 902, 964, 964, 964, 900, 900
    .short 900, 900, 900, 962, 962, 962, 898, 898
    .short 898, 898, 898, 960, 960, 960, 896, 896
    .short 896, 896, 896, 894, 894, 894, 830, 830
    .short 830, 830, 830, 892, 892, 892, 828, 828
    .short 828, 828, 828, 890, 890, 890, 826, 826
    .short 826, 826, 826, 888, 888, 888, 824, 824
    .short 824, 824, 824, 886, 886, 886, 822, 822
    .short 822, 822, 822, 884, 884, 884, 820, 820
    .short 820, 820, 820, 882, 882, 882, 818, 818
    .short 818, 818, 818, 880, 880, 880, 816, 816
    .short 816, 816, 816, 878, 878, 878, 814, 814
    .short 814, 814, 814, 876, 876, 876, 812, 812
    .short 812, 812, 812, 874, 874, 874, 810, 810
    .short 810, 810, 810, 872, 872, 872, 808, 808
    .short 808, 808, 808, 870, 870, 870, 806, 806
    .short 806, 806, 806, 868, 868, 868, 804, 804
    .short 804, 804, 804, 866, 866, 866, 802, 802
    .short 802, 802, 802, 864, 864, 864, 800, 800
    .short 800, 800, 800, 862, 862, 862, 798, 798
    .short 798, 798, 798, 860, 860, 860, 796, 796
    .short 796, 796, 796, 858, 858, 858, 794, 794
    .short 794, 794, 794, 856, 856, 856, 792, 792
    .short 792, 792, 792, 854, 854, 854, 790, 790
    .short 790, 790, 790, 852, 852, 852, 788, 788
    .short 788, 788, 788, 850, 850, 850, 786, 786
    .short 786, 786, 786, 848, 848, 848, 784, 784
    .short 784, 784, 784, 846, 846, 846, 782, 782
    .short 782, 782, 782, 844, 844, 844, 780, 780
    .short 780, 780, 780, 842, 842, 842, 778, 778
    .short 778, 778, 778, 840, 840, 840, 776, 776
    .short 776, 776, 776, 838, 838, 838, 774, 774
    .short 774, 774, 774, 836, 836, 836, 772, 772
    .short 772, 772, 772, 834, 834, 834, 770, 770
    .short 770, 770, 770, 832, 832, 832, 768, 768
    .short 768, 768, 766, 702, 702, 702, 638, 574
    .short 574, 574, 764, 700, 700, 700, 636, 572
    .short 572, 572, 762, 698, 698, 698, 634, 570
    .short 570, 570, 760, 696, 696, 696, 632, 568
    .short 568, 568, 758, 694, 694, 694, 630, 566
    .short 566, 566, 756, 692, 692, 692, 628, 564
    .short 564, 564, 754, 690, 690, 690, 626, 562
    .short 562, 562, 752, 688, 688, 688, 624, 560
    .short 560, 560, 750, 686, 686, 686, 622, 558
    .short 558, 558, 748, 684, 684, 684, 620, 556
    .short 556, 556, 746, 682, 682, 682, 618, 554
    .short 554, 554, 744, 680, 680, 680, 616, 552
    .short 552, 552, 742, 678, 678, 678, 614, 550
    .short 550, 550, 740, 676, 676, 676, 612, 548
    .short 548, 548, 738, 674, 674, 674, 610, 546
    .short 546, 546, 736, 672, 672, 672, 608, 544
    .short 544, 544, 734, 670, 670, 670, 606, 542
    .short 542, 542, 732, 668, 668, 668, 604, 540
    .short 540, 540, 730, 666, 666, 666, 602, 538
    .short 538, 538, 728, 664, 664, 664, 600, 536
    .short 536, 536, 726, 662, 662, 662, 598, 534
    .short 534, 534, 724, 660, 660, 660, 596, 532
    .short 532, 532, 722, 658, 658, 658, 594, 530
    .short 530, 530, 720, 656, 656, 656, 592, 528
    .short 528, 528, 718, 654, 654, 654, 590, 526
    .short 526, 526, 716, 652, 652, 652, 588, 524
    .short 524, 524, 714, 650, 650, 650, 586, 522
    .short 522, 522, 712, 648, 648, 648, 584, 520
    .short 520, 520, 710, 646, 646, 646, 582, 518
    .short 518, 518, 708, 644, 644, 644, 580, 516
    .short 516, 516, 706, 642, 642, 642, 578, 514
    .short 514, 514, 704, 640, 640, 640, 576, 512
    .short 512, 510, 446, 382, 318, 254, 190, 126
    .short 62, 508, 444, 380, 316, 252, 188, 124
    .short 60, 506, 442, 378, 314, 250, 186, 122
    .short 58, 504, 440, 376, 312, 248, 184, 120
    .short 56, 502, 438, 374, 310, 246, 182, 118
    .short 54, 500, 436, 372, 308, 244, 180, 116
    .short 52, 498, 434, 370, 306, 242, 178, 114
    .short 50, 496, 432, 368, 304, 240, 176, 112
    .short 48, 494, 430, 366, 302, 238, 174, 110
    .short 46, 492, 428, 364, 300, 236, 172, 108
    .short 44, 490, 426, 362, 298, 234, 170, 106
    .short 42, 488, 424, 360, 296, 232, 168, 104
    .short 40, 486, 422, 358, 294, 230, 166, 102
    .short 38, 484, 420, 356, 292, 228, 164, 100
    .short 36, 482, 418, 354, 290, 226, 162, 98
    .short 34, 480, 416, 352, 288, 224, 160, 96
    .short 32, 478, 414, 350, 286, 222, 158, 94
    .short 30, 476, 412, 348, 284, 220, 156, 92
    .short 28, 474, 410, 346, 282, 218, 154, 90
    .short 26, 472, 408, 344, 280, 216, 152, 88
    .short 24, 470, 406, 342, 278, 214, 150, 86
    .short 22, 468, 404, 340, 276, 212, 148, 84
    .short 20, 466, 402, 338, 274, 210, 146, 82
    .short 18, 464, 400, 336, 272, 208, 144, 80
    .short 16, 462, 398, 334, 270, 206, 142, 78
    .short 14, 460, 396, 332, 268, 204, 140, 76
    .short 12, 458, 394, 330, 266, 202, 138, 74
    .short 10, 456, 392, 328, 264, 200, 136, 72
    .short 8, 454, 390, 326, 262, 198, 134, 70
    .short 6, 452, 388, 324, 260, 196, 132, 68
    .short 4, 450, 386, 322, 258, 194, 130, 66
    .short 2, 448, 384, 320, 256, 192, 128, 64
    .short 0, 1344, 1344, 1344, 1344, 1344, 1344, 1344
    .short 1344, 1344, 1344, 1344, 1344, 1344, 1344, 1344
    .short 1344, 1344, 1344, 1344, 1344, 1344, 1344, 1344
    .short 1344, 1344, 1344, 1344, 1344, 1344, 1344, 1344
.section .rodata,"a"
.p2align 6
.amdhsa_kernel gated_mix__ssm_conv_s4d__geglu_ffn__prompt_kernel
  .amdhsa_next_free_vgpr 512
  .amdhsa_next_free_sgpr 102
  .amdhsa_accum_offset 256
  .amdhsa_group_segment_fixed_size 0
  .amdhsa_kernarg_size 120
  .amdhsa_user_sgpr_count 2
  .amdhsa_user_sgpr_kernarg_segment_ptr 1
  .amdhsa_system_sgpr_workgroup_id_x 1
  .amdhsa_float_denorm_mode_32 3
  .amdhsa_float_denorm_mode_16_64 3
.end_amdhsa_kernel
.text
```
